```python
import torch

def _softmax(x, axis=-1):
    return torch.softmax(x, dim=axis)
def _gelu(x):
    return torch.nn.functional.gelu(x, approximate="tanh")
def _silu(x):
    return torch.nn.functional.silu(x)
def _sigmoid(x):
    return torch.sigmoid(x)
def _layernorm(x, axis=-1, eps=1e-5):
    m = x.mean(dim=axis, keepdim=True)
    v = x.var(dim=axis, keepdim=True, unbiased=False)
    return (x - m) / torch.sqrt(v + eps)
def _scatter_add(tgt, idx, src, axis=0):
    return tgt.clone().index_add_(axis, idx, src)
def _segment_sum(src, seg, n):
    out = torch.zeros((n,) + src.shape[1:], dtype=src.dtype)
    return out.index_add_(0, seg, src)
def _pad(x, pw):
    flat = tuple(v for pair in reversed(pw) for v in pair)
    return torch.nn.functional.pad(x, flat)

kernel_name = 'gated_mix__linear_kernel_hedgehog__glu_gated_glu__prompt'

def setup_inputs():

    _w = (lambda a: (lambda t: t.to(torch.bfloat16) if t.is_floating_point() else t)(torch.as_tensor(a)))
    def _A_setup():
        B, S, D, H = 1, 2048, 448, 16
        Dh = D // H
        return {
            "x": _w((lambda *s: torch.randn(*s, dtype=torch.bfloat16) * 0.05)(B, S, D)),
            "wqkv": _w((lambda *s: torch.randn(*s, dtype=torch.bfloat16) * 0.8)(D, 3 * D)),
            "w_phi": _w((lambda *s: torch.randn(*s, dtype=torch.bfloat16) * 0.8)(H, Dh, Dh) * (Dh ** -0.5)),
            "wo": _w((lambda *s: torch.randn(*s, dtype=torch.bfloat16) * 0.2)(D, D)),
        }
    _A_in = _A_setup()

    def _B_setup():
        B, S, D, F = 1, 2048, 448, 1792
        return {
            "x": _w((lambda *s: torch.randn(*s, dtype=torch.bfloat16) * 0.05)(B, S, D)),
            "w_gate": _w((lambda *s: torch.randn(*s, dtype=torch.bfloat16) * 0.4)(D, F)),
            "w_up": _w((lambda *s: torch.randn(*s, dtype=torch.bfloat16) * 0.05)(D, F)),
            "w_down": _w((lambda *s: torch.randn(*s, dtype=torch.bfloat16) * 0.05)(F, D)),
        }
    _B_in = _B_setup()

    return {
        "A_x": _A_in["x"],
        "A_wqkv": _A_in["wqkv"],
        "A_w_phi": _A_in["w_phi"],
        "A_wo": _A_in["wo"],
        "B_x": _B_in["x"],
        "B_w_gate": _B_in["w_gate"],
        "B_w_up": _B_in["w_up"],
        "B_w_down": _B_in["w_down"],
        "gate_w": _w((lambda *s: torch.randn(*s, dtype=torch.bfloat16) * 0.05)(448) * 16.0),
    }

def reference(A_x, A_wqkv, A_w_phi, A_wo, B_x, B_w_gate, B_w_up, B_w_down, gate_w):
    def _A_ref(x, wqkv, w_phi, wo):
        B, S, D = x.shape
        H = 16; Dh = D // H
        qkv = (lambda x, *d: x.permute(*d))((x @ wqkv).reshape(B, S, 3, H, Dh), 2, 0, 3, 1, 4)
        q, k, v = qkv[0], qkv[1], qkv[2]
        pq = torch.einsum("bhsd,hdf->bhsf", q, w_phi)
        pk = torch.einsum("bhsd,hdf->bhsf", k, w_phi)
        phi_q = torch.concatenate([_softmax(pq, axis=-1), _softmax(-pq, axis=-1)], axis=-1)
        phi_k = torch.concatenate([_softmax(pk, axis=-1), _softmax(-pk, axis=-1)], axis=-1)
        kv = torch.einsum("bhsf,bhsd->bhfd", phi_k, v)
        z  = torch.einsum("bhsf->bhf", phi_k)
        num = torch.einsum("bhqf,bhfd->bhqd", phi_q, kv)
        den = torch.einsum("bhqf,bhf->bhq", phi_q, z)[..., None] + 1e-6
        o = num / den
        return (lambda x, *d: x.permute(*d))(o, 0, 2, 1, 3).reshape(B, S, D) @ wo

    def _B_ref(x, w_gate, w_up, w_down):
        g = torch.einsum("bsd,df->bsf", x, w_gate)
        u = torch.einsum("bsd,df->bsf", x, w_up)
        h = _sigmoid(g) * u
        return torch.einsum("bsf,fd->bsd", h, w_down)

    x = A_x
    g = _sigmoid((x * gate_w).sum(-1, keepdims=True))
    a = _A_ref(x, A_wqkv, A_w_phi, A_wo)
    b = _B_ref(x, B_w_gate, B_w_up, B_w_down)
    return g * a + (1 - g) * b
```

```asm
; @launch grid=(256,1,1) block=(512,1,1) lds=163840
.amdgcn_target "amdgcn-amd-amdhsa--gfx950"
.text
.globl gated_mix__linear_kernel_hedgehog__glu_gated_glu__prompt_kernel
.p2align 8
.type gated_mix__linear_kernel_hedgehog__glu_gated_glu__prompt_kernel,@function
gated_mix__linear_kernel_hedgehog__glu_gated_glu__prompt_kernel:
    s_cmp_ge_u32 s2, 256
    s_cbranch_scc1 L_end
    s_load_dwordx2 s[4:5], s[0:1], 0
    s_load_dwordx2 s[8:9], s[0:1], 8
    s_load_dwordx2 s[12:13], s[0:1], 40
    s_load_dwordx2 s[16:17], s[0:1], 48
    s_load_dwordx2 s[40:41], s[0:1], 64
    s_getpc_b64 s[74:75]
L_pc:
    s_lshr_b32 s70, s2, 3
    s_lshl_b32 s71, s70, 11
    v_lshrrev_b32 v1, 5, v0
    v_lshl_add_u32 v2, v1, 7, s71
    v_min_u32 v2, L_end-L_pc, v2
    global_load_dword v9, v2, s[74:75]
    v_lshrrev_b32 v1, 6, v0
    v_and_b32 v0, 63, v0
    v_readfirstlane_b32 s3, v1
    s_and_b32 s49, s2, 7
    s_and_b32 s50, s70, 3
    s_lshr_b32 s51, s70, 2
    s_and_b32 s48, s3, 3
    s_and_b32 s53, s49, 1
    s_lshl_b32 s53, s53, 2
    s_add_u32 s53, s53, s50
    s_lshl_b32 s76, s53, 2
    s_add_u32 s76, s76, s48
    s_lshl_b32 s60, s48, 13
    s_lshr_b32 s52, s49, 1
    s_sub_u32 s71, 7, s51
    s_cmp_ge_u32 s51, 4
    s_cselect_b32 s71, s71, s51
    s_lshl_b32 s54, s52, 2
    s_add_u32 s54, s54, s71
    v_lshrrev_b32 v30, 3, v0
    v_and_b32 v31, 7, v0
    s_cmp_lt_u32 s3, 4
    s_cbranch_scc0 L_compute
    s_sub_u32 s71, s49, 7
    s_min_u32 s55, s49, s71
    s_mul_i32 s56, s76, 57344
    s_mov_b32 s6, 1835008
    s_mov_b32 s7, 0x20000
    s_mov_b32 s10, 1204224
    s_mov_b32 s11, 0x20000
    s_mov_b32 s14, 1605632
    s_mov_b32 s15, 0x20000
    s_mov_b32 s18, 1605632
    s_mov_b32 s19, 0x20000
    s_mov_b32 s42, 896
    s_mov_b32 s43, 0x20000
    v_lshrrev_b32 v40, 4, v0
    v_mul_u32_u24 v41, 896, v30
    v_xor_b32 v42, v31, v40
    v_lshl_add_u32 v16, v42, 4, v41
    v_xor_b32 v42, 4, v42
    v_lshl_add_u32 v17, v42, 4, v41
    v_add_u32 v15, s55, v30
    s_lshl_b32 s57, s55, 7
    s_add_u32 s57, s57, s56
    s_mul_i32 s58, s55, 172032
    s_mul_i32 s59, s55, 229376
    s_add_u32 s55, s55, 1
    s_cmp_eq_u32 s55, 7
    s_cselect_b32 s55, 0, s55
    s_mul_i32 s70, s48, 43008
    s_mul_i32 s71, s54, 56
    s_add_u32 s70, s70, s71
    v_lshrrev_b32 v40, 2, v0
    v_mul_u32_u24 v40, 2688, v40
    v_lshrrev_b32 v41, 4, v0
    v_and_b32 v41, 2, v41
    v_bitop3_b32 v41, v41, v0, 3 bitop3:0x78
    v_lshl_add_u32 v40, v41, 4, v40
    v_add_u32 v14, s70, v40
    s_waitcnt lgkmcnt(0)
    s_add_u32 m0, s60, 0
    s_nop 0
    buffer_load_dwordx4 v16, s[4:7], s57 offen lds
    s_add_u32 m0, s60, 1024
    s_add_u32 s57, s57, 7168
    buffer_load_dwordx4 v17, s[4:7], s57 offen lds
    s_add_u32 m0, s60, 2048
    s_add_u32 s57, s57, 7168
    buffer_load_dwordx4 v16, s[4:7], s57 offen lds
    s_add_u32 m0, s60, 3072
    s_add_u32 s57, s57, 7168
    buffer_load_dwordx4 v17, s[4:7], s57 offen lds
    s_add_u32 m0, s60, 4096
    s_add_u32 s57, s57, 7168
    buffer_load_dwordx4 v16, s[4:7], s57 offen lds
    s_add_u32 m0, s60, 5120
    s_add_u32 s57, s57, 7168
    buffer_load_dwordx4 v17, s[4:7], s57 offen lds
    s_add_u32 m0, s60, 6144
    s_add_u32 s57, s57, 7168
    buffer_load_dwordx4 v16, s[4:7], s57 offen lds
    s_add_u32 m0, s60, 7168
    s_add_u32 s57, s57, 7168
    buffer_load_dwordx4 v17, s[4:7], s57 offen lds
    s_load_dwordx2 s[28:29], s[0:1], 88
    s_load_dwordx2 s[36:37], s[0:1], 16
    s_load_dwordx2 s[20:21], s[0:1], 56
    s_load_dwordx2 s[24:25], s[0:1], 24
    s_load_dwordx2 s[32:33], s[0:1], 72
    s_load_dwordx2 s[44:45], s[0:1], 80
    s_cmp_ge_u32 s51, 4
    s_cbranch_scc0 L_firstB
    v_add_u32 v10, 896, v14
    v_add_u32 v11, 1792, v14
    s_lshl_b32 s61, s48, 10
    s_add_u32 s61, s61, 98304
    s_lshl_b32 s70, s54, 1
    s_lshr_b32 s70, 3789665481, s70
    s_and_b32 s70, s70, 3
    s_lshl_b32 s71, s52, 2
    s_add_u32 s70, s70, s71
    s_mul_i32 s70, s70, 96
    s_lshr_b32 s71, s48, 1
    s_mul_i32 s72, s71, 114688
    s_add_u32 s70, s70, s72
    s_add_u32 s70, s70, 2048
    s_mul_i32 s62, s71, 3072
    s_add_u32 s62, s62, 106496
    s_add_u32 s72, s62, 6272
    s_bitcmp1_b32 s48, 0
    s_cselect_b32 s62, s72, s62
    s_cselect_b32 s12, s16, s12
    s_cselect_b32 s13, s17, s13
    v_add_u32 v40, 0, v0
    v_mul_u32_u24 v41, 171, v40
    v_lshrrev_b32 v41, 10, v41
    v_lshrrev_b32 v42, 1, v41
    v_bitop3_b32 v42, v42, v41, 4 bitop3:0x28
    v_mul_u32_u24 v42, 3, v42
    v_xor_b32 v42, v42, v41
    v_mul_u32_u24 v42, 3584, v42
    v_mul_u32_u24 v41, 96, v41
    v_sub_u32 v41, v42, v41
    v_lshl_add_u32 v41, v40, 4, v41
    v_add_u32 v12, s70, v41
    v_add_u32 v40, 64, v0
    v_mul_u32_u24 v41, 171, v40
    v_lshrrev_b32 v41, 10, v41
    v_lshrrev_b32 v42, 1, v41
    v_bitop3_b32 v42, v42, v41, 4 bitop3:0x28
    v_mul_u32_u24 v42, 3, v42
    v_xor_b32 v42, v42, v41
    v_mul_u32_u24 v42, 3584, v42
    v_mul_u32_u24 v41, 96, v41
    v_sub_u32 v41, v42, v41
    v_lshl_add_u32 v41, v40, 4, v41
    v_add_u32 v13, s70, v41
    v_add_u32 v40, 128, v0
    v_mul_u32_u24 v41, 171, v40
    v_lshrrev_b32 v41, 10, v41
    v_lshrrev_b32 v42, 1, v41
    v_bitop3_b32 v42, v42, v41, 4 bitop3:0x28
    v_mul_u32_u24 v42, 3, v42
    v_xor_b32 v42, v42, v41
    v_mul_u32_u24 v42, 3584, v42
    v_mul_u32_u24 v41, 96, v41
    v_sub_u32 v41, v42, v41
    v_lshl_add_u32 v41, v40, 4, v41
    v_add_u32 v14, s70, v41
    s_add_u32 m0, s61, 0
    s_nop 0
    buffer_load_dwordx4 v10, s[8:11], s58 offen lds
    s_add_u32 m0, s61, 4096
    s_nop 0
    buffer_load_dwordx4 v11, s[8:11], s58 offen lds
    s_add_u32 m0, s62, 0
    s_nop 0
    buffer_load_dwordx4 v12, s[12:15], s59 offen lds
    s_add_u32 m0, s62, 1024
    s_nop 0
    buffer_load_dwordx4 v13, s[12:15], s59 offen lds
    s_add_u32 m0, s62, 2048
    s_nop 0
    buffer_load_dwordx4 v14, s[12:15], s59 offen lds
    s_branch L_loadA
L_firstB:
    s_mul_i32 s61, s48, 5120
    s_add_u32 s61, s61, 98304
    s_mul_i32 s70, s48, 57344
    s_lshl_b32 s71, s54, 7
    s_add_u32 s70, s70, s71
    v_mul_u32_u24 v40, 3584, v30
    v_add_u32 v40, s70, v40
    v_bfe_u32 v41, v0, 4, 1
    v_lshlrev_b32 v41, 1, v41
    v_xor_b32 v41, v41, v31
    v_lshl_add_u32 v10, v41, 4, v40
    v_xor_b32 v41, 64, v10
    v_add_u32 v11, 28672, v41
    s_add_u32 m0, s61, 0
    s_nop 0
    buffer_load_dwordx4 v10, s[12:15], s59 offen lds
    s_add_u32 m0, s61, 1024
    s_nop 0
    buffer_load_dwordx4 v11, s[12:15], s59 offen lds
    s_add_u32 m0, s61, 2048
    s_nop 0
    buffer_load_dwordx4 v10, s[16:19], s59 offen lds
    s_add_u32 m0, s61, 3072
    s_nop 0
    buffer_load_dwordx4 v11, s[16:19], s59 offen lds
    s_add_u32 m0, s61, 4096
    s_nop 0
    buffer_load_dwordx4 v14, s[8:11], s58 offen lds
    v_subrev_u32 v41, 7, v15
    v_min_u32 v40, v15, v41
    v_lshlrev_b32 v40, 7, v40
    v_lshl_add_u32 v40, v31, 4, v40
    s_mov_b32 m0, 160256
    s_lshr_b64 exec, -1, 8
    buffer_load_dwordx4 v40, s[40:43], 0 offen lds
    s_mov_b64 exec, -1
    s_mov_b32 s22, 1605632
    s_mov_b32 s23, 0x20000
    s_mov_b32 s26, 401408
    s_mov_b32 s27, 0x20000
    s_mov_b32 s30, 11075712
    s_mov_b32 s31, 0x20000
    s_mov_b32 s34, 1835008
    s_mov_b32 s35, 0x20000
    s_mov_b32 s38, 25088
    s_mov_b32 s39, 0x20000
    s_mov_b32 s46, 256
    s_mov_b32 s47, 0x20000
    s_waitcnt lgkmcnt(0)
    v_lshlrev_b32 v1, 4, v0
    s_lshl_b32 s67, s49, 2
    s_add_u32 s67, s67, s50
    s_add_u32 s65, s51, s50
    s_lshl_b32 s66, s51, 7
    s_mul_i32 s77, s67, 294912
    v_mov_b32 v5, 163712
    v_mul_u32_u24 v40, 896, v30
    v_bfe_u32 v41, v30, 2, 1
    v_and_b32 v42, 2, v30
    v_add_lshl_u32 v42, v42, v41, 1
    v_xor_b32 v42, v42, v31
    v_lshl_add_u32 v40, v42, 4, v40
    v_add_u32 v4, s66, v40
    v_lshrrev_b32 v42, 5, v0
    v_mul_u32_u24 v42, 2688, v42
    v_add_u32 v7, v4, v42
    v_and_b32 v42, 3, v30
    v_cmp_eq_u32 vcc, 3, v42
    v_mov_b32 v42, 0x10000000
    s_nop 0
    v_cndmask_b32 v8, v7, v42, vcc
    v_bfe_u32 v40, v0, 2, 3
    v_lshrrev_b32 v42, 5, v0
    v_lshl_add_u32 v40, v42, 4, v40
    v_bfe_u32 v42, v40, 2, 1
    v_and_b32 v41, 2, v40
    v_add_lshl_u32 v41, v41, v42, 1
    v_lshl_add_u32 v40, v40, 7, s60
    v_lshl_add_u32 v40, v41, 4, v40
    v_and_b32 v42, 3, v0
    v_lshl_add_u32 v6, v42, 3, v40
    v_mov_b32 v3, 11075584
    s_or_b32 s70, s2, s48
    s_cbranch_scc1 L_notag0
    buffer_load_dword v2, v3, s[28:31], 0 offen sc1
L_notag0:
    v_mul_u32_u24 v40, 52, v0
    v_lshrrev_b32 v40, 8, v40
    v_mul_u32_u24 v41, 5, v40
    v_sub_u32 v41, v0, v41
    v_lshlrev_b32 v41, 4, v41
    v_min_u32 v41, 52, v41
    v_lshl_add_u32 v40, s48, 3, v40
    v_cmp_lt_u32 vcc, 27, v40
    v_mul_u32_u24 v40, 56, v40
    s_mul_i32 s70, s54, 1568
    v_add3_u32 v40, v40, v41, s70
    v_mov_b32 v41, 0x10000000
    v_cndmask_b32 v40, v40, v41, vcc
    s_mul_i32 s70, s48, 640
    s_add_u32 m0, s70, 161152
    s_lshr_b64 exec, -1, 24
    buffer_load_dwordx4 v40, s[36:39], 0 offen lds
    s_mov_b64 exec, -1
    s_bitcmp1_b32 s48, 0
    s_cselect_b32 s40, s16, s12
    s_cselect_b32 s41, s17, s13
    s_cselect_b32 s42, s18, s14
    s_cmp_ge_u32 s48, 2
    s_cselect_b32 s40, s8, s40
    s_cselect_b32 s41, s9, s41
    s_cselect_b32 s42, s10, s42
    s_mov_b32 s74, 3584
    s_cmov_b32 s74, 2688
    s_mov_b32 s71, 512
    s_cmov_b32 s71, 224
    s_mov_b32 s72, 384
    s_cmov_b32 s72, 224
    s_mov_b32 s73, 2048
    s_cmov_b32 s73, 896
    s_mul_i32 s63, s71, s52
    s_mul_i32 s64, s72, s52
    s_add_u32 s64, s64, s73
    s_cmp_eq_u32 s48, 3
    s_cselect_b32 s71, 1792, 0
    s_add_u32 s63, s63, s71
    s_lshr_b32 s71, s2, 3
    s_and_b32 s72, s2, 1
    s_lshl_b32 s72, s72, 5
    s_add_u32 s71, s71, s72
    s_mul_i32 s71, s71, s74
    s_and_b32 s63, s63, 0xffffff80
    s_add_u32 s63, s63, s71
    s_and_b32 s64, s64, 0xffffff80
    s_add_u32 s64, s64, s71
    s_lshl_b32 s69, s74, 6
    s_or_b32 s71, s49, 1
    s_add_u32 s71, s71, 2
    s_sub_u32 s72, s71, 7
    s_min_u32 s71, s71, s72
    s_mul_i32 s71, s71, s69
    s_add_u32 s72, s71, s64
    s_add_u32 s71, s71, s63
    s_buffer_load_dwordx2 s[78:79], s[40:43], s71 offset:60
    s_buffer_load_dwordx2 s[78:79], s[40:43], s71 offset:188
    s_buffer_load_dwordx2 s[78:79], s[40:43], s71 offset:316
    s_cmp_eq_u32 s48, 3
    s_cbranch_scc1 L_1
    s_buffer_load_dwordx2 s[78:79], s[40:43], s72 offset:60
    s_buffer_load_dwordx2 s[78:79], s[40:43], s72 offset:188
    s_buffer_load_dwordx2 s[78:79], s[40:43], s72 offset:316
    s_cmp_eq_u32 s48, 2
    s_cbranch_scc1 L_1
    s_buffer_load_dwordx2 s[78:79], s[40:43], s71 offset:444
L_1:
    s_lshl_b32 s57, s55, 7
    s_add_u32 s57, s57, s56
    s_mul_i32 s58, s55, 172032
    s_mul_i32 s59, s55, 229376
    s_add_u32 s55, s55, 1
    s_cmp_eq_u32 s55, 7
    s_cselect_b32 s55, 0, s55
    s_add_u32 m0, s61, 24832
    s_nop 0
    buffer_load_dwordx4 v14, s[8:11], s58 offen lds
    s_add_u32 m0, s60, 32768
    s_nop 0
    buffer_load_dwordx4 v16, s[4:7], s57 offen lds
    s_add_u32 m0, s60, 33792
    s_add_u32 s57, s57, 7168
    buffer_load_dwordx4 v17, s[4:7], s57 offen lds
    s_add_u32 m0, s60, 34816
    s_add_u32 s57, s57, 7168
    buffer_load_dwordx4 v16, s[4:7], s57 offen lds
    s_add_u32 m0, s60, 35840
    s_add_u32 s57, s57, 7168
    buffer_load_dwordx4 v17, s[4:7], s57 offen lds
    s_add_u32 m0, s60, 36864
    s_add_u32 s57, s57, 7168
    buffer_load_dwordx4 v16, s[4:7], s57 offen lds
    s_add_u32 m0, s60, 37888
    s_add_u32 s57, s57, 7168
    buffer_load_dwordx4 v17, s[4:7], s57 offen lds
    s_add_u32 m0, s60, 38912
    s_add_u32 s57, s57, 7168
    buffer_load_dwordx4 v16, s[4:7], s57 offen lds
    s_add_u32 m0, s60, 39936
    s_add_u32 s57, s57, 7168
    buffer_load_dwordx4 v17, s[4:7], s57 offen lds
    s_waitcnt vmcnt(10)
    s_barrier
    s_add_u32 m0, s61, 20736
    s_nop 0
    buffer_load_dwordx4 v10, s[12:15], s59 offen lds
    s_add_u32 m0, s61, 21760
    s_nop 0
    buffer_load_dwordx4 v11, s[12:15], s59 offen lds
    s_add_u32 m0, s61, 22784
    s_nop 0
    buffer_load_dwordx4 v10, s[16:19], s59 offen lds
    s_add_u32 m0, s61, 23808
    s_nop 0
    buffer_load_dwordx4 v11, s[16:19], s59 offen lds
    s_lshl_b32 s57, s55, 7
    s_add_u32 s57, s57, s56
    s_mul_i32 s58, s55, 172032
    s_mul_i32 s59, s55, 229376
    s_add_u32 s55, s55, 1
    s_cmp_eq_u32 s55, 7
    s_cselect_b32 s55, 0, s55
    s_add_u32 m0, s61, 45568
    s_nop 0
    buffer_load_dwordx4 v14, s[8:11], s58 offen lds
    s_add_u32 m0, s60, 65536
    s_nop 0
    buffer_load_dwordx4 v16, s[4:7], s57 offen lds
    s_add_u32 m0, s60, 66560
    s_add_u32 s57, s57, 7168
    buffer_load_dwordx4 v17, s[4:7], s57 offen lds
    s_add_u32 m0, s60, 67584
    s_add_u32 s57, s57, 7168
    buffer_load_dwordx4 v16, s[4:7], s57 offen lds
    s_add_u32 m0, s60, 68608
    s_add_u32 s57, s57, 7168
    buffer_load_dwordx4 v17, s[4:7], s57 offen lds
    s_add_u32 m0, s60, 69632
    s_add_u32 s57, s57, 7168
    buffer_load_dwordx4 v16, s[4:7], s57 offen lds
    s_add_u32 m0, s60, 70656
    s_add_u32 s57, s57, 7168
    buffer_load_dwordx4 v17, s[4:7], s57 offen lds
    s_add_u32 m0, s60, 71680
    s_add_u32 s57, s57, 7168
    buffer_load_dwordx4 v16, s[4:7], s57 offen lds
    s_add_u32 m0, s60, 72704
    s_add_u32 s57, s57, 7168
    buffer_load_dwordx4 v17, s[4:7], s57 offen lds
    s_add_u32 m0, s61, 41472
    s_nop 0
    buffer_load_dwordx4 v10, s[12:15], s59 offen lds
    s_add_u32 m0, s61, 42496
    s_nop 0
    buffer_load_dwordx4 v11, s[12:15], s59 offen lds
    s_add_u32 m0, s61, 43520
    s_nop 0
    buffer_load_dwordx4 v10, s[16:19], s59 offen lds
    s_add_u32 m0, s61, 44544
    s_nop 0
    buffer_load_dwordx4 v11, s[16:19], s59 offen lds
    s_or_b32 s71, s49, 1
    s_add_u32 s71, s71, 3
    s_sub_u32 s72, s71, 7
    s_min_u32 s71, s71, s72
    s_mul_i32 s71, s71, s69
    s_add_u32 s72, s71, s64
    s_add_u32 s71, s71, s63
    s_buffer_load_dwordx2 s[78:79], s[40:43], s71 offset:60
    s_buffer_load_dwordx2 s[78:79], s[40:43], s71 offset:188
    s_buffer_load_dwordx2 s[78:79], s[40:43], s71 offset:316
    s_cmp_eq_u32 s48, 3
    s_cbranch_scc1 L_2
    s_buffer_load_dwordx2 s[78:79], s[40:43], s72 offset:60
    s_buffer_load_dwordx2 s[78:79], s[40:43], s72 offset:188
    s_buffer_load_dwordx2 s[78:79], s[40:43], s72 offset:316
    s_cmp_eq_u32 s48, 2
    s_cbranch_scc1 L_2
    s_buffer_load_dwordx2 s[78:79], s[40:43], s71 offset:444
L_2:
    s_waitcnt vmcnt(13)
    s_or_b32 s70, s2, s48
    s_cbranch_scc1 L_notag1
    s_mov_b64 exec, 1
    v_add_u32 v2, 0x9e3779b1, v2
    v_max_u32 v2, 1, v2
    buffer_store_dword v2, v1, s[44:47], 0 offen sc1
    buffer_store_dword v2, v3, s[28:31], 0 offen sc1
    s_mov_b64 exec, -1
L_notag1:
    s_barrier
    s_lshl_b32 s57, s55, 7
    s_add_u32 s57, s57, s56
    s_mul_i32 s58, s55, 172032
    s_mul_i32 s59, s55, 229376
    s_add_u32 s55, s55, 1
    s_cmp_eq_u32 s55, 7
    s_cselect_b32 s55, 0, s55
    s_add_u32 m0, s61, 4096
    s_nop 0
    buffer_load_dwordx4 v14, s[8:11], s58 offen lds
    s_add_u32 m0, s60, 0
    s_nop 0
    buffer_load_dwordx4 v16, s[4:7], s57 offen lds
    s_add_u32 m0, s60, 1024
    s_add_u32 s57, s57, 7168
    buffer_load_dwordx4 v17, s[4:7], s57 offen lds
    s_add_u32 m0, s60, 2048
    s_add_u32 s57, s57, 7168
    buffer_load_dwordx4 v16, s[4:7], s57 offen lds
    s_add_u32 m0, s60, 3072
    s_add_u32 s57, s57, 7168
    buffer_load_dwordx4 v17, s[4:7], s57 offen lds
    s_add_u32 m0, s60, 4096
    s_add_u32 s57, s57, 7168
    buffer_load_dwordx4 v16, s[4:7], s57 offen lds
    s_add_u32 m0, s60, 5120
    s_add_u32 s57, s57, 7168
    buffer_load_dwordx4 v17, s[4:7], s57 offen lds
    s_add_u32 m0, s60, 6144
    s_add_u32 s57, s57, 7168
    buffer_load_dwordx4 v16, s[4:7], s57 offen lds
    s_add_u32 m0, s60, 7168
    s_add_u32 s57, s57, 7168
    buffer_load_dwordx4 v17, s[4:7], s57 offen lds
    s_add_u32 m0, s61, 0
    s_nop 0
    buffer_load_dwordx4 v10, s[12:15], s59 offen lds
    s_add_u32 m0, s61, 1024
    s_nop 0
    buffer_load_dwordx4 v11, s[12:15], s59 offen lds
    s_add_u32 m0, s61, 2048
    s_nop 0
    buffer_load_dwordx4 v10, s[16:19], s59 offen lds
    s_add_u32 m0, s61, 3072
    s_nop 0
    buffer_load_dwordx4 v11, s[16:19], s59 offen lds
    s_or_b32 s71, s49, 1
    s_add_u32 s71, s71, 4
    s_sub_u32 s72, s71, 7
    s_min_u32 s71, s71, s72
    s_mul_i32 s71, s71, s69
    s_add_u32 s72, s71, s64
    s_add_u32 s71, s71, s63
    s_buffer_load_dwordx2 s[78:79], s[40:43], s71 offset:60
    s_buffer_load_dwordx2 s[78:79], s[40:43], s71 offset:188
    s_buffer_load_dwordx2 s[78:79], s[40:43], s71 offset:316
    s_cmp_eq_u32 s48, 3
    s_cbranch_scc1 L_3
    s_buffer_load_dwordx2 s[78:79], s[40:43], s72 offset:60
    s_buffer_load_dwordx2 s[78:79], s[40:43], s72 offset:188
    s_buffer_load_dwordx2 s[78:79], s[40:43], s72 offset:316
    s_cmp_eq_u32 s48, 2
    s_cbranch_scc1 L_3
    s_buffer_load_dwordx2 s[78:79], s[40:43], s71 offset:444
L_3:
    s_waitcnt vmcnt(13)
    s_barrier
    s_lshl_b32 s57, s55, 7
    s_add_u32 s57, s57, s56
    s_mul_i32 s58, s55, 172032
    s_mul_i32 s59, s55, 229376
    s_add_u32 s55, s55, 1
    s_cmp_eq_u32 s55, 7
    s_cselect_b32 s55, 0, s55
    s_add_u32 m0, s61, 24832
    s_nop 0
    buffer_load_dwordx4 v14, s[8:11], s58 offen lds
    s_add_u32 m0, s60, 32768
    s_nop 0
    buffer_load_dwordx4 v16, s[4:7], s57 offen lds
    s_add_u32 m0, s60, 33792
    s_add_u32 s57, s57, 7168
    buffer_load_dwordx4 v17, s[4:7], s57 offen lds
    s_add_u32 m0, s60, 34816
    s_add_u32 s57, s57, 7168
    buffer_load_dwordx4 v16, s[4:7], s57 offen lds
    s_add_u32 m0, s60, 35840
    s_add_u32 s57, s57, 7168
    buffer_load_dwordx4 v17, s[4:7], s57 offen lds
    s_add_u32 m0, s60, 36864
    s_add_u32 s57, s57, 7168
    buffer_load_dwordx4 v16, s[4:7], s57 offen lds
    s_add_u32 m0, s60, 37888
    s_add_u32 s57, s57, 7168
    buffer_load_dwordx4 v17, s[4:7], s57 offen lds
    s_add_u32 m0, s60, 38912
    s_add_u32 s57, s57, 7168
    buffer_load_dwordx4 v16, s[4:7], s57 offen lds
    s_add_u32 m0, s60, 39936
    s_add_u32 s57, s57, 7168
    buffer_load_dwordx4 v17, s[4:7], s57 offen lds
    s_add_u32 m0, s61, 20736
    s_nop 0
    buffer_load_dwordx4 v10, s[12:15], s59 offen lds
    s_add_u32 m0, s61, 21760
    s_nop 0
    buffer_load_dwordx4 v11, s[12:15], s59 offen lds
    s_add_u32 m0, s61, 22784
    s_nop 0
    buffer_load_dwordx4 v10, s[16:19], s59 offen lds
    s_add_u32 m0, s61, 23808
    s_nop 0
    buffer_load_dwordx4 v11, s[16:19], s59 offen lds
    s_or_b32 s71, s49, 1
    s_add_u32 s71, s71, 5
    s_sub_u32 s72, s71, 7
    s_min_u32 s71, s71, s72
    s_mul_i32 s71, s71, s69
    s_add_u32 s72, s71, s64
    s_add_u32 s71, s71, s63
    s_buffer_load_dwordx2 s[78:79], s[40:43], s71 offset:60
    s_buffer_load_dwordx2 s[78:79], s[40:43], s71 offset:188
    s_buffer_load_dwordx2 s[78:79], s[40:43], s71 offset:316
    s_cmp_eq_u32 s48, 3
    s_cbranch_scc1 L_4
    s_buffer_load_dwordx2 s[78:79], s[40:43], s72 offset:60
    s_buffer_load_dwordx2 s[78:79], s[40:43], s72 offset:188
    s_buffer_load_dwordx2 s[78:79], s[40:43], s72 offset:316
    s_cmp_eq_u32 s48, 2
    s_cbranch_scc1 L_4
    s_buffer_load_dwordx2 s[78:79], s[40:43], s71 offset:444
L_4:
    s_waitcnt vmcnt(13)
    s_barrier
    s_lshl_b32 s57, s55, 7
    s_add_u32 s57, s57, s56
    s_mul_i32 s58, s55, 172032
    s_mul_i32 s59, s55, 229376
    s_add_u32 s55, s55, 1
    s_cmp_eq_u32 s55, 7
    s_cselect_b32 s55, 0, s55
    s_add_u32 m0, s61, 45568
    s_nop 0
    buffer_load_dwordx4 v14, s[8:11], s58 offen lds
    s_add_u32 m0, s60, 65536
    s_nop 0
    buffer_load_dwordx4 v16, s[4:7], s57 offen lds
    s_add_u32 m0, s60, 66560
    s_add_u32 s57, s57, 7168
    buffer_load_dwordx4 v17, s[4:7], s57 offen lds
    s_add_u32 m0, s60, 67584
    s_add_u32 s57, s57, 7168
    buffer_load_dwordx4 v16, s[4:7], s57 offen lds
    s_add_u32 m0, s60, 68608
    s_add_u32 s57, s57, 7168
    buffer_load_dwordx4 v17, s[4:7], s57 offen lds
    s_add_u32 m0, s60, 69632
    s_add_u32 s57, s57, 7168
    buffer_load_dwordx4 v16, s[4:7], s57 offen lds
    s_add_u32 m0, s60, 70656
    s_add_u32 s57, s57, 7168
    buffer_load_dwordx4 v17, s[4:7], s57 offen lds
    s_add_u32 m0, s60, 71680
    s_add_u32 s57, s57, 7168
    buffer_load_dwordx4 v16, s[4:7], s57 offen lds
    s_add_u32 m0, s60, 72704
    s_add_u32 s57, s57, 7168
    buffer_load_dwordx4 v17, s[4:7], s57 offen lds
    s_add_u32 m0, s61, 41472
    s_nop 0
    buffer_load_dwordx4 v10, s[12:15], s59 offen lds
    s_add_u32 m0, s61, 42496
    s_nop 0
    buffer_load_dwordx4 v11, s[12:15], s59 offen lds
    s_add_u32 m0, s61, 43520
    s_nop 0
    buffer_load_dwordx4 v10, s[16:19], s59 offen lds
    s_add_u32 m0, s61, 44544
    s_nop 0
    buffer_load_dwordx4 v11, s[16:19], s59 offen lds
    s_lshl_b32 s70, s2, 2
    s_add_u32 s70, s70, s48
    s_mul_i32 s71, s70, 1664
    s_lshl_b32 s70, s70, 9
    s_add_u32 s72, s71, 60
    s_buffer_load_dwordx2 s[78:79], s[20:23], s72
    s_add_u32 s72, s71, 188
    s_buffer_load_dwordx2 s[78:79], s[20:23], s72
    s_add_u32 s72, s71, 316
    s_buffer_load_dwordx2 s[78:79], s[20:23], s72
    s_add_u32 s72, s71, 444
    s_buffer_load_dwordx2 s[78:79], s[20:23], s72
    s_add_u32 s72, s71, 572
    s_buffer_load_dwordx2 s[78:79], s[20:23], s72
    s_add_u32 s72, s71, 700
    s_buffer_load_dwordx2 s[78:79], s[20:23], s72
    s_waitcnt vmcnt(13)
    s_barrier
    s_lshl_b32 s57, s55, 7
    s_add_u32 s57, s57, s56
    s_mul_i32 s58, s55, 172032
    s_mul_i32 s59, s55, 229376
    s_add_u32 s55, s55, 1
    s_cmp_eq_u32 s55, 7
    s_cselect_b32 s55, 0, s55
    s_add_u32 m0, s61, 4096
    s_nop 0
    buffer_load_dwordx4 v14, s[8:11], s58 offen lds
    s_add_u32 m0, s60, 0
    s_nop 0
    buffer_load_dwordx4 v16, s[4:7], s57 offen lds
    s_add_u32 m0, s60, 1024
    s_add_u32 s57, s57, 7168
    buffer_load_dwordx4 v17, s[4:7], s57 offen lds
    s_add_u32 m0, s60, 2048
    s_add_u32 s57, s57, 7168
    buffer_load_dwordx4 v16, s[4:7], s57 offen lds
    s_add_u32 m0, s60, 3072
    s_add_u32 s57, s57, 7168
    buffer_load_dwordx4 v17, s[4:7], s57 offen lds
    s_add_u32 m0, s60, 4096
    s_add_u32 s57, s57, 7168
    buffer_load_dwordx4 v16, s[4:7], s57 offen lds
    s_add_u32 m0, s60, 5120
    s_add_u32 s57, s57, 7168
    buffer_load_dwordx4 v17, s[4:7], s57 offen lds
    s_add_u32 m0, s60, 6144
    s_add_u32 s57, s57, 7168
    buffer_load_dwordx4 v16, s[4:7], s57 offen lds
    s_add_u32 m0, s60, 7168
    s_add_u32 s57, s57, 7168
    buffer_load_dwordx4 v17, s[4:7], s57 offen lds
    s_add_u32 m0, s61, 0
    s_nop 0
    buffer_load_dwordx4 v10, s[12:15], s59 offen lds
    s_add_u32 m0, s61, 1024
    s_nop 0
    buffer_load_dwordx4 v11, s[12:15], s59 offen lds
    s_add_u32 m0, s61, 2048
    s_nop 0
    buffer_load_dwordx4 v10, s[16:19], s59 offen lds
    s_add_u32 m0, s61, 3072
    s_nop 0
    buffer_load_dwordx4 v11, s[16:19], s59 offen lds
    s_lshl_b32 s70, s2, 2
    s_add_u32 s70, s70, s48
    s_mul_i32 s71, s70, 1664
    s_lshl_b32 s70, s70, 9
    s_add_u32 s72, s71, 828
    s_buffer_load_dwordx2 s[78:79], s[20:23], s72
    s_add_u32 s72, s71, 956
    s_buffer_load_dwordx2 s[78:79], s[20:23], s72
    s_add_u32 s72, s71, 1084
    s_buffer_load_dwordx2 s[78:79], s[20:23], s72
    s_add_u32 s72, s71, 1212
    s_buffer_load_dwordx2 s[78:79], s[20:23], s72
    s_add_u32 s72, s71, 1340
    s_buffer_load_dwordx2 s[78:79], s[20:23], s72
    s_add_u32 s72, s71, 1468
    s_buffer_load_dwordx2 s[78:79], s[20:23], s72
    s_waitcnt vmcnt(13)
    s_barrier
    s_lshl_b32 s70, s2, 2
    s_add_u32 s70, s70, s48
    s_mul_i32 s71, s70, 1664
    s_lshl_b32 s70, s70, 9
    s_add_u32 s72, s71, 1596
    s_buffer_load_dwordx2 s[78:79], s[20:23], s72
    s_add_u32 s72, s70, 60
    s_buffer_load_dwordx2 s[78:79], s[24:27], s72
    s_add_u32 s72, s70, 188
    s_buffer_load_dwordx2 s[78:79], s[24:27], s72
    s_add_u32 s72, s70, 316
    s_buffer_load_dwordx2 s[78:79], s[24:27], s72
    s_add_u32 s72, s70, 444
    s_buffer_load_dwordx2 s[78:79], s[24:27], s72
    s_lshl_b32 s56, s48, 12
    s_add_u32 s56, s56, 119040
    s_sub_u32 s70, s56, s60
    v_xor_b32 v20, 0, v6
    v_add_u32 v24, s70, v20
    v_xor_b32 v21, 32, v6
    v_add_u32 v25, s70, v21
    v_xor_b32 v22, 64, v6
    v_add_u32 v26, s70, v22
    v_xor_b32 v23, 96, v6
    v_add_u32 v27, s70, v23
    s_and_b32 s70, s65, 0
    s_xor_b32 s70, s70, 0
    s_lshl_b32 s71, s48, 4
    s_add_u32 s70, s70, s71
    s_mul_i32 s68, s70, 14336
    s_add_u32 m0, s60, 32768
    s_nop 0
    buffer_load_dwordx4 v4, s[20:23], s68 offen lds
    s_add_u32 m0, s60, 33792
    s_add_u32 s68, s68, 7168
    buffer_load_dwordx4 v4, s[20:23], s68 offen lds
    s_add_u32 m0, s60, 34816
    s_add_u32 s68, s68, 50176
    buffer_load_dwordx4 v4, s[20:23], s68 offen lds
    s_add_u32 m0, s60, 35840
    s_add_u32 s68, s68, 7168
    buffer_load_dwordx4 v4, s[20:23], s68 offen lds
    s_and_b32 s70, s65, 0
    s_xor_b32 s70, s70, 0
    s_lshl_b32 s71, s48, 4
    s_add_u32 s70, s70, s71
    s_mul_i32 s68, s70, 14336
    s_add_u32 s68, s68, 114688
    s_add_u32 m0, s60, 36864
    s_nop 0
    buffer_load_dwordx4 v4, s[20:23], s68 offen lds
    s_add_u32 m0, s60, 37888
    s_add_u32 s68, s68, 7168
    buffer_load_dwordx4 v4, s[20:23], s68 offen lds
    s_add_u32 m0, s60, 38912
    s_add_u32 s68, s68, 50176
    buffer_load_dwordx4 v4, s[20:23], s68 offen lds
    s_add_u32 m0, s60, 39936
    s_add_u32 s68, s68, 7168
    buffer_load_dwordx4 v4, s[20:23], s68 offen lds
    s_waitcnt vmcnt(8)
    s_barrier
    s_mov_b64 exec, 1
    buffer_load_dword v28, v1, s[44:47], 0 offen
    s_mov_b64 exec, -1
    s_lshl_b32 s74, s67, 2
    s_add_u32 s74, s74, s48
    s_lshl_b32 s74, s74, 9
    s_add_u32 s74, s74, 10551296
    s_add_u32 s16, s28, s74
    s_addc_u32 s17, s29, 0
    s_mul_i32 s68, s48, 172032
    s_add_u32 s68, s68, 917504
    s_add_u32 m0, s56, 0
    s_nop 0
    buffer_load_dwordx4 v4, s[20:23], s68 offen lds
    s_add_u32 m0, s56, 1024
    s_add_u32 s68, s68, 7168
    buffer_load_dwordx4 v4, s[20:23], s68 offen lds
    s_add_u32 m0, s56, 2048
    s_add_u32 s68, s68, 35840
    buffer_load_dwordx4 v4, s[20:23], s68 offen lds
    s_add_u32 m0, s56, 3072
    s_add_u32 s68, s68, 7168
    buffer_load_dwordx4 v4, s[20:23], s68 offen lds
    s_mul_i32 s68, s48, 172032
    s_add_u32 s68, s68, 1003520
    s_add_u32 m0, s56, 20736
    s_nop 0
    buffer_load_dwordx4 v4, s[20:23], s68 offen lds
    s_add_u32 m0, s56, 21760
    s_add_u32 s68, s68, 7168
    buffer_load_dwordx4 v4, s[20:23], s68 offen lds
    s_add_u32 m0, s56, 22784
    s_add_u32 s68, s68, 35840
    buffer_load_dwordx4 v4, s[20:23], s68 offen lds
    s_add_u32 m0, s56, 23808
    s_add_u32 s68, s68, 7168
    buffer_load_dwordx4 v4, s[20:23], s68 offen lds
    s_waitcnt vmcnt(13)
    ds_read_b64_tr_b16 v[96:97], v20 offset:32768
    ds_read_b64_tr_b16 v[98:99], v20 offset:33792
    ds_read_b64_tr_b16 v[100:101], v21 offset:32768
    ds_read_b64_tr_b16 v[102:103], v21 offset:33792
    ds_read_b64_tr_b16 v[104:105], v22 offset:32768
    ds_read_b64_tr_b16 v[106:107], v22 offset:33792
    ds_read_b64_tr_b16 v[108:109], v23 offset:32768
    ds_read_b64_tr_b16 v[110:111], v23 offset:33792
    s_waitcnt lgkmcnt(0)
    s_and_b32 s70, s65, 0
    s_xor_b32 s70, s70, 1
    s_lshl_b32 s71, s48, 4
    s_add_u32 s70, s70, s71
    s_mul_i32 s68, s70, 14336
    s_add_u32 m0, s60, 32768
    s_nop 0
    buffer_load_dwordx4 v4, s[20:23], s68 offen lds
    s_add_u32 m0, s60, 33792
    s_add_u32 s68, s68, 7168
    buffer_load_dwordx4 v4, s[20:23], s68 offen lds
    s_add_u32 m0, s60, 34816
    s_add_u32 s68, s68, 50176
    buffer_load_dwordx4 v4, s[20:23], s68 offen lds
    s_add_u32 m0, s60, 35840
    s_add_u32 s68, s68, 7168
    buffer_load_dwordx4 v4, s[20:23], s68 offen lds
    s_waitcnt vmcnt(13)
    ds_read_b64_tr_b16 v[112:113], v20 offset:36864
    ds_read_b64_tr_b16 v[114:115], v20 offset:37888
    ds_read_b64_tr_b16 v[116:117], v21 offset:36864
    ds_read_b64_tr_b16 v[118:119], v21 offset:37888
    ds_read_b64_tr_b16 v[120:121], v22 offset:36864
    ds_read_b64_tr_b16 v[122:123], v22 offset:37888
    ds_read_b64_tr_b16 v[124:125], v23 offset:36864
    ds_read_b64_tr_b16 v[126:127], v23 offset:37888
    s_waitcnt lgkmcnt(0)
    s_and_b32 s70, s65, 0
    s_xor_b32 s70, s70, 1
    s_lshl_b32 s71, s48, 4
    s_add_u32 s70, s70, s71
    s_mul_i32 s68, s70, 14336
    s_add_u32 s68, s68, 114688
    s_add_u32 m0, s60, 36864
    s_nop 0
    buffer_load_dwordx4 v4, s[20:23], s68 offen lds
    s_add_u32 m0, s60, 37888
    s_add_u32 s68, s68, 7168
    buffer_load_dwordx4 v4, s[20:23], s68 offen lds
    s_add_u32 m0, s60, 38912
    s_add_u32 s68, s68, 50176
    buffer_load_dwordx4 v4, s[20:23], s68 offen lds
    s_add_u32 m0, s60, 39936
    s_add_u32 s68, s68, 7168
    buffer_load_dwordx4 v4, s[20:23], s68 offen lds
    s_waitcnt vmcnt(12)
    ds_read_b64_tr_b16 v[224:225], v24 offset:0
    ds_read_b64_tr_b16 v[226:227], v24 offset:1024
    ds_read_b64_tr_b16 v[228:229], v25 offset:0
    ds_read_b64_tr_b16 v[230:231], v25 offset:1024
    ds_read_b64_tr_b16 v[232:233], v26 offset:0
    ds_read_b64_tr_b16 v[234:235], v26 offset:1024
    ds_read_b64_tr_b16 v[236:237], v27 offset:0
    ds_read_b64_tr_b16 v[238:239], v27 offset:1024
    s_waitcnt lgkmcnt(0)
    s_and_b32 s70, s65, 0
    s_xor_b32 s70, s70, 2
    s_lshl_b32 s71, s48, 4
    s_add_u32 s70, s70, s71
    s_mul_i32 s68, s70, 14336
    s_add_u32 m0, s56, 0
    s_nop 0
    buffer_load_dwordx4 v4, s[20:23], s68 offen lds
    s_add_u32 m0, s56, 1024
    s_add_u32 s68, s68, 7168
    buffer_load_dwordx4 v4, s[20:23], s68 offen lds
    s_add_u32 m0, s56, 2048
    s_add_u32 s68, s68, 50176
    buffer_load_dwordx4 v4, s[20:23], s68 offen lds
    s_add_u32 m0, s56, 3072
    s_add_u32 s68, s68, 7168
    buffer_load_dwordx4 v4, s[20:23], s68 offen lds
    s_waitcnt vmcnt(12)
    ds_read_b64_tr_b16 v[240:241], v24 offset:20736
    ds_read_b64_tr_b16 v[242:243], v24 offset:21760
    ds_read_b64_tr_b16 v[244:245], v25 offset:20736
    ds_read_b64_tr_b16 v[246:247], v25 offset:21760
    ds_read_b64_tr_b16 v[248:249], v26 offset:20736
    ds_read_b64_tr_b16 v[250:251], v26 offset:21760
    ds_read_b64_tr_b16 v[252:253], v27 offset:20736
    ds_read_b64_tr_b16 v[254:255], v27 offset:21760
    s_waitcnt lgkmcnt(0)
    s_and_b32 s70, s65, 0
    s_xor_b32 s70, s70, 2
    s_lshl_b32 s71, s48, 4
    s_add_u32 s70, s70, s71
    s_mul_i32 s68, s70, 14336
    s_add_u32 s68, s68, 114688
    s_add_u32 m0, s56, 20736
    s_nop 0
    buffer_load_dwordx4 v4, s[20:23], s68 offen lds
    s_add_u32 m0, s56, 21760
    s_add_u32 s68, s68, 7168
    buffer_load_dwordx4 v4, s[20:23], s68 offen lds
    s_add_u32 m0, s56, 22784
    s_add_u32 s68, s68, 50176
    buffer_load_dwordx4 v4, s[20:23], s68 offen lds
    s_add_u32 m0, s56, 23808
    s_add_u32 s68, s68, 7168
    buffer_load_dwordx4 v4, s[20:23], s68 offen lds
    s_waitcnt vmcnt(12)
    ds_read_b64_tr_b16 v[128:129], v20 offset:32768
    ds_read_b64_tr_b16 v[130:131], v20 offset:33792
    ds_read_b64_tr_b16 v[132:133], v21 offset:32768
    ds_read_b64_tr_b16 v[134:135], v21 offset:33792
    ds_read_b64_tr_b16 v[136:137], v22 offset:32768
    ds_read_b64_tr_b16 v[138:139], v22 offset:33792
    ds_read_b64_tr_b16 v[140:141], v23 offset:32768
    ds_read_b64_tr_b16 v[142:143], v23 offset:33792
    s_waitcnt lgkmcnt(0)
    s_and_b32 s70, s65, 0
    s_xor_b32 s70, s70, 3
    s_lshl_b32 s71, s48, 4
    s_add_u32 s70, s70, s71
    s_mul_i32 s68, s70, 14336
    s_add_u32 m0, s60, 32768
    s_nop 0
    buffer_load_dwordx4 v4, s[20:23], s68 offen lds
    s_add_u32 m0, s60, 33792
    s_add_u32 s68, s68, 7168
    buffer_load_dwordx4 v4, s[20:23], s68 offen lds
    s_add_u32 m0, s60, 34816
    s_add_u32 s68, s68, 50176
    buffer_load_dwordx4 v4, s[20:23], s68 offen lds
    s_add_u32 m0, s60, 35840
    s_add_u32 s68, s68, 7168
    buffer_load_dwordx4 v4, s[20:23], s68 offen lds
    s_waitcnt vmcnt(12)
    ds_read_b64_tr_b16 v[144:145], v20 offset:36864
    ds_read_b64_tr_b16 v[146:147], v20 offset:37888
    ds_read_b64_tr_b16 v[148:149], v21 offset:36864
    ds_read_b64_tr_b16 v[150:151], v21 offset:37888
    ds_read_b64_tr_b16 v[152:153], v22 offset:36864
    ds_read_b64_tr_b16 v[154:155], v22 offset:37888
    ds_read_b64_tr_b16 v[156:157], v23 offset:36864
    ds_read_b64_tr_b16 v[158:159], v23 offset:37888
    s_waitcnt lgkmcnt(0)
    s_and_b32 s70, s65, 0
    s_xor_b32 s70, s70, 3
    s_lshl_b32 s71, s48, 4
    s_add_u32 s70, s70, s71
    s_mul_i32 s68, s70, 14336
    s_add_u32 s68, s68, 114688
    s_add_u32 m0, s60, 36864
    s_nop 0
    buffer_load_dwordx4 v4, s[20:23], s68 offen lds
    s_add_u32 m0, s60, 37888
    s_add_u32 s68, s68, 7168
    buffer_load_dwordx4 v4, s[20:23], s68 offen lds
    s_add_u32 m0, s60, 38912
    s_add_u32 s68, s68, 50176
    buffer_load_dwordx4 v4, s[20:23], s68 offen lds
    s_add_u32 m0, s60, 39936
    s_add_u32 s68, s68, 7168
    buffer_load_dwordx4 v4, s[20:23], s68 offen lds
    s_waitcnt vmcnt(12)
    ds_read_b64_tr_b16 v[160:161], v24 offset:0
    ds_read_b64_tr_b16 v[162:163], v24 offset:1024
    ds_read_b64_tr_b16 v[164:165], v25 offset:0
    ds_read_b64_tr_b16 v[166:167], v25 offset:1024
    ds_read_b64_tr_b16 v[168:169], v26 offset:0
    ds_read_b64_tr_b16 v[170:171], v26 offset:1024
    ds_read_b64_tr_b16 v[172:173], v27 offset:0
    ds_read_b64_tr_b16 v[174:175], v27 offset:1024
    s_waitcnt lgkmcnt(0)
    s_brev_b32 s70, s65
    s_lshr_b32 s70, s70, 29
    s_lshl_b32 s71, s48, 1
    s_xor_b32 s70, s70, s71
    s_xor_b32 s70, s70, 0
    s_mul_i32 s68, s70, 50176
    s_add_u32 m0, s56, 0
    s_nop 0
    buffer_load_dwordx4 v7, s[24:27], s68 offen lds
    s_add_u32 m0, s56, 1024
    s_add_u32 s68, s68, 3584
    buffer_load_dwordx4 v8, s[24:27], s68 offen lds
    s_add_u32 m0, s56, 2048
    s_add_u32 s68, s68, 8960
    buffer_load_dwordx4 v7, s[24:27], s68 offen lds
    s_add_u32 m0, s56, 3072
    s_add_u32 s68, s68, 3584
    buffer_load_dwordx4 v8, s[24:27], s68 offen lds
    s_waitcnt vmcnt(12)
    ds_read_b64_tr_b16 v[176:177], v24 offset:20736
    ds_read_b64_tr_b16 v[178:179], v24 offset:21760
    ds_read_b64_tr_b16 v[180:181], v25 offset:20736
    ds_read_b64_tr_b16 v[182:183], v25 offset:21760
    ds_read_b64_tr_b16 v[184:185], v26 offset:20736
    ds_read_b64_tr_b16 v[186:187], v26 offset:21760
    ds_read_b64_tr_b16 v[188:189], v27 offset:20736
    ds_read_b64_tr_b16 v[190:191], v27 offset:21760
    s_waitcnt lgkmcnt(0)
    s_brev_b32 s70, s65
    s_lshr_b32 s70, s70, 29
    s_lshl_b32 s71, s48, 1
    s_xor_b32 s70, s70, s71
    s_xor_b32 s70, s70, 0
    s_mul_i32 s68, s70, 50176
    s_add_u32 s68, s68, 25088
    s_add_u32 m0, s56, 20736
    s_nop 0
    buffer_load_dwordx4 v7, s[24:27], s68 offen lds
    s_add_u32 m0, s56, 21760
    s_add_u32 s68, s68, 3584
    buffer_load_dwordx4 v8, s[24:27], s68 offen lds
    s_add_u32 m0, s56, 22784
    s_add_u32 s68, s68, 8960
    buffer_load_dwordx4 v7, s[24:27], s68 offen lds
    s_add_u32 m0, s56, 23808
    s_add_u32 s68, s68, 3584
    buffer_load_dwordx4 v8, s[24:27], s68 offen lds
    s_waitcnt vmcnt(12)
    ds_read_b64_tr_b16 v[192:193], v20 offset:32768
    ds_read_b64_tr_b16 v[194:195], v20 offset:33792
    ds_read_b64_tr_b16 v[196:197], v21 offset:32768
    ds_read_b64_tr_b16 v[198:199], v21 offset:33792
    ds_read_b64_tr_b16 v[200:201], v22 offset:32768
    ds_read_b64_tr_b16 v[202:203], v22 offset:33792
    ds_read_b64_tr_b16 v[204:205], v23 offset:32768
    ds_read_b64_tr_b16 v[206:207], v23 offset:33792
    s_waitcnt lgkmcnt(0)
    s_brev_b32 s70, s65
    s_lshr_b32 s70, s70, 29
    s_lshl_b32 s71, s48, 1
    s_xor_b32 s70, s70, s71
    s_xor_b32 s70, s70, 1
    s_mul_i32 s68, s70, 50176
    s_add_u32 m0, s60, 32768
    s_nop 0
    buffer_load_dwordx4 v7, s[24:27], s68 offen lds
    s_add_u32 m0, s60, 33792
    s_add_u32 s68, s68, 3584
    buffer_load_dwordx4 v8, s[24:27], s68 offen lds
    s_add_u32 m0, s60, 34816
    s_add_u32 s68, s68, 8960
    buffer_load_dwordx4 v7, s[24:27], s68 offen lds
    s_add_u32 m0, s60, 35840
    s_add_u32 s68, s68, 3584
    buffer_load_dwordx4 v8, s[24:27], s68 offen lds
    s_waitcnt vmcnt(12)
    ds_read_b64_tr_b16 v[208:209], v20 offset:36864
    ds_read_b64_tr_b16 v[210:211], v20 offset:37888
    ds_read_b64_tr_b16 v[212:213], v21 offset:36864
    ds_read_b64_tr_b16 v[214:215], v21 offset:37888
    ds_read_b64_tr_b16 v[216:217], v22 offset:36864
    ds_read_b64_tr_b16 v[218:219], v22 offset:37888
    ds_read_b64_tr_b16 v[220:221], v23 offset:36864
    ds_read_b64_tr_b16 v[222:223], v23 offset:37888
    s_waitcnt lgkmcnt(0)
    s_brev_b32 s70, s65
    s_lshr_b32 s70, s70, 29
    s_lshl_b32 s71, s48, 1
    s_xor_b32 s70, s70, s71
    s_xor_b32 s70, s70, 1
    s_mul_i32 s68, s70, 50176
    s_add_u32 s68, s68, 25088
    s_add_u32 m0, s60, 36864
    s_nop 0
    buffer_load_dwordx4 v7, s[24:27], s68 offen lds
    s_add_u32 m0, s60, 37888
    s_add_u32 s68, s68, 3584
    buffer_load_dwordx4 v8, s[24:27], s68 offen lds
    s_add_u32 m0, s60, 38912
    s_add_u32 s68, s68, 8960
    buffer_load_dwordx4 v7, s[24:27], s68 offen lds
    s_add_u32 m0, s60, 39936
    s_add_u32 s68, s68, 3584
    buffer_load_dwordx4 v8, s[24:27], s68 offen lds
    s_mov_b32 s3, 200000
    s_branch L_6
L_5:
    s_mov_b64 exec, 1
    buffer_load_dword v28, v1, s[44:47], 0 offen sc1
    s_mov_b64 exec, -1
    s_sub_u32 s3, s3, 1
    s_waitcnt vmcnt(0)
    s_cbranch_scc1 L_7
L_6:
    v_readfirstlane_b32 s0, v28
    s_nop 0
    s_cmp_eq_u32 s0, 0
    s_cbranch_scc1 L_5
L_7:
    s_not_b32 s1, s0
    s_mov_b32 s3, 200000
L_8:
    ds_read_b32 v2, v5 offset:4
    s_sub_u32 s3, s3, 1
    s_waitcnt lgkmcnt(0)
    s_cbranch_scc1 L_9
    v_cmp_gt_u32 vcc, 4, v2
    s_nop 0
    s_cbranch_vccnz L_8
L_9:
    s_mul_i32 s68, s48, 172032
    s_add_u32 s68, s68, 931840
    s_add_u32 m0, s60, 0
    s_nop 0
    buffer_load_dwordx4 v4, s[20:23], s68 offen lds
    s_add_u32 m0, s60, 1024
    s_add_u32 s68, s68, 7168
    buffer_load_dwordx4 v4, s[20:23], s68 offen lds
    s_add_u32 m0, s60, 2048
    s_add_u32 s68, s68, 35840
    buffer_load_dwordx4 v4, s[20:23], s68 offen lds
    s_add_u32 m0, s60, 3072
    s_add_u32 s68, s68, 7168
    buffer_load_dwordx4 v4, s[20:23], s68 offen lds
    s_mul_i32 s68, s48, 172032
    s_add_u32 s68, s68, 1017856
    s_add_u32 m0, s60, 4096
    s_nop 0
    buffer_load_dwordx4 v4, s[20:23], s68 offen lds
    s_add_u32 m0, s60, 5120
    s_add_u32 s68, s68, 7168
    buffer_load_dwordx4 v4, s[20:23], s68 offen lds
    s_add_u32 m0, s60, 6144
    s_add_u32 s68, s68, 35840
    buffer_load_dwordx4 v4, s[20:23], s68 offen lds
    s_add_u32 m0, s60, 7168
    s_add_u32 s68, s68, 7168
    buffer_load_dwordx4 v4, s[20:23], s68 offen lds
    s_load_dwordx2 s[4:5], s[16:17], 262144 glc
    s_load_dwordx2 s[6:7], s[16:17], 262272 glc
    s_load_dwordx2 s[8:9], s[16:17], 262400 glc
    s_load_dwordx2 s[10:11], s[16:17], 262528 glc
    s_mul_i32 s68, s48, 172032
    s_add_u32 s68, s68, 946176
    s_add_u32 m0, s60, 65536
    s_nop 0
    buffer_load_dwordx4 v4, s[20:23], s68 offen lds
    s_add_u32 m0, s60, 66560
    s_add_u32 s68, s68, 7168
    buffer_load_dwordx4 v4, s[20:23], s68 offen lds
    s_add_u32 m0, s60, 67584
    s_add_u32 s68, s68, 35840
    buffer_load_dwordx4 v4, s[20:23], s68 offen lds
    s_add_u32 m0, s60, 68608
    s_add_u32 s68, s68, 7168
    buffer_load_dwordx4 v4, s[20:23], s68 offen lds
    s_mul_i32 s68, s48, 172032
    s_add_u32 s68, s68, 1032192
    s_add_u32 m0, s60, 69632
    s_nop 0
    buffer_load_dwordx4 v4, s[20:23], s68 offen lds
    s_add_u32 m0, s60, 70656
    s_add_u32 s68, s68, 7168
    buffer_load_dwordx4 v4, s[20:23], s68 offen lds
    s_add_u32 m0, s60, 71680
    s_add_u32 s68, s68, 35840
    buffer_load_dwordx4 v4, s[20:23], s68 offen lds
    s_add_u32 m0, s60, 72704
    s_add_u32 s68, s68, 7168
    buffer_load_dwordx4 v4, s[20:23], s68 offen lds
    s_branch L_ltail
L_loadA:
    s_mov_b32 s22, 1605632
    s_mov_b32 s23, 0x20000
    s_mov_b32 s26, 401408
    s_mov_b32 s27, 0x20000
    s_mov_b32 s30, 11075712
    s_mov_b32 s31, 0x20000
    s_mov_b32 s34, 1835008
    s_mov_b32 s35, 0x20000
    s_mov_b32 s38, 25088
    s_mov_b32 s39, 0x20000
    s_mov_b32 s46, 256
    s_mov_b32 s47, 0x20000
    s_waitcnt lgkmcnt(0)
    v_lshlrev_b32 v1, 4, v0
    s_lshl_b32 s67, s49, 2
    s_add_u32 s67, s67, s50
    s_add_u32 s65, s51, s50
    s_lshl_b32 s66, s51, 7
    s_mul_i32 s77, s67, 294912
    v_mov_b32 v5, 163712
    v_mul_u32_u24 v40, 896, v30
    v_bfe_u32 v41, v30, 2, 1
    v_and_b32 v42, 2, v30
    v_add_lshl_u32 v42, v42, v41, 1
    v_xor_b32 v42, v42, v31
    v_lshl_add_u32 v40, v42, 4, v40
    v_add_u32 v4, s66, v40
    v_lshrrev_b32 v42, 5, v0
    v_mul_u32_u24 v42, 2688, v42
    v_add_u32 v7, v4, v42
    v_and_b32 v42, 3, v30
    v_cmp_eq_u32 vcc, 3, v42
    v_mov_b32 v42, 0x10000000
    s_nop 0
    v_cndmask_b32 v8, v7, v42, vcc
    v_bfe_u32 v40, v0, 2, 3
    v_lshrrev_b32 v42, 5, v0
    v_lshl_add_u32 v40, v42, 4, v40
    v_bfe_u32 v42, v40, 2, 1
    v_and_b32 v41, 2, v40
    v_add_lshl_u32 v41, v41, v42, 1
    v_lshl_add_u32 v40, v40, 7, s60
    v_lshl_add_u32 v40, v41, 4, v40
    v_and_b32 v42, 3, v0
    v_lshl_add_u32 v6, v42, 3, v40
    v_mul_u32_u24 v40, 52, v0
    v_lshrrev_b32 v40, 8, v40
    v_mul_u32_u24 v41, 5, v40
    v_sub_u32 v41, v0, v41
    v_lshlrev_b32 v41, 4, v41
    v_min_u32 v41, 52, v41
    v_lshl_add_u32 v40, s48, 3, v40
    v_cmp_lt_u32 vcc, 27, v40
    v_mul_u32_u24 v40, 56, v40
    s_mul_i32 s70, s54, 1568
    v_add3_u32 v40, v40, v41, s70
    v_mov_b32 v41, 0x10000000
    v_cndmask_b32 v40, v40, v41, vcc
    s_mul_i32 s70, s48, 640
    s_add_u32 m0, s70, 161152
    s_lshr_b64 exec, -1, 24
    buffer_load_dwordx4 v40, s[36:39], 0 offen lds
    s_mov_b64 exec, -1
    s_bitcmp1_b32 s48, 0
    s_cselect_b32 s40, s16, s12
    s_cselect_b32 s41, s17, s13
    s_cselect_b32 s42, s18, s14
    s_cmp_ge_u32 s48, 2
    s_cselect_b32 s40, s8, s40
    s_cselect_b32 s41, s9, s41
    s_cselect_b32 s42, s10, s42
    s_mov_b32 s74, 3584
    s_cmov_b32 s74, 2688
    s_mov_b32 s71, 512
    s_cmov_b32 s71, 224
    s_mov_b32 s72, 384
    s_cmov_b32 s72, 224
    s_mov_b32 s73, 2048
    s_cmov_b32 s73, 896
    s_mul_i32 s63, s71, s52
    s_mul_i32 s64, s72, s52
    s_add_u32 s64, s64, s73
    s_cmp_eq_u32 s48, 3
    s_cselect_b32 s71, 1792, 0
    s_add_u32 s63, s63, s71
    s_lshr_b32 s71, s2, 3
    s_and_b32 s72, s2, 1
    s_lshl_b32 s72, s72, 5
    s_add_u32 s71, s71, s72
    s_mul_i32 s71, s71, s74
    s_and_b32 s63, s63, 0xffffff80
    s_add_u32 s63, s63, s71
    s_and_b32 s64, s64, 0xffffff80
    s_add_u32 s64, s64, s71
    s_lshl_b32 s69, s74, 6
    s_or_b32 s71, s49, 1
    s_add_u32 s71, s71, 2
    s_sub_u32 s72, s71, 7
    s_min_u32 s71, s71, s72
    s_mul_i32 s71, s71, s69
    s_add_u32 s72, s71, s64
    s_add_u32 s71, s71, s63
    s_buffer_load_dwordx2 s[78:79], s[40:43], s71 offset:60
    s_buffer_load_dwordx2 s[78:79], s[40:43], s71 offset:188
    s_buffer_load_dwordx2 s[78:79], s[40:43], s71 offset:316
    s_cmp_eq_u32 s48, 3
    s_cbranch_scc1 L_10
    s_buffer_load_dwordx2 s[78:79], s[40:43], s72 offset:60
    s_buffer_load_dwordx2 s[78:79], s[40:43], s72 offset:188
    s_buffer_load_dwordx2 s[78:79], s[40:43], s72 offset:316
    s_cmp_eq_u32 s48, 2
    s_cbranch_scc1 L_10
    s_buffer_load_dwordx2 s[78:79], s[40:43], s71 offset:444
L_10:
    s_lshl_b32 s57, s55, 7
    s_add_u32 s57, s57, s56
    s_mul_i32 s58, s55, 172032
    s_mul_i32 s59, s55, 229376
    s_add_u32 s55, s55, 1
    s_cmp_eq_u32 s55, 7
    s_cselect_b32 s55, 0, s55
    s_add_u32 m0, s60, 32768
    s_nop 0
    buffer_load_dwordx4 v16, s[4:7], s57 offen lds
    s_add_u32 m0, s60, 33792
    s_add_u32 s57, s57, 7168
    buffer_load_dwordx4 v17, s[4:7], s57 offen lds
    s_add_u32 m0, s60, 34816
    s_add_u32 s57, s57, 7168
    buffer_load_dwordx4 v16, s[4:7], s57 offen lds
    s_add_u32 m0, s60, 35840
    s_add_u32 s57, s57, 7168
    buffer_load_dwordx4 v17, s[4:7], s57 offen lds
    s_add_u32 m0, s60, 36864
    s_add_u32 s57, s57, 7168
    buffer_load_dwordx4 v16, s[4:7], s57 offen lds
    s_add_u32 m0, s60, 37888
    s_add_u32 s57, s57, 7168
    buffer_load_dwordx4 v17, s[4:7], s57 offen lds
    s_add_u32 m0, s60, 38912
    s_add_u32 s57, s57, 7168
    buffer_load_dwordx4 v16, s[4:7], s57 offen lds
    s_add_u32 m0, s60, 39936
    s_add_u32 s57, s57, 7168
    buffer_load_dwordx4 v17, s[4:7], s57 offen lds
    s_add_u32 m0, s61, 20736
    s_nop 0
    buffer_load_dwordx4 v10, s[8:11], s58 offen lds
    s_waitcnt vmcnt(10)
    s_barrier
    s_add_u32 m0, s61, 24832
    s_nop 0
    buffer_load_dwordx4 v11, s[8:11], s58 offen lds
    s_add_u32 m0, s62, 20736
    s_nop 0
    buffer_load_dwordx4 v12, s[12:15], s59 offen lds
    s_add_u32 m0, s62, 21760
    s_nop 0
    buffer_load_dwordx4 v13, s[12:15], s59 offen lds
    s_add_u32 m0, s62, 22784
    s_nop 0
    buffer_load_dwordx4 v14, s[12:15], s59 offen lds
    s_lshl_b32 s57, s55, 7
    s_add_u32 s57, s57, s56
    s_mul_i32 s58, s55, 172032
    s_mul_i32 s59, s55, 229376
    s_add_u32 s55, s55, 1
    s_cmp_eq_u32 s55, 7
    s_cselect_b32 s55, 0, s55
    s_add_u32 m0, s60, 65536
    s_nop 0
    buffer_load_dwordx4 v16, s[4:7], s57 offen lds
    s_add_u32 m0, s60, 66560
    s_add_u32 s57, s57, 7168
    buffer_load_dwordx4 v17, s[4:7], s57 offen lds
    s_add_u32 m0, s60, 67584
    s_add_u32 s57, s57, 7168
    buffer_load_dwordx4 v16, s[4:7], s57 offen lds
    s_add_u32 m0, s60, 68608
    s_add_u32 s57, s57, 7168
    buffer_load_dwordx4 v17, s[4:7], s57 offen lds
    s_add_u32 m0, s60, 69632
    s_add_u32 s57, s57, 7168
    buffer_load_dwordx4 v16, s[4:7], s57 offen lds
    s_add_u32 m0, s60, 70656
    s_add_u32 s57, s57, 7168
    buffer_load_dwordx4 v17, s[4:7], s57 offen lds
    s_add_u32 m0, s60, 71680
    s_add_u32 s57, s57, 7168
    buffer_load_dwordx4 v16, s[4:7], s57 offen lds
    s_add_u32 m0, s60, 72704
    s_add_u32 s57, s57, 7168
    buffer_load_dwordx4 v17, s[4:7], s57 offen lds
    s_add_u32 m0, s61, 41472
    s_nop 0
    buffer_load_dwordx4 v10, s[8:11], s58 offen lds
    s_or_b32 s71, s49, 1
    s_add_u32 s71, s71, 3
    s_sub_u32 s72, s71, 7
    s_min_u32 s71, s71, s72
    s_mul_i32 s71, s71, s69
    s_add_u32 s72, s71, s64
    s_add_u32 s71, s71, s63
    s_buffer_load_dwordx2 s[78:79], s[40:43], s71 offset:60
    s_buffer_load_dwordx2 s[78:79], s[40:43], s71 offset:188
    s_buffer_load_dwordx2 s[78:79], s[40:43], s71 offset:316
    s_cmp_eq_u32 s48, 3
    s_cbranch_scc1 L_11
    s_buffer_load_dwordx2 s[78:79], s[40:43], s72 offset:60
    s_buffer_load_dwordx2 s[78:79], s[40:43], s72 offset:188
    s_buffer_load_dwordx2 s[78:79], s[40:43], s72 offset:316
    s_cmp_eq_u32 s48, 2
    s_cbranch_scc1 L_11
    s_buffer_load_dwordx2 s[78:79], s[40:43], s71 offset:444
L_11:
    s_waitcnt vmcnt(9)
    s_barrier
    s_add_u32 m0, s61, 45568
    s_nop 0
    buffer_load_dwordx4 v11, s[8:11], s58 offen lds
    s_add_u32 m0, s62, 41472
    s_nop 0
    buffer_load_dwordx4 v12, s[12:15], s59 offen lds
    s_add_u32 m0, s62, 42496
    s_nop 0
    buffer_load_dwordx4 v13, s[12:15], s59 offen lds
    s_add_u32 m0, s62, 43520
    s_nop 0
    buffer_load_dwordx4 v14, s[12:15], s59 offen lds
    s_lshl_b32 s57, s55, 7
    s_add_u32 s57, s57, s56
    s_mul_i32 s58, s55, 172032
    s_mul_i32 s59, s55, 229376
    s_add_u32 s55, s55, 1
    s_cmp_eq_u32 s55, 7
    s_cselect_b32 s55, 0, s55
    s_add_u32 m0, s60, 0
    s_nop 0
    buffer_load_dwordx4 v16, s[4:7], s57 offen lds
    s_add_u32 m0, s60, 1024
    s_add_u32 s57, s57, 7168
    buffer_load_dwordx4 v17, s[4:7], s57 offen lds
    s_add_u32 m0, s60, 2048
    s_add_u32 s57, s57, 7168
    buffer_load_dwordx4 v16, s[4:7], s57 offen lds
    s_add_u32 m0, s60, 3072
    s_add_u32 s57, s57, 7168
    buffer_load_dwordx4 v17, s[4:7], s57 offen lds
    s_add_u32 m0, s60, 4096
    s_add_u32 s57, s57, 7168
    buffer_load_dwordx4 v16, s[4:7], s57 offen lds
    s_add_u32 m0, s60, 5120
    s_add_u32 s57, s57, 7168
    buffer_load_dwordx4 v17, s[4:7], s57 offen lds
    s_add_u32 m0, s60, 6144
    s_add_u32 s57, s57, 7168
    buffer_load_dwordx4 v16, s[4:7], s57 offen lds
    s_add_u32 m0, s60, 7168
    s_add_u32 s57, s57, 7168
    buffer_load_dwordx4 v17, s[4:7], s57 offen lds
    s_add_u32 m0, s61, 0
    s_nop 0
    buffer_load_dwordx4 v10, s[8:11], s58 offen lds
    s_or_b32 s71, s49, 1
    s_add_u32 s71, s71, 4
    s_sub_u32 s72, s71, 7
    s_min_u32 s71, s71, s72
    s_mul_i32 s71, s71, s69
    s_add_u32 s72, s71, s64
    s_add_u32 s71, s71, s63
    s_buffer_load_dwordx2 s[78:79], s[40:43], s71 offset:60
    s_buffer_load_dwordx2 s[78:79], s[40:43], s71 offset:188
    s_buffer_load_dwordx2 s[78:79], s[40:43], s71 offset:316
    s_cmp_eq_u32 s48, 3
    s_cbranch_scc1 L_12
    s_buffer_load_dwordx2 s[78:79], s[40:43], s72 offset:60
    s_buffer_load_dwordx2 s[78:79], s[40:43], s72 offset:188
    s_buffer_load_dwordx2 s[78:79], s[40:43], s72 offset:316
    s_cmp_eq_u32 s48, 2
    s_cbranch_scc1 L_12
    s_buffer_load_dwordx2 s[78:79], s[40:43], s71 offset:444
L_12:
    s_waitcnt vmcnt(9)
    s_barrier
    s_add_u32 m0, s61, 4096
    s_nop 0
    buffer_load_dwordx4 v11, s[8:11], s58 offen lds
    s_add_u32 m0, s62, 0
    s_nop 0
    buffer_load_dwordx4 v12, s[12:15], s59 offen lds
    s_add_u32 m0, s62, 1024
    s_nop 0
    buffer_load_dwordx4 v13, s[12:15], s59 offen lds
    s_add_u32 m0, s62, 2048
    s_nop 0
    buffer_load_dwordx4 v14, s[12:15], s59 offen lds
    s_lshl_b32 s57, s55, 7
    s_add_u32 s57, s57, s56
    s_mul_i32 s58, s55, 172032
    s_mul_i32 s59, s55, 229376
    s_add_u32 s55, s55, 1
    s_cmp_eq_u32 s55, 7
    s_cselect_b32 s55, 0, s55
    s_add_u32 m0, s60, 32768
    s_nop 0
    buffer_load_dwordx4 v16, s[4:7], s57 offen lds
    s_add_u32 m0, s60, 33792
    s_add_u32 s57, s57, 7168
    buffer_load_dwordx4 v17, s[4:7], s57 offen lds
    s_add_u32 m0, s60, 34816
    s_add_u32 s57, s57, 7168
    buffer_load_dwordx4 v16, s[4:7], s57 offen lds
    s_add_u32 m0, s60, 35840
    s_add_u32 s57, s57, 7168
    buffer_load_dwordx4 v17, s[4:7], s57 offen lds
    s_add_u32 m0, s60, 36864
    s_add_u32 s57, s57, 7168
    buffer_load_dwordx4 v16, s[4:7], s57 offen lds
    s_add_u32 m0, s60, 37888
    s_add_u32 s57, s57, 7168
    buffer_load_dwordx4 v17, s[4:7], s57 offen lds
    s_add_u32 m0, s60, 38912
    s_add_u32 s57, s57, 7168
    buffer_load_dwordx4 v16, s[4:7], s57 offen lds
    s_add_u32 m0, s60, 39936
    s_add_u32 s57, s57, 7168
    buffer_load_dwordx4 v17, s[4:7], s57 offen lds
    s_add_u32 m0, s61, 20736
    s_nop 0
    buffer_load_dwordx4 v10, s[8:11], s58 offen lds
    s_or_b32 s71, s49, 1
    s_add_u32 s71, s71, 5
    s_sub_u32 s72, s71, 7
    s_min_u32 s71, s71, s72
    s_mul_i32 s71, s71, s69
    s_add_u32 s72, s71, s64
    s_add_u32 s71, s71, s63
    s_buffer_load_dwordx2 s[78:79], s[40:43], s71 offset:60
    s_buffer_load_dwordx2 s[78:79], s[40:43], s71 offset:188
    s_buffer_load_dwordx2 s[78:79], s[40:43], s71 offset:316
    s_cmp_eq_u32 s48, 3
    s_cbranch_scc1 L_13
    s_buffer_load_dwordx2 s[78:79], s[40:43], s72 offset:60
    s_buffer_load_dwordx2 s[78:79], s[40:43], s72 offset:188
    s_buffer_load_dwordx2 s[78:79], s[40:43], s72 offset:316
    s_cmp_eq_u32 s48, 2
    s_cbranch_scc1 L_13
    s_buffer_load_dwordx2 s[78:79], s[40:43], s71 offset:444
L_13:
    s_waitcnt vmcnt(9)
    s_barrier
    s_add_u32 m0, s61, 24832
    s_nop 0
    buffer_load_dwordx4 v11, s[8:11], s58 offen lds
    s_add_u32 m0, s62, 20736
    s_nop 0
    buffer_load_dwordx4 v12, s[12:15], s59 offen lds
    s_add_u32 m0, s62, 21760
    s_nop 0
    buffer_load_dwordx4 v13, s[12:15], s59 offen lds
    s_add_u32 m0, s62, 22784
    s_nop 0
    buffer_load_dwordx4 v14, s[12:15], s59 offen lds
    s_lshl_b32 s57, s55, 7
    s_add_u32 s57, s57, s56
    s_mul_i32 s58, s55, 172032
    s_mul_i32 s59, s55, 229376
    s_add_u32 s55, s55, 1
    s_cmp_eq_u32 s55, 7
    s_cselect_b32 s55, 0, s55
    s_add_u32 m0, s60, 65536
    s_nop 0
    buffer_load_dwordx4 v16, s[4:7], s57 offen lds
    s_add_u32 m0, s60, 66560
    s_add_u32 s57, s57, 7168
    buffer_load_dwordx4 v17, s[4:7], s57 offen lds
    s_add_u32 m0, s60, 67584
    s_add_u32 s57, s57, 7168
    buffer_load_dwordx4 v16, s[4:7], s57 offen lds
    s_add_u32 m0, s60, 68608
    s_add_u32 s57, s57, 7168
    buffer_load_dwordx4 v17, s[4:7], s57 offen lds
    s_add_u32 m0, s60, 69632
    s_add_u32 s57, s57, 7168
    buffer_load_dwordx4 v16, s[4:7], s57 offen lds
    s_add_u32 m0, s60, 70656
    s_add_u32 s57, s57, 7168
    buffer_load_dwordx4 v17, s[4:7], s57 offen lds
    s_add_u32 m0, s60, 71680
    s_add_u32 s57, s57, 7168
    buffer_load_dwordx4 v16, s[4:7], s57 offen lds
    s_add_u32 m0, s60, 72704
    s_add_u32 s57, s57, 7168
    buffer_load_dwordx4 v17, s[4:7], s57 offen lds
    s_add_u32 m0, s61, 41472
    s_nop 0
    buffer_load_dwordx4 v10, s[8:11], s58 offen lds
    s_lshl_b32 s70, s2, 2
    s_add_u32 s70, s70, s48
    s_mul_i32 s71, s70, 1664
    s_lshl_b32 s70, s70, 9
    s_add_u32 s72, s71, 60
    s_buffer_load_dwordx2 s[78:79], s[20:23], s72
    s_add_u32 s72, s71, 188
    s_buffer_load_dwordx2 s[78:79], s[20:23], s72
    s_add_u32 s72, s71, 316
    s_buffer_load_dwordx2 s[78:79], s[20:23], s72
    s_add_u32 s72, s71, 444
    s_buffer_load_dwordx2 s[78:79], s[20:23], s72
    s_add_u32 s72, s71, 572
    s_buffer_load_dwordx2 s[78:79], s[20:23], s72
    s_add_u32 s72, s71, 700
    s_buffer_load_dwordx2 s[78:79], s[20:23], s72
    s_waitcnt vmcnt(9)
    s_barrier
    s_add_u32 m0, s61, 45568
    s_nop 0
    buffer_load_dwordx4 v11, s[8:11], s58 offen lds
    s_add_u32 m0, s62, 41472
    s_nop 0
    buffer_load_dwordx4 v12, s[12:15], s59 offen lds
    s_add_u32 m0, s62, 42496
    s_nop 0
    buffer_load_dwordx4 v13, s[12:15], s59 offen lds
    s_add_u32 m0, s62, 43520
    s_nop 0
    buffer_load_dwordx4 v14, s[12:15], s59 offen lds
    s_lshl_b32 s57, s55, 7
    s_add_u32 s57, s57, s56
    s_mul_i32 s58, s55, 172032
    s_mul_i32 s59, s55, 229376
    s_add_u32 s55, s55, 1
    s_cmp_eq_u32 s55, 7
    s_cselect_b32 s55, 0, s55
    s_add_u32 m0, s60, 0
    s_nop 0
    buffer_load_dwordx4 v16, s[4:7], s57 offen lds
    s_add_u32 m0, s60, 1024
    s_add_u32 s57, s57, 7168
    buffer_load_dwordx4 v17, s[4:7], s57 offen lds
    s_add_u32 m0, s60, 2048
    s_add_u32 s57, s57, 7168
    buffer_load_dwordx4 v16, s[4:7], s57 offen lds
    s_add_u32 m0, s60, 3072
    s_add_u32 s57, s57, 7168
    buffer_load_dwordx4 v17, s[4:7], s57 offen lds
    s_add_u32 m0, s60, 4096
    s_add_u32 s57, s57, 7168
    buffer_load_dwordx4 v16, s[4:7], s57 offen lds
    s_add_u32 m0, s60, 5120
    s_add_u32 s57, s57, 7168
    buffer_load_dwordx4 v17, s[4:7], s57 offen lds
    s_add_u32 m0, s60, 6144
    s_add_u32 s57, s57, 7168
    buffer_load_dwordx4 v16, s[4:7], s57 offen lds
    s_add_u32 m0, s60, 7168
    s_add_u32 s57, s57, 7168
    buffer_load_dwordx4 v17, s[4:7], s57 offen lds
    s_add_u32 m0, s61, 0
    s_nop 0
    buffer_load_dwordx4 v10, s[8:11], s58 offen lds
    s_lshl_b32 s70, s2, 2
    s_add_u32 s70, s70, s48
    s_mul_i32 s71, s70, 1664
    s_lshl_b32 s70, s70, 9
    s_add_u32 s72, s71, 828
    s_buffer_load_dwordx2 s[78:79], s[20:23], s72
    s_add_u32 s72, s71, 956
    s_buffer_load_dwordx2 s[78:79], s[20:23], s72
    s_add_u32 s72, s71, 1084
    s_buffer_load_dwordx2 s[78:79], s[20:23], s72
    s_add_u32 s72, s71, 1212
    s_buffer_load_dwordx2 s[78:79], s[20:23], s72
    s_add_u32 s72, s71, 1340
    s_buffer_load_dwordx2 s[78:79], s[20:23], s72
    s_add_u32 s72, s71, 1468
    s_buffer_load_dwordx2 s[78:79], s[20:23], s72
    s_waitcnt vmcnt(9)
    s_barrier
    s_add_u32 m0, s61, 4096
    s_nop 0
    buffer_load_dwordx4 v11, s[8:11], s58 offen lds
    s_add_u32 m0, s62, 0
    s_nop 0
    buffer_load_dwordx4 v12, s[12:15], s59 offen lds
    s_add_u32 m0, s62, 1024
    s_nop 0
    buffer_load_dwordx4 v13, s[12:15], s59 offen lds
    s_add_u32 m0, s62, 2048
    s_nop 0
    buffer_load_dwordx4 v14, s[12:15], s59 offen lds
    s_lshl_b32 s70, s2, 2
    s_add_u32 s70, s70, s48
    s_mul_i32 s71, s70, 1664
    s_lshl_b32 s70, s70, 9
    s_add_u32 s72, s71, 1596
    s_buffer_load_dwordx2 s[78:79], s[20:23], s72
    s_add_u32 s72, s70, 60
    s_buffer_load_dwordx2 s[78:79], s[24:27], s72
    s_add_u32 s72, s70, 188
    s_buffer_load_dwordx2 s[78:79], s[24:27], s72
    s_add_u32 s72, s70, 316
    s_buffer_load_dwordx2 s[78:79], s[24:27], s72
    s_add_u32 s72, s70, 444
    s_buffer_load_dwordx2 s[78:79], s[24:27], s72
    s_cmp_eq_u32 s51, 7
    s_cselect_b32 s22, 0, s22
    s_lshl_b32 s56, s48, 12
    s_add_u32 s56, s56, 119040
    s_sub_u32 s70, s56, s60
    v_xor_b32 v20, 0, v6
    v_add_u32 v24, s70, v20
    v_xor_b32 v21, 32, v6
    v_add_u32 v25, s70, v21
    v_xor_b32 v22, 64, v6
    v_add_u32 v26, s70, v22
    v_xor_b32 v23, 96, v6
    v_add_u32 v27, s70, v23
    s_and_b32 s70, s65, 0
    s_xor_b32 s70, s70, 0
    s_lshl_b32 s71, s48, 4
    s_add_u32 s70, s70, s71
    s_mul_i32 s68, s70, 14336
    s_add_u32 m0, s60, 32768
    s_nop 0
    buffer_load_dwordx4 v4, s[20:23], s68 offen lds
    s_add_u32 m0, s60, 33792
    s_add_u32 s68, s68, 7168
    buffer_load_dwordx4 v4, s[20:23], s68 offen lds
    s_add_u32 m0, s60, 34816
    s_add_u32 s68, s68, 50176
    buffer_load_dwordx4 v4, s[20:23], s68 offen lds
    s_add_u32 m0, s60, 35840
    s_add_u32 s68, s68, 7168
    buffer_load_dwordx4 v4, s[20:23], s68 offen lds
    s_and_b32 s70, s65, 0
    s_xor_b32 s70, s70, 0
    s_lshl_b32 s71, s48, 4
    s_add_u32 s70, s70, s71
    s_mul_i32 s68, s70, 14336
    s_add_u32 s68, s68, 114688
    s_add_u32 m0, s60, 36864
    s_nop 0
    buffer_load_dwordx4 v4, s[20:23], s68 offen lds
    s_add_u32 m0, s60, 37888
    s_add_u32 s68, s68, 7168
    buffer_load_dwordx4 v4, s[20:23], s68 offen lds
    s_add_u32 m0, s60, 38912
    s_add_u32 s68, s68, 50176
    buffer_load_dwordx4 v4, s[20:23], s68 offen lds
    s_add_u32 m0, s60, 39936
    s_add_u32 s68, s68, 7168
    buffer_load_dwordx4 v4, s[20:23], s68 offen lds
    s_waitcnt vmcnt(8)
    s_barrier
    s_cmp_eq_u32 s51, 7
    s_cbranch_scc1 L_fin
    s_mov_b64 exec, 1
    buffer_load_dword v28, v1, s[44:47], 0 offen
    s_mov_b64 exec, -1
    s_lshl_b32 s74, s67, 2
    s_add_u32 s74, s74, s48
    s_lshl_b32 s74, s74, 9
    s_add_u32 s74, s74, 10551296
    s_add_u32 s16, s28, s74
    s_addc_u32 s17, s29, 0
    s_mul_i32 s68, s48, 172032
    s_add_u32 s68, s68, 917504
    s_add_u32 m0, s56, 0
    s_nop 0
    buffer_load_dwordx4 v4, s[20:23], s68 offen lds
    s_add_u32 m0, s56, 1024
    s_add_u32 s68, s68, 7168
    buffer_load_dwordx4 v4, s[20:23], s68 offen lds
    s_add_u32 m0, s56, 2048
    s_add_u32 s68, s68, 35840
    buffer_load_dwordx4 v4, s[20:23], s68 offen lds
    s_add_u32 m0, s56, 3072
    s_add_u32 s68, s68, 7168
    buffer_load_dwordx4 v4, s[20:23], s68 offen lds
    s_mul_i32 s68, s48, 172032
    s_add_u32 s68, s68, 1003520
    s_add_u32 m0, s56, 20736
    s_nop 0
    buffer_load_dwordx4 v4, s[20:23], s68 offen lds
    s_add_u32 m0, s56, 21760
    s_add_u32 s68, s68, 7168
    buffer_load_dwordx4 v4, s[20:23], s68 offen lds
    s_add_u32 m0, s56, 22784
    s_add_u32 s68, s68, 35840
    buffer_load_dwordx4 v4, s[20:23], s68 offen lds
    s_add_u32 m0, s56, 23808
    s_add_u32 s68, s68, 7168
    buffer_load_dwordx4 v4, s[20:23], s68 offen lds
    s_waitcnt vmcnt(13)
    ds_read_b64_tr_b16 v[96:97], v20 offset:32768
    ds_read_b64_tr_b16 v[98:99], v20 offset:33792
    ds_read_b64_tr_b16 v[100:101], v21 offset:32768
    ds_read_b64_tr_b16 v[102:103], v21 offset:33792
    ds_read_b64_tr_b16 v[104:105], v22 offset:32768
    ds_read_b64_tr_b16 v[106:107], v22 offset:33792
    ds_read_b64_tr_b16 v[108:109], v23 offset:32768
    ds_read_b64_tr_b16 v[110:111], v23 offset:33792
    s_waitcnt lgkmcnt(0)
    s_and_b32 s70, s65, 0
    s_xor_b32 s70, s70, 1
    s_lshl_b32 s71, s48, 4
    s_add_u32 s70, s70, s71
    s_mul_i32 s68, s70, 14336
    s_add_u32 m0, s60, 32768
    s_nop 0
    buffer_load_dwordx4 v4, s[20:23], s68 offen lds
    s_add_u32 m0, s60, 33792
    s_add_u32 s68, s68, 7168
    buffer_load_dwordx4 v4, s[20:23], s68 offen lds
    s_add_u32 m0, s60, 34816
    s_add_u32 s68, s68, 50176
    buffer_load_dwordx4 v4, s[20:23], s68 offen lds
    s_add_u32 m0, s60, 35840
    s_add_u32 s68, s68, 7168
    buffer_load_dwordx4 v4, s[20:23], s68 offen lds
    s_waitcnt vmcnt(13)
    ds_read_b64_tr_b16 v[112:113], v20 offset:36864
    ds_read_b64_tr_b16 v[114:115], v20 offset:37888
    ds_read_b64_tr_b16 v[116:117], v21 offset:36864
    ds_read_b64_tr_b16 v[118:119], v21 offset:37888
    ds_read_b64_tr_b16 v[120:121], v22 offset:36864
    ds_read_b64_tr_b16 v[122:123], v22 offset:37888
    ds_read_b64_tr_b16 v[124:125], v23 offset:36864
    ds_read_b64_tr_b16 v[126:127], v23 offset:37888
    s_waitcnt lgkmcnt(0)
    s_and_b32 s70, s65, 0
    s_xor_b32 s70, s70, 1
    s_lshl_b32 s71, s48, 4
    s_add_u32 s70, s70, s71
    s_mul_i32 s68, s70, 14336
    s_add_u32 s68, s68, 114688
    s_add_u32 m0, s60, 36864
    s_nop 0
    buffer_load_dwordx4 v4, s[20:23], s68 offen lds
    s_add_u32 m0, s60, 37888
    s_add_u32 s68, s68, 7168
    buffer_load_dwordx4 v4, s[20:23], s68 offen lds
    s_add_u32 m0, s60, 38912
    s_add_u32 s68, s68, 50176
    buffer_load_dwordx4 v4, s[20:23], s68 offen lds
    s_add_u32 m0, s60, 39936
    s_add_u32 s68, s68, 7168
    buffer_load_dwordx4 v4, s[20:23], s68 offen lds
    s_waitcnt vmcnt(12)
    ds_read_b64_tr_b16 v[224:225], v24 offset:0
    ds_read_b64_tr_b16 v[226:227], v24 offset:1024
    ds_read_b64_tr_b16 v[228:229], v25 offset:0
    ds_read_b64_tr_b16 v[230:231], v25 offset:1024
    ds_read_b64_tr_b16 v[232:233], v26 offset:0
    ds_read_b64_tr_b16 v[234:235], v26 offset:1024
    ds_read_b64_tr_b16 v[236:237], v27 offset:0
    ds_read_b64_tr_b16 v[238:239], v27 offset:1024
    s_waitcnt lgkmcnt(0)
    s_and_b32 s70, s65, 0
    s_xor_b32 s70, s70, 2
    s_lshl_b32 s71, s48, 4
    s_add_u32 s70, s70, s71
    s_mul_i32 s68, s70, 14336
    s_add_u32 m0, s56, 0
    s_nop 0
    buffer_load_dwordx4 v4, s[20:23], s68 offen lds
    s_add_u32 m0, s56, 1024
    s_add_u32 s68, s68, 7168
    buffer_load_dwordx4 v4, s[20:23], s68 offen lds
    s_add_u32 m0, s56, 2048
    s_add_u32 s68, s68, 50176
    buffer_load_dwordx4 v4, s[20:23], s68 offen lds
    s_add_u32 m0, s56, 3072
    s_add_u32 s68, s68, 7168
    buffer_load_dwordx4 v4, s[20:23], s68 offen lds
    s_waitcnt vmcnt(12)
    ds_read_b64_tr_b16 v[240:241], v24 offset:20736
    ds_read_b64_tr_b16 v[242:243], v24 offset:21760
    ds_read_b64_tr_b16 v[244:245], v25 offset:20736
    ds_read_b64_tr_b16 v[246:247], v25 offset:21760
    ds_read_b64_tr_b16 v[248:249], v26 offset:20736
    ds_read_b64_tr_b16 v[250:251], v26 offset:21760
    ds_read_b64_tr_b16 v[252:253], v27 offset:20736
    ds_read_b64_tr_b16 v[254:255], v27 offset:21760
    s_waitcnt lgkmcnt(0)
    s_and_b32 s70, s65, 0
    s_xor_b32 s70, s70, 2
    s_lshl_b32 s71, s48, 4
    s_add_u32 s70, s70, s71
    s_mul_i32 s68, s70, 14336
    s_add_u32 s68, s68, 114688
    s_add_u32 m0, s56, 20736
    s_nop 0
    buffer_load_dwordx4 v4, s[20:23], s68 offen lds
    s_add_u32 m0, s56, 21760
    s_add_u32 s68, s68, 7168
    buffer_load_dwordx4 v4, s[20:23], s68 offen lds
    s_add_u32 m0, s56, 22784
    s_add_u32 s68, s68, 50176
    buffer_load_dwordx4 v4, s[20:23], s68 offen lds
    s_add_u32 m0, s56, 23808
    s_add_u32 s68, s68, 7168
    buffer_load_dwordx4 v4, s[20:23], s68 offen lds
    s_waitcnt vmcnt(12)
    ds_read_b64_tr_b16 v[128:129], v20 offset:32768
    ds_read_b64_tr_b16 v[130:131], v20 offset:33792
    ds_read_b64_tr_b16 v[132:133], v21 offset:32768
    ds_read_b64_tr_b16 v[134:135], v21 offset:33792
    ds_read_b64_tr_b16 v[136:137], v22 offset:32768
    ds_read_b64_tr_b16 v[138:139], v22 offset:33792
    ds_read_b64_tr_b16 v[140:141], v23 offset:32768
    ds_read_b64_tr_b16 v[142:143], v23 offset:33792
    s_waitcnt lgkmcnt(0)
    s_and_b32 s70, s65, 0
    s_xor_b32 s70, s70, 3
    s_lshl_b32 s71, s48, 4
    s_add_u32 s70, s70, s71
    s_mul_i32 s68, s70, 14336
    s_add_u32 m0, s60, 32768
    s_nop 0
    buffer_load_dwordx4 v4, s[20:23], s68 offen lds
    s_add_u32 m0, s60, 33792
    s_add_u32 s68, s68, 7168
    buffer_load_dwordx4 v4, s[20:23], s68 offen lds
    s_add_u32 m0, s60, 34816
    s_add_u32 s68, s68, 50176
    buffer_load_dwordx4 v4, s[20:23], s68 offen lds
    s_add_u32 m0, s60, 35840
    s_add_u32 s68, s68, 7168
    buffer_load_dwordx4 v4, s[20:23], s68 offen lds
    s_waitcnt vmcnt(12)
    ds_read_b64_tr_b16 v[144:145], v20 offset:36864
    ds_read_b64_tr_b16 v[146:147], v20 offset:37888
    ds_read_b64_tr_b16 v[148:149], v21 offset:36864
    ds_read_b64_tr_b16 v[150:151], v21 offset:37888
    ds_read_b64_tr_b16 v[152:153], v22 offset:36864
    ds_read_b64_tr_b16 v[154:155], v22 offset:37888
    ds_read_b64_tr_b16 v[156:157], v23 offset:36864
    ds_read_b64_tr_b16 v[158:159], v23 offset:37888
    s_waitcnt lgkmcnt(0)
    s_and_b32 s70, s65, 0
    s_xor_b32 s70, s70, 3
    s_lshl_b32 s71, s48, 4
    s_add_u32 s70, s70, s71
    s_mul_i32 s68, s70, 14336
    s_add_u32 s68, s68, 114688
    s_add_u32 m0, s60, 36864
    s_nop 0
    buffer_load_dwordx4 v4, s[20:23], s68 offen lds
    s_add_u32 m0, s60, 37888
    s_add_u32 s68, s68, 7168
    buffer_load_dwordx4 v4, s[20:23], s68 offen lds
    s_add_u32 m0, s60, 38912
    s_add_u32 s68, s68, 50176
    buffer_load_dwordx4 v4, s[20:23], s68 offen lds
    s_add_u32 m0, s60, 39936
    s_add_u32 s68, s68, 7168
    buffer_load_dwordx4 v4, s[20:23], s68 offen lds
    s_waitcnt vmcnt(12)
    ds_read_b64_tr_b16 v[160:161], v24 offset:0
    ds_read_b64_tr_b16 v[162:163], v24 offset:1024
    ds_read_b64_tr_b16 v[164:165], v25 offset:0
    ds_read_b64_tr_b16 v[166:167], v25 offset:1024
    ds_read_b64_tr_b16 v[168:169], v26 offset:0
    ds_read_b64_tr_b16 v[170:171], v26 offset:1024
    ds_read_b64_tr_b16 v[172:173], v27 offset:0
    ds_read_b64_tr_b16 v[174:175], v27 offset:1024
    s_waitcnt lgkmcnt(0)
    s_waitcnt vmcnt(8)
    ds_read_b64_tr_b16 v[176:177], v24 offset:20736
    ds_read_b64_tr_b16 v[178:179], v24 offset:21760
    ds_read_b64_tr_b16 v[180:181], v25 offset:20736
    ds_read_b64_tr_b16 v[182:183], v25 offset:21760
    ds_read_b64_tr_b16 v[184:185], v26 offset:20736
    ds_read_b64_tr_b16 v[186:187], v26 offset:21760
    ds_read_b64_tr_b16 v[188:189], v27 offset:20736
    ds_read_b64_tr_b16 v[190:191], v27 offset:21760
    s_waitcnt lgkmcnt(0)
    s_waitcnt vmcnt(4)
    ds_read_b64_tr_b16 v[192:193], v20 offset:32768
    ds_read_b64_tr_b16 v[194:195], v20 offset:33792
    ds_read_b64_tr_b16 v[196:197], v21 offset:32768
    ds_read_b64_tr_b16 v[198:199], v21 offset:33792
    ds_read_b64_tr_b16 v[200:201], v22 offset:32768
    ds_read_b64_tr_b16 v[202:203], v22 offset:33792
    ds_read_b64_tr_b16 v[204:205], v23 offset:32768
    ds_read_b64_tr_b16 v[206:207], v23 offset:33792
    s_waitcnt lgkmcnt(0)
    s_waitcnt vmcnt(0)
    ds_read_b64_tr_b16 v[208:209], v20 offset:36864
    ds_read_b64_tr_b16 v[210:211], v20 offset:37888
    ds_read_b64_tr_b16 v[212:213], v21 offset:36864
    ds_read_b64_tr_b16 v[214:215], v21 offset:37888
    ds_read_b64_tr_b16 v[216:217], v22 offset:36864
    ds_read_b64_tr_b16 v[218:219], v22 offset:37888
    ds_read_b64_tr_b16 v[220:221], v23 offset:36864
    ds_read_b64_tr_b16 v[222:223], v23 offset:37888
    s_waitcnt lgkmcnt(0)
    s_mov_b32 s3, 200000
    s_branch L_15
L_14:
    s_mov_b64 exec, 1
    buffer_load_dword v28, v1, s[44:47], 0 offen sc1
    s_mov_b64 exec, -1
    s_sub_u32 s3, s3, 1
    s_waitcnt vmcnt(0)
    s_cbranch_scc1 L_16
L_15:
    v_readfirstlane_b32 s0, v28
    s_nop 0
    s_cmp_eq_u32 s0, 0
    s_cbranch_scc1 L_14
L_16:
    s_not_b32 s1, s0
    s_brev_b32 s70, s65
    s_lshr_b32 s70, s70, 29
    s_lshl_b32 s71, s48, 1
    s_xor_b32 s70, s70, s71
    s_xor_b32 s70, s70, 0
    s_mul_i32 s68, s70, 50176
    buffer_load_dwordx4 v[32:35], v7, s[24:27], s68 offen
    s_add_u32 s68, s68, 3584
    buffer_load_dwordx4 v[36:39], v8, s[24:27], s68 offen
    s_add_u32 s68, s68, 8960
    buffer_load_dwordx4 v[40:43], v7, s[24:27], s68 offen
    s_add_u32 s68, s68, 3584
    buffer_load_dwordx4 v[44:47], v8, s[24:27], s68 offen
    s_brev_b32 s70, s65
    s_lshr_b32 s70, s70, 29
    s_lshl_b32 s71, s48, 1
    s_xor_b32 s70, s70, s71
    s_xor_b32 s70, s70, 0
    s_mul_i32 s68, s70, 50176
    s_add_u32 s68, s68, 25088
    buffer_load_dwordx4 v[48:51], v7, s[24:27], s68 offen
    s_add_u32 s68, s68, 3584
    buffer_load_dwordx4 v[52:55], v8, s[24:27], s68 offen
    s_add_u32 s68, s68, 8960
    buffer_load_dwordx4 v[56:59], v7, s[24:27], s68 offen
    s_add_u32 s68, s68, 3584
    buffer_load_dwordx4 v[60:63], v8, s[24:27], s68 offen
    s_load_dwordx2 s[4:5], s[16:17], 262144 glc
    s_load_dwordx2 s[6:7], s[16:17], 262272 glc
    s_load_dwordx2 s[8:9], s[16:17], 262400 glc
    s_load_dwordx2 s[10:11], s[16:17], 262528 glc
    s_brev_b32 s70, s65
    s_lshr_b32 s70, s70, 29
    s_lshl_b32 s71, s48, 1
    s_xor_b32 s70, s70, s71
    s_xor_b32 s70, s70, 1
    s_mul_i32 s68, s70, 50176
    buffer_load_dwordx4 v[64:67], v7, s[24:27], s68 offen
    s_add_u32 s68, s68, 3584
    buffer_load_dwordx4 v[68:71], v8, s[24:27], s68 offen
    s_add_u32 s68, s68, 8960
    buffer_load_dwordx4 v[72:75], v7, s[24:27], s68 offen
    s_add_u32 s68, s68, 3584
    buffer_load_dwordx4 v[76:79], v8, s[24:27], s68 offen
    s_brev_b32 s70, s65
    s_lshr_b32 s70, s70, 29
    s_lshl_b32 s71, s48, 1
    s_xor_b32 s70, s70, s71
    s_xor_b32 s70, s70, 1
    s_mul_i32 s68, s70, 50176
    s_add_u32 s68, s68, 25088
    buffer_load_dwordx4 v[12:15], v7, s[24:27], s68 offen
    s_add_u32 s68, s68, 3584
    buffer_load_dwordx4 v[16:19], v8, s[24:27], s68 offen
    s_add_u32 s68, s68, 8960
    buffer_load_dwordx4 v[20:23], v7, s[24:27], s68 offen
    s_add_u32 s68, s68, 3584
    buffer_load_dwordx4 v[24:27], v8, s[24:27], s68 offen
    v_add_u32 v10, s60, v1
    v_add_u32 v11, s56, v1
L_ltail:
    s_mov_b32 s3, 200000
    s_branch L_18
L_17:
    s_load_dwordx2 s[4:5], s[16:17], 262144 glc
    s_load_dwordx2 s[6:7], s[16:17], 262272 glc
    s_load_dwordx2 s[8:9], s[16:17], 262400 glc
    s_load_dwordx2 s[10:11], s[16:17], 262528 glc
    s_sub_u32 s3, s3, 1
    s_cbranch_scc1 L_19
L_18:
    s_waitcnt lgkmcnt(0)
    s_xor_b64 s[4:5], s[4:5], s[0:1]
    s_xor_b64 s[6:7], s[6:7], s[0:1]
    s_xor_b64 s[8:9], s[8:9], s[0:1]
    s_xor_b64 s[10:11], s[10:11], s[0:1]
    s_or_b64 s[4:5], s[4:5], s[6:7]
    s_or_b64 s[8:9], s[8:9], s[10:11]
    s_or_b64 s[4:5], s[4:5], s[8:9]
    s_cbranch_scc1 L_17
L_19:
    s_waitcnt lgkmcnt(0)
    s_mul_i32 s70, s48, 8256
    s_lshl_b32 s71, s67, 8
    s_add_u32 s70, s70, s71
    s_add_u32 s75, s70, 10485760
    v_lshrrev_b32 v2, 5, v0
    v_lshl_add_u32 v1, v2, 9, v1
    s_setprio 2
    s_and_b32 s70, s65, 0
    s_xor_b32 s70, s70, 0
    s_lshl_b32 s71, s48, 2
    s_add_u32 s70, s70, s71
    s_lshl_b32 s70, s70, 12
    s_add_u32 s72, s77, s70
    s_add_u32 s73, s72, 147456
    buffer_load_dwordx4 v[80:83], v1, s[28:31], s72 offen offset:0 sc1
    buffer_load_dwordx4 v[84:87], v1, s[28:31], s72 offen offset:2048 sc1
    buffer_load_dwordx4 v[88:91], v1, s[28:31], s72 offen offset:512 sc1
    buffer_load_dwordx4 v[92:95], v1, s[28:31], s72 offen offset:2560 sc1
    buffer_load_dwordx4 v[28:31], v1, s[28:31], s73 offen offset:0 sc1
    s_cmp_lt_u32 s51, 4
    s_cbranch_scc1 L_20
    s_mov_b32 s3, 200000
L_21:
    ds_read_b32 v2, v5 offset:0
    s_sub_u32 s3, s3, 1
    s_waitcnt lgkmcnt(0)
    s_cbranch_scc1 L_22
    v_cmp_gt_u32 vcc, 4, v2
    s_nop 0
    s_cbranch_vccnz L_21
L_22:
    s_waitcnt vmcnt(5)
    ds_write_b128 v11, v[32:35] offset:0
    ds_write_b128 v11, v[36:39] offset:1024
    ds_write_b128 v11, v[40:43] offset:2048
    ds_write_b128 v11, v[44:47] offset:3072
    ds_write_b128 v11, v[48:51] offset:20736
    ds_write_b128 v11, v[52:55] offset:21760
    ds_write_b128 v11, v[56:59] offset:22784
    ds_write_b128 v11, v[60:63] offset:23808
    ds_write_b128 v10, v[64:67] offset:32768
    ds_write_b128 v10, v[68:71] offset:33792
    ds_write_b128 v10, v[72:75] offset:34816
    ds_write_b128 v10, v[76:79] offset:35840
    ds_write_b128 v10, v[12:15] offset:36864
    ds_write_b128 v10, v[16:19] offset:37888
    ds_write_b128 v10, v[20:23] offset:38912
    ds_write_b128 v10, v[24:27] offset:39936
    s_waitcnt lgkmcnt(0)
L_20:
    s_load_dwordx2 s[4:5], s[16:17], 0 glc
    s_load_dwordx2 s[6:7], s[16:17], 128 glc
    s_load_dwordx2 s[8:9], s[16:17], 256 glc
    s_load_dwordx2 s[10:11], s[16:17], 384 glc
    buffer_load_dwordx4 v[24:27], v1, s[28:31], s73 offen offset:2048 sc1
    buffer_load_dwordx4 v[20:23], v1, s[28:31], s73 offen offset:512 sc1
    buffer_load_dwordx4 v[16:19], v1, s[28:31], s73 offen offset:2560 sc1
    s_and_b32 s70, s65, 0
    s_xor_b32 s70, s70, 1
    s_lshl_b32 s71, s48, 2
    s_add_u32 s70, s70, s71
    s_lshl_b32 s70, s70, 12
    s_add_u32 s72, s77, s70
    s_add_u32 s73, s72, 147456
    buffer_load_dwordx4 v[12:15], v1, s[28:31], s72 offen offset:0 sc1
    buffer_load_dwordx4 v[8:11], v1, s[28:31], s72 offen offset:2048 sc1
    s_waitcnt vmcnt(9)
    v_mfma_f32_16x16x32_bf16 v[32:35], v[96:99], v[80:83], 0
    v_mov_b32 v2, 1
    s_mov_b64 exec, 1
    ds_add_u32 v5, v2 offset:16
    s_mov_b64 exec, -1
    s_waitcnt vmcnt(8)
    v_mfma_f32_16x16x32_bf16 v[32:35], v[112:115], v[84:87], v[32:35]
    v_mfma_f32_16x16x32_bf16 v[36:39], v[100:103], v[80:83], 0
    v_mfma_f32_16x16x32_bf16 v[36:39], v[116:119], v[84:87], v[36:39]
    v_mfma_f32_16x16x32_bf16 v[40:43], v[104:107], v[80:83], 0
    v_mfma_f32_16x16x32_bf16 v[40:43], v[120:123], v[84:87], v[40:43]
    v_mfma_f32_16x16x32_bf16 v[44:47], v[108:111], v[80:83], 0
    v_mfma_f32_16x16x32_bf16 v[44:47], v[124:127], v[84:87], v[44:47]
    s_waitcnt vmcnt(7)
    v_mfma_f32_16x16x32_bf16 v[48:51], v[96:99], v[88:91], 0
    s_waitcnt vmcnt(6)
    v_mfma_f32_16x16x32_bf16 v[48:51], v[112:115], v[92:95], v[48:51]
    v_mfma_f32_16x16x32_bf16 v[52:55], v[100:103], v[88:91], 0
    v_mfma_f32_16x16x32_bf16 v[52:55], v[116:119], v[92:95], v[52:55]
    v_mfma_f32_16x16x32_bf16 v[56:59], v[104:107], v[88:91], 0
    v_mfma_f32_16x16x32_bf16 v[56:59], v[120:123], v[92:95], v[56:59]
    v_mfma_f32_16x16x32_bf16 v[60:63], v[108:111], v[88:91], 0
    v_mfma_f32_16x16x32_bf16 v[60:63], v[124:127], v[92:95], v[60:63]
    s_waitcnt vmcnt(5)
    v_mfma_f32_16x16x32_bf16 v[64:67], v[96:99], v[28:31], 0
    s_waitcnt vmcnt(4)
    v_mfma_f32_16x16x32_bf16 v[64:67], v[112:115], v[24:27], v[64:67]
    v_mfma_f32_16x16x32_bf16 v[68:71], v[100:103], v[28:31], 0
    v_mfma_f32_16x16x32_bf16 v[68:71], v[116:119], v[24:27], v[68:71]
    v_mfma_f32_16x16x32_bf16 v[72:75], v[104:107], v[28:31], 0
    v_mfma_f32_16x16x32_bf16 v[72:75], v[120:123], v[24:27], v[72:75]
    v_mfma_f32_16x16x32_bf16 v[76:79], v[108:111], v[28:31], 0
    v_mfma_f32_16x16x32_bf16 v[76:79], v[124:127], v[24:27], v[76:79]
    s_waitcnt vmcnt(3)
    v_mfma_f32_16x16x32_bf16 v[80:83], v[96:99], v[20:23], 0
    s_waitcnt vmcnt(2)
    v_mfma_f32_16x16x32_bf16 v[80:83], v[112:115], v[16:19], v[80:83]
    buffer_load_dwordx4 v[28:31], v1, s[28:31], s72 offen offset:512 sc1
    v_mfma_f32_16x16x32_bf16 v[84:87], v[100:103], v[20:23], 0
    v_mfma_f32_16x16x32_bf16 v[84:87], v[116:119], v[16:19], v[84:87]
    s_cmp_lt_u32 s51, 4
    s_cbranch_scc1 L_23
    s_mov_b32 s3, 200000
L_24:
    ds_read_b32 v2, v5 offset:4
    s_sub_u32 s3, s3, 1
    s_waitcnt lgkmcnt(0)
    s_cbranch_scc1 L_25
    v_cmp_gt_u32 vcc, 4, v2
    s_nop 0
    s_cbranch_vccnz L_24
L_25:
    s_mul_i32 s68, s48, 172032
    s_add_u32 s68, s68, 931840
    s_add_u32 m0, s60, 0
    s_nop 0
    buffer_load_dwordx4 v4, s[20:23], s68 offen lds
    s_add_u32 m0, s60, 1024
    s_add_u32 s68, s68, 7168
    buffer_load_dwordx4 v4, s[20:23], s68 offen lds
    s_add_u32 m0, s60, 2048
    s_add_u32 s68, s68, 35840
    buffer_load_dwordx4 v4, s[20:23], s68 offen lds
    s_add_u32 m0, s60, 3072
    s_add_u32 s68, s68, 7168
    buffer_load_dwordx4 v4, s[20:23], s68 offen lds
L_23:
    buffer_load_dwordx4 v[24:27], v1, s[28:31], s72 offen offset:2560 sc1
    v_mfma_f32_16x16x32_bf16 v[88:91], v[104:107], v[20:23], 0
    v_mfma_f32_16x16x32_bf16 v[88:91], v[120:123], v[16:19], v[88:91]
    buffer_load_dwordx4 v[96:99], v1, s[28:31], s73 offen offset:0 sc1
    v_mfma_f32_16x16x32_bf16 v[92:95], v[108:111], v[20:23], 0
    v_mfma_f32_16x16x32_bf16 v[92:95], v[124:127], v[16:19], v[92:95]
    buffer_load_dwordx4 v[112:115], v1, s[28:31], s73 offen offset:2048 sc1
    s_waitcnt vmcnt(5)
    v_mfma_f32_16x16x32_bf16 v[32:35], v[128:131], v[12:15], v[32:35]
    s_waitcnt vmcnt(4)
    v_mfma_f32_16x16x32_bf16 v[32:35], v[144:147], v[8:11], v[32:35]
    buffer_load_dwordx4 v[100:103], v1, s[28:31], s73 offen offset:512 sc1
    v_mfma_f32_16x16x32_bf16 v[36:39], v[132:135], v[12:15], v[36:39]
    v_mfma_f32_16x16x32_bf16 v[36:39], v[148:151], v[8:11], v[36:39]
    s_cmp_lt_u32 s51, 4
    s_cbranch_scc1 L_26
    s_mul_i32 s68, s48, 172032
    s_add_u32 s68, s68, 1017856
    s_add_u32 m0, s60, 4096
    s_nop 0
    buffer_load_dwordx4 v4, s[20:23], s68 offen lds
    s_add_u32 m0, s60, 5120
    s_add_u32 s68, s68, 7168
    buffer_load_dwordx4 v4, s[20:23], s68 offen lds
    s_add_u32 m0, s60, 6144
    s_add_u32 s68, s68, 35840
    buffer_load_dwordx4 v4, s[20:23], s68 offen lds
    s_add_u32 m0, s60, 7168
    s_add_u32 s68, s68, 7168
    buffer_load_dwordx4 v4, s[20:23], s68 offen lds
L_26:
    buffer_load_dwordx4 v[116:119], v1, s[28:31], s73 offen offset:2560 sc1
    v_mfma_f32_16x16x32_bf16 v[40:43], v[136:139], v[12:15], v[40:43]
    v_mfma_f32_16x16x32_bf16 v[40:43], v[152:155], v[8:11], v[40:43]
    s_mov_b32 s3, 200000
    s_branch L_28
L_27:
    s_load_dwordx2 s[4:5], s[16:17], 0 glc
    s_load_dwordx2 s[6:7], s[16:17], 128 glc
    s_load_dwordx2 s[8:9], s[16:17], 256 glc
    s_load_dwordx2 s[10:11], s[16:17], 384 glc
    s_sub_u32 s3, s3, 1
    s_cbranch_scc1 L_29
L_28:
    s_waitcnt lgkmcnt(0)
    s_xor_b64 s[4:5], s[4:5], s[0:1]
    s_xor_b64 s[6:7], s[6:7], s[0:1]
    s_xor_b64 s[8:9], s[8:9], s[0:1]
    s_xor_b64 s[10:11], s[10:11], s[0:1]
    s_or_b64 s[4:5], s[4:5], s[6:7]
    s_or_b64 s[8:9], s[8:9], s[10:11]
    s_or_b64 s[4:5], s[4:5], s[8:9]
    s_cbranch_scc1 L_27
L_29:
    s_waitcnt lgkmcnt(0)
    s_and_b32 s70, s65, 0
    s_xor_b32 s70, s70, 2
    s_lshl_b32 s71, s48, 2
    s_add_u32 s70, s70, s71
    s_lshl_b32 s70, s70, 12
    s_add_u32 s72, s77, s70
    s_add_u32 s73, s72, 147456
    buffer_load_dwordx4 v[104:107], v1, s[28:31], s72 offen offset:0 sc1
    v_mfma_f32_16x16x32_bf16 v[44:47], v[140:143], v[12:15], v[44:47]
    v_mfma_f32_16x16x32_bf16 v[44:47], v[156:159], v[8:11], v[44:47]
    buffer_load_dwordx4 v[108:111], v1, s[28:31], s72 offen offset:2048 sc1
    s_waitcnt vmcnt(7)
    v_mfma_f32_16x16x32_bf16 v[48:51], v[128:131], v[28:31], v[48:51]
    v_xor_b32 v120, 0, v6
    s_waitcnt vmcnt(6)
    v_mfma_f32_16x16x32_bf16 v[48:51], v[144:147], v[24:27], v[48:51]
    v_xor_b32 v121, 32, v6
    buffer_load_dwordx4 v[20:23], v1, s[28:31], s72 offen offset:512 sc1
    v_mfma_f32_16x16x32_bf16 v[52:55], v[132:135], v[28:31], v[52:55]
    v_xor_b32 v122, 64, v6
    v_mfma_f32_16x16x32_bf16 v[52:55], v[148:151], v[24:27], v[52:55]
    v_xor_b32 v123, 96, v6
    s_cmp_lt_u32 s51, 4
    s_cbranch_scc1 L_30
    s_mul_i32 s68, s48, 172032
    s_add_u32 s68, s68, 946176
    s_add_u32 m0, s60, 65536
    s_nop 0
    buffer_load_dwordx4 v4, s[20:23], s68 offen lds
    s_add_u32 m0, s60, 66560
    s_add_u32 s68, s68, 7168
    buffer_load_dwordx4 v4, s[20:23], s68 offen lds
    s_add_u32 m0, s60, 67584
    s_add_u32 s68, s68, 35840
    buffer_load_dwordx4 v4, s[20:23], s68 offen lds
    s_add_u32 m0, s60, 68608
    s_add_u32 s68, s68, 7168
    buffer_load_dwordx4 v4, s[20:23], s68 offen lds
L_30:
    buffer_load_dwordx4 v[16:19], v1, s[28:31], s72 offen offset:2560 sc1
    v_mfma_f32_16x16x32_bf16 v[56:59], v[136:139], v[28:31], v[56:59]
    v_mfma_f32_16x16x32_bf16 v[56:59], v[152:155], v[24:27], v[56:59]
    buffer_load_dwordx4 v[12:15], v1, s[28:31], s73 offen offset:0 sc1
    v_mfma_f32_16x16x32_bf16 v[60:63], v[140:143], v[28:31], v[60:63]
    v_mfma_f32_16x16x32_bf16 v[60:63], v[156:159], v[24:27], v[60:63]
    s_load_dwordx2 s[4:5], s[16:17], 458752 glc
    s_load_dwordx2 s[6:7], s[16:17], 458880 glc
    s_load_dwordx2 s[8:9], s[16:17], 459008 glc
    s_load_dwordx2 s[10:11], s[16:17], 459136 glc
    buffer_load_dwordx4 v[8:11], v1, s[28:31], s73 offen offset:2048 sc1
    s_waitcnt vmcnt(9)
    v_mfma_f32_16x16x32_bf16 v[64:67], v[128:131], v[96:99], v[64:67]
    s_waitcnt vmcnt(8)
    v_mfma_f32_16x16x32_bf16 v[64:67], v[144:147], v[112:115], v[64:67]
    buffer_load_dwordx4 v[28:31], v1, s[28:31], s73 offen offset:512 sc1
    v_mfma_f32_16x16x32_bf16 v[68:71], v[132:135], v[96:99], v[68:71]
    v_mfma_f32_16x16x32_bf16 v[68:71], v[148:151], v[112:115], v[68:71]
    s_cmp_lt_u32 s51, 4
    s_cbranch_scc1 L_31
    s_mul_i32 s68, s48, 172032
    s_add_u32 s68, s68, 1032192
    s_add_u32 m0, s60, 69632
    s_nop 0
    buffer_load_dwordx4 v4, s[20:23], s68 offen lds
    s_add_u32 m0, s60, 70656
    s_add_u32 s68, s68, 7168
    buffer_load_dwordx4 v4, s[20:23], s68 offen lds
    s_add_u32 m0, s60, 71680
    s_add_u32 s68, s68, 35840
    buffer_load_dwordx4 v4, s[20:23], s68 offen lds
    s_add_u32 m0, s60, 72704
    s_add_u32 s68, s68, 7168
    buffer_load_dwordx4 v4, s[20:23], s68 offen lds
L_31:
    buffer_load_dwordx4 v[24:27], v1, s[28:31], s73 offen offset:2560 sc1
    v_mfma_f32_16x16x32_bf16 v[72:75], v[136:139], v[96:99], v[72:75]
    v_mfma_f32_16x16x32_bf16 v[72:75], v[152:155], v[112:115], v[72:75]
    v_mfma_f32_16x16x32_bf16 v[76:79], v[140:143], v[96:99], v[76:79]
    v_mfma_f32_16x16x32_bf16 v[76:79], v[156:159], v[112:115], v[76:79]
    s_waitcnt vmcnt(9)
    v_mfma_f32_16x16x32_bf16 v[80:83], v[128:131], v[100:103], v[80:83]
    s_waitcnt vmcnt(8)
    v_mfma_f32_16x16x32_bf16 v[80:83], v[144:147], v[116:119], v[80:83]
    s_and_b32 s70, s65, 0
    s_xor_b32 s70, s70, 3
    s_lshl_b32 s71, s48, 2
    s_add_u32 s70, s70, s71
    s_lshl_b32 s70, s70, 12
    s_add_u32 s72, s77, s70
    s_add_u32 s73, s72, 147456
    buffer_load_dwordx4 v[96:99], v1, s[28:31], s72 offen offset:0 sc1
    v_mfma_f32_16x16x32_bf16 v[84:87], v[132:135], v[100:103], v[84:87]
    v_mfma_f32_16x16x32_bf16 v[84:87], v[148:151], v[116:119], v[84:87]
    buffer_load_dwordx4 v[112:115], v1, s[28:31], s72 offen offset:2048 sc1
    v_mfma_f32_16x16x32_bf16 v[88:91], v[136:139], v[100:103], v[88:91]
    v_mfma_f32_16x16x32_bf16 v[88:91], v[152:155], v[116:119], v[88:91]
    v_mfma_f32_16x16x32_bf16 v[92:95], v[140:143], v[100:103], v[92:95]
    v_mfma_f32_16x16x32_bf16 v[92:95], v[156:159], v[116:119], v[92:95]
    s_waitcnt vmcnt(9)
    v_mfma_f32_16x16x32_bf16 v[32:35], v[160:163], v[104:107], v[32:35]
    s_waitcnt vmcnt(8)
    v_mfma_f32_16x16x32_bf16 v[32:35], v[176:179], v[108:111], v[32:35]
    buffer_load_dwordx4 v[100:103], v1, s[28:31], s72 offen offset:512 sc1
    v_mfma_f32_16x16x32_bf16 v[36:39], v[164:167], v[104:107], v[36:39]
    v_mfma_f32_16x16x32_bf16 v[36:39], v[180:183], v[108:111], v[36:39]
    buffer_load_dwordx4 v[116:119], v1, s[28:31], s72 offen offset:2560 sc1
    v_mfma_f32_16x16x32_bf16 v[40:43], v[168:171], v[104:107], v[40:43]
    v_mfma_f32_16x16x32_bf16 v[40:43], v[184:187], v[108:111], v[40:43]
    v_mfma_f32_16x16x32_bf16 v[44:47], v[172:175], v[104:107], v[44:47]
    v_mfma_f32_16x16x32_bf16 v[44:47], v[188:191], v[108:111], v[44:47]
    s_waitcnt vmcnt(9)
    v_mfma_f32_16x16x32_bf16 v[48:51], v[160:163], v[20:23], v[48:51]
    ds_read_b64_tr_b16 v[128:129], v120 offset:0
    s_waitcnt vmcnt(8)
    v_mfma_f32_16x16x32_bf16 v[48:51], v[176:179], v[16:19], v[48:51]
    ds_read_b64_tr_b16 v[130:131], v120 offset:1024
    buffer_load_dwordx4 v[104:107], v1, s[28:31], s73 offen offset:0 sc1
    v_mfma_f32_16x16x32_bf16 v[52:55], v[164:167], v[20:23], v[52:55]
    ds_read_b64_tr_b16 v[132:133], v121 offset:0
    v_mfma_f32_16x16x32_bf16 v[52:55], v[180:183], v[16:19], v[52:55]
    ds_read_b64_tr_b16 v[134:135], v121 offset:1024
    buffer_load_dwordx4 v[108:111], v1, s[28:31], s73 offen offset:2048 sc1
    v_mfma_f32_16x16x32_bf16 v[56:59], v[168:171], v[20:23], v[56:59]
    ds_read_b64_tr_b16 v[136:137], v122 offset:0
    v_mfma_f32_16x16x32_bf16 v[56:59], v[184:187], v[16:19], v[56:59]
    ds_read_b64_tr_b16 v[138:139], v122 offset:1024
    v_mfma_f32_16x16x32_bf16 v[60:63], v[172:175], v[20:23], v[60:63]
    ds_read_b64_tr_b16 v[140:141], v123 offset:0
    v_mfma_f32_16x16x32_bf16 v[60:63], v[188:191], v[16:19], v[60:63]
    ds_read_b64_tr_b16 v[142:143], v123 offset:1024
    s_waitcnt vmcnt(9)
    v_mfma_f32_16x16x32_bf16 v[64:67], v[160:163], v[12:15], v[64:67]
    ds_read_b64_tr_b16 v[144:145], v120 offset:4096
    s_waitcnt vmcnt(8)
    v_mfma_f32_16x16x32_bf16 v[64:67], v[176:179], v[8:11], v[64:67]
    ds_read_b64_tr_b16 v[146:147], v120 offset:5120
    buffer_load_dwordx4 v[20:23], v1, s[28:31], s73 offen offset:512 sc1
    v_mfma_f32_16x16x32_bf16 v[68:71], v[164:167], v[12:15], v[68:71]
    ds_read_b64_tr_b16 v[148:149], v121 offset:4096
    v_mfma_f32_16x16x32_bf16 v[68:71], v[180:183], v[8:11], v[68:71]
    ds_read_b64_tr_b16 v[150:151], v121 offset:5120
    buffer_load_dwordx4 v[16:19], v1, s[28:31], s73 offen offset:2560 sc1
    v_mfma_f32_16x16x32_bf16 v[72:75], v[168:171], v[12:15], v[72:75]
    ds_read_b64_tr_b16 v[152:153], v122 offset:4096
    v_mfma_f32_16x16x32_bf16 v[72:75], v[184:187], v[8:11], v[72:75]
    ds_read_b64_tr_b16 v[154:155], v122 offset:5120
    v_mfma_f32_16x16x32_bf16 v[76:79], v[172:175], v[12:15], v[76:79]
    ds_read_b64_tr_b16 v[156:157], v123 offset:4096
    v_mfma_f32_16x16x32_bf16 v[76:79], v[188:191], v[8:11], v[76:79]
    ds_read_b64_tr_b16 v[158:159], v123 offset:5120
    s_waitcnt vmcnt(9)
    v_mfma_f32_16x16x32_bf16 v[80:83], v[160:163], v[28:31], v[80:83]
    v_add_u32 v120, 65536, v120
    s_waitcnt vmcnt(8)
    v_mfma_f32_16x16x32_bf16 v[80:83], v[176:179], v[24:27], v[80:83]
    v_add_u32 v121, 65536, v121
    s_mov_b32 s3, 200000
    s_branch L_33
L_32:
    s_load_dwordx2 s[4:5], s[16:17], 458752 glc
    s_load_dwordx2 s[6:7], s[16:17], 458880 glc
    s_load_dwordx2 s[8:9], s[16:17], 459008 glc
    s_load_dwordx2 s[10:11], s[16:17], 459136 glc
    s_sub_u32 s3, s3, 1
    s_cbranch_scc1 L_34
L_33:
    s_waitcnt lgkmcnt(0)
    s_xor_b64 s[4:5], s[4:5], s[0:1]
    s_xor_b64 s[6:7], s[6:7], s[0:1]
    s_xor_b64 s[8:9], s[8:9], s[0:1]
    s_xor_b64 s[10:11], s[10:11], s[0:1]
    s_or_b64 s[4:5], s[4:5], s[6:7]
    s_or_b64 s[8:9], s[8:9], s[10:11]
    s_or_b64 s[4:5], s[4:5], s[8:9]
    s_cbranch_scc1 L_32
L_34:
    s_waitcnt lgkmcnt(0)
    s_mul_i32 s70, s48, 3
    s_add_u32 s70, s70, 16
    s_lshl_b32 s70, s70, 12
    s_add_u32 s72, s77, s70
    s_add_u32 s73, s72, 147456
    buffer_load_dwordx4 v[12:15], v1, s[28:31], s72 offen offset:0 sc1
    v_mfma_f32_16x16x32_bf16 v[84:87], v[164:167], v[28:31], v[84:87]
    v_add_u32 v122, 65536, v122
    v_mfma_f32_16x16x32_bf16 v[84:87], v[180:183], v[24:27], v[84:87]
    v_add_u32 v123, 65536, v123
    buffer_load_dwordx4 v[8:11], v1, s[28:31], s72 offen offset:2048 sc1
    v_mfma_f32_16x16x32_bf16 v[88:91], v[168:171], v[28:31], v[88:91]
    v_mfma_f32_16x16x32_bf16 v[88:91], v[184:187], v[24:27], v[88:91]
    v_mfma_f32_16x16x32_bf16 v[92:95], v[172:175], v[28:31], v[92:95]
    v_mfma_f32_16x16x32_bf16 v[92:95], v[188:191], v[24:27], v[92:95]
    s_waitcnt vmcnt(9)
    v_mfma_f32_16x16x32_bf16 v[32:35], v[192:195], v[96:99], v[32:35]
    s_waitcnt vmcnt(8)
    v_mfma_f32_16x16x32_bf16 v[32:35], v[208:211], v[112:115], v[32:35]
    v_lshrrev_b32 v3, 3, v0
    v_lshlrev_b32 v3, 2, v3
    buffer_load_dword v4, v3, s[28:31], s75 offen sc1
    buffer_load_dword v3, v3, s[28:31], s75 offen offset:32 sc1
    buffer_load_dwordx4 v[28:31], v1, s[28:31], s72 offen offset:512 sc1
    v_mfma_f32_16x16x32_bf16 v[36:39], v[196:199], v[96:99], v[36:39]
    v_mfma_f32_16x16x32_bf16 v[36:39], v[212:215], v[112:115], v[36:39]
    buffer_load_dwordx4 v[24:27], v1, s[28:31], s72 offen offset:2560 sc1
    v_mfma_f32_16x16x32_bf16 v[40:43], v[200:203], v[96:99], v[40:43]
    v_mfma_f32_16x16x32_bf16 v[40:43], v[216:219], v[112:115], v[40:43]
    v_mfma_f32_16x16x32_bf16 v[44:47], v[204:207], v[96:99], v[44:47]
    v_mfma_f32_16x16x32_bf16 v[44:47], v[220:223], v[112:115], v[44:47]
    s_waitcnt vmcnt(11)
    v_mfma_f32_16x16x32_bf16 v[48:51], v[192:195], v[100:103], v[48:51]
    ds_read_b64_tr_b16 v[160:161], v120 offset:0
    s_waitcnt vmcnt(10)
    v_mfma_f32_16x16x32_bf16 v[48:51], v[208:211], v[116:119], v[48:51]
    ds_read_b64_tr_b16 v[162:163], v120 offset:1024
    buffer_load_dwordx4 v[96:99], v1, s[28:31], s73 offen offset:0 sc1
    v_mfma_f32_16x16x32_bf16 v[52:55], v[196:199], v[100:103], v[52:55]
    ds_read_b64_tr_b16 v[164:165], v121 offset:0
    v_mfma_f32_16x16x32_bf16 v[52:55], v[212:215], v[116:119], v[52:55]
    ds_read_b64_tr_b16 v[166:167], v121 offset:1024
    s_load_dwordx2 s[4:5], s[16:17], 65536 glc
    s_load_dwordx2 s[6:7], s[16:17], 65664 glc
    s_load_dwordx2 s[8:9], s[16:17], 65792 glc
    s_load_dwordx2 s[10:11], s[16:17], 65920 glc
    buffer_load_dwordx4 v[112:115], v1, s[28:31], s73 offen offset:2048 sc1
    v_mfma_f32_16x16x32_bf16 v[56:59], v[200:203], v[100:103], v[56:59]
    ds_read_b64_tr_b16 v[168:169], v122 offset:0
    v_mfma_f32_16x16x32_bf16 v[56:59], v[216:219], v[116:119], v[56:59]
    ds_read_b64_tr_b16 v[170:171], v122 offset:1024
    v_mfma_f32_16x16x32_bf16 v[60:63], v[204:207], v[100:103], v[60:63]
    ds_read_b64_tr_b16 v[172:173], v123 offset:0
    v_mfma_f32_16x16x32_bf16 v[60:63], v[220:223], v[116:119], v[60:63]
    ds_read_b64_tr_b16 v[174:175], v123 offset:1024
    s_waitcnt vmcnt(11)
    v_mfma_f32_16x16x32_bf16 v[64:67], v[192:195], v[104:107], v[64:67]
    ds_read_b64_tr_b16 v[176:177], v120 offset:4096
    s_waitcnt vmcnt(10)
    v_mfma_f32_16x16x32_bf16 v[64:67], v[208:211], v[108:111], v[64:67]
    ds_read_b64_tr_b16 v[178:179], v120 offset:5120
    buffer_load_dwordx4 v[100:103], v1, s[28:31], s73 offen offset:512 sc1
    v_mfma_f32_16x16x32_bf16 v[68:71], v[196:199], v[104:107], v[68:71]
    ds_read_b64_tr_b16 v[180:181], v121 offset:4096
    v_mfma_f32_16x16x32_bf16 v[68:71], v[212:215], v[108:111], v[68:71]
    ds_read_b64_tr_b16 v[182:183], v121 offset:5120
    buffer_load_dwordx4 v[116:119], v1, s[28:31], s73 offen offset:2560 sc1
    v_mfma_f32_16x16x32_bf16 v[72:75], v[200:203], v[104:107], v[72:75]
    ds_read_b64_tr_b16 v[184:185], v122 offset:4096
    v_mfma_f32_16x16x32_bf16 v[72:75], v[216:219], v[108:111], v[72:75]
    ds_read_b64_tr_b16 v[186:187], v122 offset:5120
    v_mfma_f32_16x16x32_bf16 v[76:79], v[204:207], v[104:107], v[76:79]
    ds_read_b64_tr_b16 v[188:189], v123 offset:4096
    v_mfma_f32_16x16x32_bf16 v[76:79], v[220:223], v[108:111], v[76:79]
    ds_read_b64_tr_b16 v[190:191], v123 offset:5120
    s_waitcnt vmcnt(11)
    v_mfma_f32_16x16x32_bf16 v[80:83], v[192:195], v[20:23], v[80:83]
    s_waitcnt vmcnt(10)
    v_mfma_f32_16x16x32_bf16 v[80:83], v[208:211], v[16:19], v[80:83]
    v_mov_b32 v2, 1
    s_mov_b64 exec, 1
    ds_add_u32 v5, v2 offset:12
    s_mov_b64 exec, -1
    s_mul_i32 s70, s48, 3
    s_add_u32 s70, s70, 17
    s_lshl_b32 s70, s70, 12
    s_add_u32 s72, s77, s70
    s_add_u32 s73, s72, 147456
    buffer_load_dwordx4 v[104:107], v1, s[28:31], s72 offen offset:0 sc1
    v_mfma_f32_16x16x32_bf16 v[84:87], v[196:199], v[20:23], v[84:87]
    v_mfma_f32_16x16x32_bf16 v[84:87], v[212:215], v[16:19], v[84:87]
    buffer_load_dwordx4 v[108:111], v1, s[28:31], s72 offen offset:2048 sc1
    v_mfma_f32_16x16x32_bf16 v[88:91], v[200:203], v[20:23], v[88:91]
    v_mfma_f32_16x16x32_bf16 v[88:91], v[216:219], v[16:19], v[88:91]
    v_mfma_f32_16x16x32_bf16 v[92:95], v[204:207], v[20:23], v[92:95]
    v_mfma_f32_16x16x32_bf16 v[92:95], v[220:223], v[16:19], v[92:95]
    s_waitcnt vmcnt(11)
    v_mfma_f32_16x16x32_bf16 v[32:35], v[224:227], v[12:15], v[32:35]
    s_waitcnt vmcnt(10)
    v_mfma_f32_16x16x32_bf16 v[32:35], v[240:243], v[8:11], v[32:35]
    buffer_load_dwordx4 v[192:195], v1, s[28:31], s72 offen offset:512 sc1
    v_mfma_f32_16x16x32_bf16 v[36:39], v[228:231], v[12:15], v[36:39]
    v_mfma_f32_16x16x32_bf16 v[36:39], v[244:247], v[8:11], v[36:39]
    buffer_load_dwordx4 v[208:211], v1, s[28:31], s72 offen offset:2560 sc1
    v_mfma_f32_16x16x32_bf16 v[40:43], v[232:235], v[12:15], v[40:43]
    v_mfma_f32_16x16x32_bf16 v[40:43], v[248:251], v[8:11], v[40:43]
    v_mfma_f32_16x16x32_bf16 v[44:47], v[236:239], v[12:15], v[44:47]
    v_mfma_f32_16x16x32_bf16 v[44:47], v[252:255], v[8:11], v[44:47]
    s_waitcnt vmcnt(9)
    v_mfma_f32_16x16x32_bf16 v[48:51], v[224:227], v[28:31], v[48:51]
    s_waitcnt vmcnt(8)
    v_mfma_f32_16x16x32_bf16 v[48:51], v[240:243], v[24:27], v[48:51]
    buffer_load_dwordx4 v[196:199], v1, s[28:31], s73 offen offset:0 sc1
    v_mfma_f32_16x16x32_bf16 v[52:55], v[228:231], v[28:31], v[52:55]
    v_mfma_f32_16x16x32_bf16 v[52:55], v[244:247], v[24:27], v[52:55]
    buffer_load_dwordx4 v[212:215], v1, s[28:31], s73 offen offset:2048 sc1
    v_mfma_f32_16x16x32_bf16 v[56:59], v[232:235], v[28:31], v[56:59]
    v_mfma_f32_16x16x32_bf16 v[56:59], v[248:251], v[24:27], v[56:59]
    v_mfma_f32_16x16x32_bf16 v[60:63], v[236:239], v[28:31], v[60:63]
    v_mfma_f32_16x16x32_bf16 v[60:63], v[252:255], v[24:27], v[60:63]
    s_waitcnt vmcnt(9)
    v_mfma_f32_16x16x32_bf16 v[64:67], v[224:227], v[96:99], v[64:67]
    s_waitcnt vmcnt(8)
    v_mfma_f32_16x16x32_bf16 v[64:67], v[240:243], v[112:115], v[64:67]
    buffer_load_dwordx4 v[200:203], v1, s[28:31], s73 offen offset:512 sc1
    v_mfma_f32_16x16x32_bf16 v[68:71], v[228:231], v[96:99], v[68:71]
    v_mfma_f32_16x16x32_bf16 v[68:71], v[244:247], v[112:115], v[68:71]
    buffer_load_dwordx4 v[216:219], v1, s[28:31], s73 offen offset:2560 sc1
    v_mfma_f32_16x16x32_bf16 v[72:75], v[232:235], v[96:99], v[72:75]
    v_mfma_f32_16x16x32_bf16 v[72:75], v[248:251], v[112:115], v[72:75]
    v_mfma_f32_16x16x32_bf16 v[76:79], v[236:239], v[96:99], v[76:79]
    v_mfma_f32_16x16x32_bf16 v[76:79], v[252:255], v[112:115], v[76:79]
    s_waitcnt vmcnt(9)
    v_mfma_f32_16x16x32_bf16 v[80:83], v[224:227], v[100:103], v[80:83]
    s_waitcnt vmcnt(8)
    v_mfma_f32_16x16x32_bf16 v[80:83], v[240:243], v[116:119], v[80:83]
    s_mov_b32 s3, 200000
    s_branch L_36
L_35:
    s_load_dwordx2 s[4:5], s[16:17], 65536 glc
    s_load_dwordx2 s[6:7], s[16:17], 65664 glc
    s_load_dwordx2 s[8:9], s[16:17], 65792 glc
    s_load_dwordx2 s[10:11], s[16:17], 65920 glc
    s_sub_u32 s3, s3, 1
    s_cbranch_scc1 L_37
L_36:
    s_waitcnt lgkmcnt(0)
    s_xor_b64 s[4:5], s[4:5], s[0:1]
    s_xor_b64 s[6:7], s[6:7], s[0:1]
    s_xor_b64 s[8:9], s[8:9], s[0:1]
    s_xor_b64 s[10:11], s[10:11], s[0:1]
    s_or_b64 s[4:5], s[4:5], s[6:7]
    s_or_b64 s[8:9], s[8:9], s[10:11]
    s_or_b64 s[4:5], s[4:5], s[8:9]
    s_cbranch_scc1 L_35
L_37:
    s_waitcnt lgkmcnt(0)
    s_mul_i32 s70, s48, 3
    s_add_u32 s70, s70, 18
    s_lshl_b32 s70, s70, 12
    s_add_u32 s72, s77, s70
    s_add_u32 s73, s72, 147456
    buffer_load_dwordx4 v[204:207], v1, s[28:31], s72 offen offset:0 sc1
    v_mfma_f32_16x16x32_bf16 v[84:87], v[228:231], v[100:103], v[84:87]
    v_mfma_f32_16x16x32_bf16 v[84:87], v[244:247], v[116:119], v[84:87]
    buffer_load_dwordx4 v[220:223], v1, s[28:31], s72 offen offset:2048 sc1
    v_mfma_f32_16x16x32_bf16 v[88:91], v[232:235], v[100:103], v[88:91]
    v_mfma_f32_16x16x32_bf16 v[88:91], v[248:251], v[116:119], v[88:91]
    v_mfma_f32_16x16x32_bf16 v[92:95], v[236:239], v[100:103], v[92:95]
    v_mfma_f32_16x16x32_bf16 v[92:95], v[252:255], v[116:119], v[92:95]
    s_waitcnt lgkmcnt(0)
    s_waitcnt vmcnt(9)
    v_mfma_f32_16x16x32_bf16 v[32:35], v[128:131], v[104:107], v[32:35]
    s_waitcnt vmcnt(8)
    v_mfma_f32_16x16x32_bf16 v[32:35], v[144:147], v[108:111], v[32:35]
    buffer_load_dwordx4 v[20:23], v1, s[28:31], s72 offen offset:512 sc1
    v_mfma_f32_16x16x32_bf16 v[36:39], v[132:135], v[104:107], v[36:39]
    v_mfma_f32_16x16x32_bf16 v[36:39], v[148:151], v[108:111], v[36:39]
    buffer_load_dwordx4 v[16:19], v1, s[28:31], s72 offen offset:2560 sc1
    v_mfma_f32_16x16x32_bf16 v[40:43], v[136:139], v[104:107], v[40:43]
    v_mfma_f32_16x16x32_bf16 v[40:43], v[152:155], v[108:111], v[40:43]
    v_mfma_f32_16x16x32_bf16 v[44:47], v[140:143], v[104:107], v[44:47]
    v_mfma_f32_16x16x32_bf16 v[44:47], v[156:159], v[108:111], v[44:47]
    s_waitcnt vmcnt(9)
    v_mfma_f32_16x16x32_bf16 v[48:51], v[128:131], v[192:195], v[48:51]
    v_mov_b32 v6, v3
    s_waitcnt vmcnt(8)
    v_mfma_f32_16x16x32_bf16 v[48:51], v[144:147], v[208:211], v[48:51]
    v_and_b32 v121, 15, v0
    buffer_load_dwordx4 v[12:15], v1, s[28:31], s73 offen offset:0 sc1
    v_mfma_f32_16x16x32_bf16 v[52:55], v[132:135], v[192:195], v[52:55]
    v_lshrrev_b32 v122, 4, v0
    v_mfma_f32_16x16x32_bf16 v[52:55], v[148:151], v[208:211], v[52:55]
    v_xor_b32 v122, v122, v121
    buffer_load_dwordx4 v[8:11], v1, s[28:31], s73 offen offset:2048 sc1
    v_mfma_f32_16x16x32_bf16 v[56:59], v[136:139], v[192:195], v[56:59]
    v_lshl_add_u32 v121, v121, 8, s60
    v_mfma_f32_16x16x32_bf16 v[56:59], v[152:155], v[208:211], v[56:59]
    v_lshl_add_u32 v120, v122, 4, v121
    v_mfma_f32_16x16x32_bf16 v[60:63], v[140:143], v[192:195], v[60:63]
    v_xor_b32 v121, 64, v120
    v_mfma_f32_16x16x32_bf16 v[60:63], v[156:159], v[208:211], v[60:63]
    v_xor_b32 v122, 128, v120
    s_waitcnt vmcnt(9)
    v_mfma_f32_16x16x32_bf16 v[64:67], v[128:131], v[196:199], v[64:67]
    v_xor_b32 v123, 192, v120
    s_waitcnt vmcnt(8)
    v_mfma_f32_16x16x32_bf16 v[64:67], v[144:147], v[212:215], v[64:67]
    v_add_u32 v124, 65536, v120
    buffer_load_dwordx4 v[28:31], v1, s[28:31], s73 offen offset:512 sc1
    v_mfma_f32_16x16x32_bf16 v[68:71], v[132:135], v[196:199], v[68:71]
    v_add_u32 v125, 65536, v121
    v_mfma_f32_16x16x32_bf16 v[68:71], v[148:151], v[212:215], v[68:71]
    v_add_u32 v126, 65536, v122
    buffer_load_dwordx4 v[24:27], v1, s[28:31], s73 offen offset:2560 sc1
    v_mfma_f32_16x16x32_bf16 v[72:75], v[136:139], v[196:199], v[72:75]
    v_add_u32 v127, 65536, v123
    v_mfma_f32_16x16x32_bf16 v[72:75], v[152:155], v[212:215], v[72:75]
    v_mfma_f32_16x16x32_bf16 v[76:79], v[140:143], v[196:199], v[76:79]
    v_mfma_f32_16x16x32_bf16 v[76:79], v[156:159], v[212:215], v[76:79]
    s_waitcnt vmcnt(9)
    v_mfma_f32_16x16x32_bf16 v[80:83], v[128:131], v[200:203], v[80:83]
    s_waitcnt vmcnt(8)
    v_mfma_f32_16x16x32_bf16 v[80:83], v[144:147], v[216:219], v[80:83]
    v_mfma_f32_16x16x32_bf16 v[84:87], v[132:135], v[200:203], v[84:87]
    v_mfma_f32_16x16x32_bf16 v[84:87], v[148:151], v[216:219], v[84:87]
    v_mfma_f32_16x16x32_bf16 v[88:91], v[136:139], v[200:203], v[88:91]
    v_mfma_f32_16x16x32_bf16 v[88:91], v[152:155], v[216:219], v[88:91]
    v_mfma_f32_16x16x32_bf16 v[92:95], v[140:143], v[200:203], v[92:95]
    v_mfma_f32_16x16x32_bf16 v[92:95], v[156:159], v[216:219], v[92:95]
    s_waitcnt vmcnt(7)
    v_mfma_f32_16x16x32_bf16 v[32:35], v[160:163], v[204:207], v[32:35]
    s_waitcnt vmcnt(6)
    v_mfma_f32_16x16x32_bf16 v[32:35], v[176:179], v[220:223], v[32:35]
    v_mfma_f32_16x16x32_bf16 v[36:39], v[164:167], v[204:207], v[36:39]
    v_mfma_f32_16x16x32_bf16 v[36:39], v[180:183], v[220:223], v[36:39]
    v_mfma_f32_16x16x32_bf16 v[40:43], v[168:171], v[204:207], v[40:43]
    v_mfma_f32_16x16x32_bf16 v[40:43], v[184:187], v[220:223], v[40:43]
    v_mfma_f32_16x16x32_bf16 v[44:47], v[172:175], v[204:207], v[44:47]
    v_mfma_f32_16x16x32_bf16 v[44:47], v[188:191], v[220:223], v[44:47]
    s_waitcnt vmcnt(5)
    v_mfma_f32_16x16x32_bf16 v[48:51], v[160:163], v[20:23], v[48:51]
    s_waitcnt vmcnt(4)
    v_mfma_f32_16x16x32_bf16 v[48:51], v[176:179], v[16:19], v[48:51]
    ds_write_b128 v120, v[32:35] offset:0
    v_mfma_f32_16x16x32_bf16 v[52:55], v[164:167], v[20:23], v[52:55]
    v_mfma_f32_16x16x32_bf16 v[52:55], v[180:183], v[16:19], v[52:55]
    ds_write_b128 v121, v[36:39] offset:0
    v_mfma_f32_16x16x32_bf16 v[56:59], v[168:171], v[20:23], v[56:59]
    v_mfma_f32_16x16x32_bf16 v[56:59], v[184:187], v[16:19], v[56:59]
    ds_write_b128 v122, v[40:43] offset:0
    v_mfma_f32_16x16x32_bf16 v[60:63], v[172:175], v[20:23], v[60:63]
    v_mfma_f32_16x16x32_bf16 v[60:63], v[188:191], v[16:19], v[60:63]
    ds_write_b128 v123, v[44:47] offset:0
    s_waitcnt vmcnt(3)
    v_mfma_f32_16x16x32_bf16 v[64:67], v[160:163], v[12:15], v[64:67]
    s_waitcnt vmcnt(2)
    v_mfma_f32_16x16x32_bf16 v[64:67], v[176:179], v[8:11], v[64:67]
    ds_write_b128 v120, v[48:51] offset:4096
    v_mfma_f32_16x16x32_bf16 v[68:71], v[164:167], v[12:15], v[68:71]
    v_mfma_f32_16x16x32_bf16 v[68:71], v[180:183], v[8:11], v[68:71]
    ds_write_b128 v121, v[52:55] offset:4096
    v_mfma_f32_16x16x32_bf16 v[72:75], v[168:171], v[12:15], v[72:75]
    v_mfma_f32_16x16x32_bf16 v[72:75], v[184:187], v[8:11], v[72:75]
    ds_write_b128 v122, v[56:59] offset:4096
    v_mfma_f32_16x16x32_bf16 v[76:79], v[172:175], v[12:15], v[76:79]
    v_mfma_f32_16x16x32_bf16 v[76:79], v[188:191], v[8:11], v[76:79]
    ds_write_b128 v123, v[60:63] offset:4096
    s_waitcnt vmcnt(1)
    v_mfma_f32_16x16x32_bf16 v[80:83], v[160:163], v[28:31], v[80:83]
    s_waitcnt vmcnt(0)
    v_mfma_f32_16x16x32_bf16 v[80:83], v[176:179], v[24:27], v[80:83]
    ds_write_b128 v124, v[64:67] offset:0
    v_mfma_f32_16x16x32_bf16 v[84:87], v[164:167], v[28:31], v[84:87]
    v_mfma_f32_16x16x32_bf16 v[84:87], v[180:183], v[24:27], v[84:87]
    ds_write_b128 v125, v[68:71] offset:0
    v_mfma_f32_16x16x32_bf16 v[88:91], v[168:171], v[28:31], v[88:91]
    v_mfma_f32_16x16x32_bf16 v[88:91], v[184:187], v[24:27], v[88:91]
    ds_write_b128 v126, v[72:75] offset:0
    v_mfma_f32_16x16x32_bf16 v[92:95], v[172:175], v[28:31], v[92:95]
    v_mfma_f32_16x16x32_bf16 v[92:95], v[188:191], v[24:27], v[92:95]
    ds_write_b128 v127, v[76:79] offset:0
L_wi2:
    ds_write_b128 v124, v[80:83] offset:4096
    ds_write_b128 v125, v[84:87] offset:4096
    s_nop 1
    ds_write_b128 v126, v[88:91] offset:4096
    s_nop 1
    ds_write_b128 v127, v[92:95] offset:4096
    v_mov_b32 v2, 1
    s_mov_b64 exec, 1
    ds_add_u32 v5, v2 offset:8
    s_mov_b64 exec, -1
    s_setprio 0
    v_lshrrev_b32 v8, 3, v0
    v_and_b32 v9, 7, v0
    v_mul_u32_u24 v20, 896, v8
    v_lshl_add_u32 v20, v9, 4, v20
    v_lshlrev_b32 v9, 1, v9
    v_xor_b32 v9, v9, v8
    v_lshlrev_b32 v8, 8, v8
    v_lshl_add_u32 v8, v9, 4, v8
    s_and_b32 s70, s48, 1
    s_lshl_b32 s70, s70, 12
    s_lshr_b32 s71, s48, 1
    s_lshl_b32 s71, s71, 16
    s_add_u32 s70, s70, s71
    s_lshl_b32 s71, s48, 12
    s_add_u32 s71, s71, 98304
    v_xor_b32 v9, 0, v8
    v_add_u32 v12, s70, v9
    v_add_u32 v16, s71, v9
    v_xor_b32 v9, 16, v8
    v_add_u32 v13, s70, v9
    v_add_u32 v17, s71, v9
    v_xor_b32 v9, 2176, v8
    v_add_u32 v14, s70, v9
    v_add_u32 v18, s71, v9
    v_xor_b32 v9, 2192, v8
    v_add_u32 v15, s70, v9
    v_add_u32 v19, s71, v9
    s_lshl_b32 s70, s67, 2
    s_add_u32 s70, s70, s48
    s_mul_i32 s70, s70, 14336
    s_add_u32 s72, s70, s66
    s_add_u32 s73, s72, 7168
    s_mov_b32 s3, 200000
L_38:
    ds_read_b32 v2, v5 offset:8
    ds_read_b128 v[96:99], v12 offset:0
    ds_read_b128 v[100:103], v13 offset:0
    ds_read_b128 v[104:107], v14 offset:0
    ds_read_b128 v[108:111], v15 offset:0
    ds_read_b128 v[112:115], v12 offset:8192
    ds_read_b128 v[116:119], v13 offset:8192
    ds_read_b128 v[120:123], v14 offset:8192
    ds_read_b128 v[124:127], v15 offset:8192
    s_sub_u32 s3, s3, 1
    s_waitcnt lgkmcnt(0)
    s_cbranch_scc1 L_39
    v_cmp_gt_u32 vcc, 4, v2
    s_nop 0
    s_cbranch_vccnz L_38
L_39:
    ds_read_b128 v[128:131], v12 offset:16384
    ds_read_b128 v[132:135], v13 offset:16384
    ds_read_b128 v[136:139], v14 offset:16384
    ds_read_b128 v[140:143], v15 offset:16384
    ds_read_b128 v[144:147], v12 offset:24576
    ds_read_b128 v[148:151], v13 offset:24576
    ds_read_b128 v[152:155], v14 offset:24576
    ds_read_b128 v[156:159], v15 offset:24576
    v_add_f32 v96, v96, v112
    v_add_f32 v97, v97, v113
    v_add_f32 v98, v98, v114
    v_add_f32 v99, v99, v115
    v_add_f32 v100, v100, v116
    v_add_f32 v101, v101, v117
    v_add_f32 v102, v102, v118
    v_add_f32 v103, v103, v119
    v_add_f32 v104, v104, v120
    v_add_f32 v105, v105, v121
    v_add_f32 v106, v106, v122
    v_add_f32 v107, v107, v123
    v_add_f32 v108, v108, v124
    v_add_f32 v109, v109, v125
    v_add_f32 v110, v110, v126
    v_add_f32 v111, v111, v127
    s_waitcnt lgkmcnt(4)
    v_add_f32 v96, v96, v128
    v_add_f32 v97, v97, v129
    v_add_f32 v98, v98, v130
    v_add_f32 v99, v99, v131
    v_add_f32 v100, v100, v132
    v_add_f32 v101, v101, v133
    v_add_f32 v102, v102, v134
    v_add_f32 v103, v103, v135
    v_add_f32 v104, v104, v136
    v_add_f32 v105, v105, v137
    v_add_f32 v106, v106, v138
    v_add_f32 v107, v107, v139
    v_add_f32 v108, v108, v140
    v_add_f32 v109, v109, v141
    v_add_f32 v110, v110, v142
    v_add_f32 v111, v111, v143
    s_waitcnt lgkmcnt(0)
    v_add_f32 v96, v96, v144
    v_add_f32 v97, v97, v145
    v_add_f32 v98, v98, v146
    v_add_f32 v99, v99, v147
    v_add_f32 v100, v100, v148
    v_add_f32 v101, v101, v149
    v_add_f32 v102, v102, v150
    v_add_f32 v103, v103, v151
    v_add_f32 v104, v104, v152
    v_add_f32 v105, v105, v153
    v_add_f32 v106, v106, v154
    v_add_f32 v107, v107, v155
    v_add_f32 v108, v108, v156
    v_add_f32 v109, v109, v157
    v_add_f32 v110, v110, v158
    v_add_f32 v111, v111, v159
    v_mul_f32 v96, v96, v4
    v_mul_f32 v97, v97, v4
    v_mul_f32 v98, v98, v4
    v_mul_f32 v99, v99, v4
    v_mul_f32 v100, v100, v4
    v_mul_f32 v101, v101, v4
    v_mul_f32 v102, v102, v4
    v_mul_f32 v103, v103, v4
    v_mul_f32 v104, v104, v6
    v_mul_f32 v105, v105, v6
    v_mul_f32 v106, v106, v6
    v_mul_f32 v107, v107, v6
    v_mul_f32 v108, v108, v6
    v_mul_f32 v109, v109, v6
    v_mul_f32 v110, v110, v6
    v_mul_f32 v111, v111, v6
    v_lshl_add_u32 v3, s48, 2, v5
    s_mov_b32 s3, 200000
L_40:
    ds_read_b32 v2, v3 offset:32
    ds_read_b128 v[112:115], v16
    ds_read_b128 v[116:119], v17
    ds_read_b128 v[120:123], v18
    ds_read_b128 v[124:127], v19
    s_sub_u32 s3, s3, 1
    s_waitcnt lgkmcnt(0)
    s_cbranch_scc1 L_41
    v_cmp_gt_u32 vcc, 1, v2
    s_nop 0
    s_cbranch_vccnz L_40
L_41:
    v_fmac_f32 v96, v112, v4
    v_fmac_f32 v97, v113, v4
    v_fmac_f32 v98, v114, v4
    v_fmac_f32 v99, v115, v4
    v_fmac_f32 v100, v116, v4
    v_fmac_f32 v101, v117, v4
    v_fmac_f32 v102, v118, v4
    v_fmac_f32 v103, v119, v4
    v_cvt_pk_bf16_f32 v96, v96, v97
    v_cvt_pk_bf16_f32 v97, v98, v99
    v_cvt_pk_bf16_f32 v98, v100, v101
    v_cvt_pk_bf16_f32 v99, v102, v103
    buffer_store_dwordx4 v[96:99], v20, s[32:35], s72 offen
    v_fmac_f32 v104, v120, v6
    v_fmac_f32 v105, v121, v6
    v_fmac_f32 v106, v122, v6
    v_fmac_f32 v107, v123, v6
    v_fmac_f32 v108, v124, v6
    v_fmac_f32 v109, v125, v6
    v_fmac_f32 v110, v126, v6
    v_fmac_f32 v111, v127, v6
    v_cvt_pk_bf16_f32 v104, v104, v105
    v_cvt_pk_bf16_f32 v105, v106, v107
    v_cvt_pk_bf16_f32 v106, v108, v109
    v_cvt_pk_bf16_f32 v107, v110, v111
    buffer_store_dwordx4 v[104:107], v20, s[32:35], s73 offen
    s_branch L_fin
L_compute:
    s_waitcnt lgkmcnt(0)
    s_load_dwordx2 s[28:29], s[0:1], 88
    s_load_dwordx2 s[32:33], s[0:1], 72
    s_load_dwordx2 s[44:45], s[0:1], 80
    s_load_dwordx2 s[20:21], s[0:1], 56
    s_load_dwordx2 s[24:25], s[0:1], 24
    s_mov_b32 s22, 1605632
    s_mov_b32 s23, 0x20000
    s_mov_b32 s26, 401408
    s_mov_b32 s27, 0x20000
    s_mov_b32 s34, 1835008
    s_mov_b32 s35, 0x20000
    s_mov_b32 s30, 11075712
    s_mov_b32 s31, 0x20000
    s_mov_b32 s46, 256
    s_mov_b32 s47, 0x20000
    v_lshlrev_b32 v1, 4, v0
    s_lshl_b32 s67, s49, 2
    s_add_u32 s67, s67, s50
    s_add_u32 s65, s51, s50
    s_lshl_b32 s66, s51, 7
    s_mul_i32 s77, s67, 294912
    v_mov_b32 v5, 163712
    v_and_b32 v47, 15, v0
    v_lshl_add_u32 v44, v47, 2, v5
    v_mov_b32 v45, 0
    ds_write_b32 v44, v45
    v_lshrrev_b32 v43, 5, v0
    v_bfe_u32 v44, v0, 1, 3
    v_lshrrev_b32 v46, 4, v0
    v_xor_b32 v44, v44, v46
    v_lshl_add_u32 v45, v47, 7, s60
    v_lshl_add_u32 v10, v44, 4, v45
    v_xor_b32 v11, 64, v10
    v_add_u32 v12, 65536, v10
    v_add_u32 v13, 65536, v11
    s_mov_b32 s10, 1204224
    s_mov_b32 s11, 0x20000
    s_mov_b32 s14, 1605632
    s_mov_b32 s15, 0x20000
    s_mov_b32 s18, 1605632
    s_mov_b32 s19, 0x20000
    s_mov_b32 s42, 0
    s_mov_b32 s43, 0x20000
    s_bitcmp1_b32 s48, 0
    s_cselect_b32 s40, s16, s12
    s_cselect_b32 s41, s17, s13
    s_cselect_b32 s42, s18, s14
    s_cmp_ge_u32 s48, 2
    s_cselect_b32 s40, s8, s40
    s_cselect_b32 s41, s9, s41
    s_cselect_b32 s42, s10, s42
    s_mov_b32 s74, 3584
    s_cmov_b32 s74, 2688
    s_mov_b32 s71, 512
    s_cmov_b32 s71, 224
    s_mov_b32 s72, 384
    s_cmov_b32 s72, 224
    s_mov_b32 s73, 2048
    s_cmov_b32 s73, 896
    s_mul_i32 s63, s71, s52
    s_mul_i32 s64, s72, s52
    s_add_u32 s64, s64, s73
    s_cmp_eq_u32 s48, 3
    s_cselect_b32 s71, 1792, 0
    s_add_u32 s63, s63, s71
    s_lshr_b32 s71, s2, 3
    s_and_b32 s72, s2, 1
    s_lshl_b32 s72, s72, 5
    s_add_u32 s71, s71, s72
    s_mul_i32 s71, s71, s74
    s_and_b32 s63, s63, 0xffffff80
    s_add_u32 s63, s63, s71
    s_and_b32 s64, s64, 0xffffff80
    s_add_u32 s64, s64, s71
    s_lshl_b32 s69, s74, 6
    s_or_b32 s71, s49, 1
    s_add_u32 s71, s71, 1
    s_sub_u32 s72, s71, 7
    s_min_u32 s71, s71, s72
    s_mul_i32 s71, s71, s69
    s_add_u32 s72, s71, s64
    s_add_u32 s71, s71, s63
    s_buffer_load_dwordx2 s[78:79], s[40:43], s71 offset:60
    s_buffer_load_dwordx2 s[78:79], s[40:43], s71 offset:188
    s_buffer_load_dwordx2 s[78:79], s[40:43], s71 offset:316
    s_cmp_eq_u32 s48, 3
    s_cbranch_scc1 L_42
    s_buffer_load_dwordx2 s[78:79], s[40:43], s72 offset:60
    s_buffer_load_dwordx2 s[78:79], s[40:43], s72 offset:188
    s_buffer_load_dwordx2 s[78:79], s[40:43], s72 offset:316
    s_cmp_eq_u32 s48, 2
    s_cbranch_scc1 L_42
    s_buffer_load_dwordx2 s[78:79], s[40:43], s71 offset:444
L_42:
    s_waitcnt lgkmcnt(0)
    s_mov_b32 s78, 0
    s_mov_b32 s79, -1
    s_mov_b32 s80, 3216550459
    s_mov_b32 s81, 3216550459
    s_mov_b32 s82, 1069066811
    s_mov_b32 s83, 1069066811
    s_mul_i32 s63, s76, 294912
    s_add_u32 s64, s63, 147456
    s_lshl_b32 s72, s76, 2
    s_add_u32 s72, s72, s52
    s_lshl_b32 s72, s72, 2
    s_and_b32 s73, s51, 3
    s_add_u32 s72, s72, s73
    s_and_b32 s73, s51, 4
    s_lshl_b32 s73, s73, 7
    s_add_u32 s72, s72, s73
    s_lshl_b32 s72, s72, 7
    s_add_u32 s72, s72, 10551296
    v_lshl_add_u32 v8, v0, 17, s72
    v_bfe_u32 v44, v0, 2, 2
    v_lshl_add_u32 v44, v43, 3, v44
    v_mul_u32_u24 v44, 80, v44
    v_bfe_u32 v45, v0, 4, 1
    v_and_b32 v46, 3, v0
    v_lshl_add_u32 v45, v45, 2, v46
    v_add_u32 v46, 1, v45
    v_lshrrev_b32 v46, 3, v46
    v_add_u32 v45, v45, v46
    v_lshl_add_u32 v44, v45, 3, v44
    v_add_u32 v6, 161152, v44
    s_setprio 3
    s_cmp_ge_u32 s51, 4
    s_cbranch_scc1 L_compA
    v_bfe_u32 v44, v0, 2, 2
    v_bfe_u32 v45, v0, 4, 1
    v_and_b32 v46, 3, v0
    v_lshl_add_u32 v49, v45, 3, v44
    v_mul_u32_u24 v48, 5120, v43
    v_lshl_add_u32 v47, v49, 6, v48
    v_lshl_add_u32 v47, v45, 5, v47
    v_lshl_add_u32 v47, v46, 3, v47
    v_add_u32 v14, 102400, v47
    v_xor_b32 v15, 32, v14
    v_cmp_eq_u32 vcc, 3, v46
    v_mov_b32 v47, 0x30000
    s_nop 0
    v_cndmask_b32 v15, v15, v47, vcc
    v_lshl_add_u32 v47, v49, 7, v48
    v_lshl_add_u32 v47, v46, 3, v47
    v_lshl_add_u32 v47, v45, 6, v47
    v_bfe_u32 v48, v0, 3, 1
    v_lshl_add_u32 v47, v48, 5, v47
    v_add_u32 v16, 98304, v47
    v_xor_b32 v17, 32, v16
    v_xor_b32 v18, 64, v16
    v_xor_b32 v19, 96, v16
    s_lshl_b32 s69, s52, 4
    s_add_u32 s69, s69, s51
    s_lshl_b32 s69, s69, 10
    v_and_b32 v47, 48, v0
    v_add_u32 v7, 160256, v47
    s_mov_b32 s40, 0x10001000
    s_mov_b32 s41, 0x10001000
    s_waitcnt lgkmcnt(0)
    s_barrier
    ds_read_b64_tr_b16 v[20:21], v16 offset:0
    ds_read_b64_tr_b16 v[22:23], v16 offset:512
    ds_read_b128 v[24:27], v10 offset:0
    ds_read_b64_tr_b16 v[28:29], v16 offset:10240
    ds_read_b64_tr_b16 v[30:31], v16 offset:10752
    ds_read_b128 v[32:35], v11 offset:0
    ds_read_b128 v[36:39], v10 offset:2048
    ds_read_b128 v[40:43], v11 offset:2048
    ds_read_b128 v[44:47], v10 offset:4096
    ds_read_b128 v[48:51], v11 offset:4096
    ds_read_b128 v[52:55], v10 offset:6144
    ds_read_b128 v[56:59], v11 offset:6144
    s_waitcnt lgkmcnt(9)
    v_mfma_f32_16x16x32_bf16 v[128:131], v[20:23], v[24:27], 0
    ds_read_b64_tr_b16 v[60:61], v16 offset:2048
    s_waitcnt lgkmcnt(7)
    v_mfma_f32_16x16x32_bf16 v[128:131], v[28:31], v[32:35], v[128:131]
    ds_read_b64_tr_b16 v[62:63], v16 offset:2560
    s_waitcnt lgkmcnt(7)
    v_mfma_f32_16x16x32_bf16 v[132:135], v[20:23], v[36:39], 0
    ds_read_b64_tr_b16 v[64:65], v16 offset:12288
    s_waitcnt lgkmcnt(7)
    v_mfma_f32_16x16x32_bf16 v[132:135], v[28:31], v[40:43], v[132:135]
    ds_read_b64_tr_b16 v[66:67], v16 offset:12800
    s_waitcnt lgkmcnt(7)
    v_mfma_f32_16x16x32_bf16 v[136:139], v[20:23], v[44:47], 0
    ds_read_b64_tr_b16 v[68:69], v17 offset:0
    s_waitcnt lgkmcnt(7)
    v_mfma_f32_16x16x32_bf16 v[136:139], v[28:31], v[48:51], v[136:139]
    ds_read_b64_tr_b16 v[70:71], v17 offset:512
    s_waitcnt lgkmcnt(7)
    v_mfma_f32_16x16x32_bf16 v[140:143], v[20:23], v[52:55], 0
    ds_read_b64_tr_b16 v[72:73], v17 offset:10240
    s_waitcnt lgkmcnt(7)
    v_mfma_f32_16x16x32_bf16 v[140:143], v[28:31], v[56:59], v[140:143]
    ds_read_b64_tr_b16 v[74:75], v17 offset:10752
    s_waitcnt lgkmcnt(6)
    v_mfma_f32_16x16x32_bf16 v[144:147], v[60:63], v[24:27], 0
    ds_read_b64_tr_b16 v[76:77], v17 offset:2048
    s_waitcnt lgkmcnt(5)
    v_mfma_f32_16x16x32_bf16 v[144:147], v[64:67], v[32:35], v[144:147]
    ds_read_b64_tr_b16 v[78:79], v17 offset:2560
    v_mfma_f32_16x16x32_bf16 v[148:151], v[60:63], v[36:39], 0
    ds_read_b64_tr_b16 v[80:81], v17 offset:12288
    v_mfma_f32_16x16x32_bf16 v[148:151], v[64:67], v[40:43], v[148:151]
    ds_read_b64_tr_b16 v[82:83], v17 offset:12800
    v_mfma_f32_16x16x32_bf16 v[152:155], v[60:63], v[44:47], 0
    ds_read_b64_tr_b16 v[84:85], v18 offset:0
    v_mfma_f32_16x16x32_bf16 v[152:155], v[64:67], v[48:51], v[152:155]
    ds_read_b64_tr_b16 v[86:87], v18 offset:512
    v_mfma_f32_16x16x32_bf16 v[156:159], v[60:63], v[52:55], 0
    ds_read_b64_tr_b16 v[88:89], v18 offset:10240
    v_mfma_f32_16x16x32_bf16 v[156:159], v[64:67], v[56:59], v[156:159]
    ds_read_b64_tr_b16 v[90:91], v18 offset:10752
    s_waitcnt lgkmcnt(7)
    v_mfma_f32_16x16x32_bf16 v[160:163], v[68:71], v[24:27], 0
    ds_read_b64_tr_b16 v[92:93], v18 offset:2048
    v_mfma_f32_16x16x32_bf16 v[160:163], v[72:75], v[32:35], v[160:163]
    ds_read_b64_tr_b16 v[94:95], v18 offset:2560
    v_mfma_f32_16x16x32_bf16 v[164:167], v[68:71], v[36:39], 0
    ds_read_b64_tr_b16 v[20:21], v18 offset:12288
    v_mfma_f32_16x16x32_bf16 v[164:167], v[72:75], v[40:43], v[164:167]
    ds_read_b64_tr_b16 v[22:23], v18 offset:12800
    v_mfma_f32_16x16x32_bf16 v[168:171], v[68:71], v[44:47], 0
    ds_read_b64_tr_b16 v[28:29], v19 offset:0
    v_mfma_f32_16x16x32_bf16 v[168:171], v[72:75], v[48:51], v[168:171]
    ds_read_b64_tr_b16 v[30:31], v19 offset:512
    v_mfma_f32_16x16x32_bf16 v[172:175], v[68:71], v[52:55], 0
    ds_read_b64_tr_b16 v[60:61], v19 offset:10240
    v_mfma_f32_16x16x32_bf16 v[172:175], v[72:75], v[56:59], v[172:175]
    ds_read_b64_tr_b16 v[62:63], v19 offset:10752
    s_waitcnt lgkmcnt(7)
    v_mfma_f32_16x16x32_bf16 v[176:179], v[76:79], v[24:27], 0
    ds_read_b64_tr_b16 v[64:65], v19 offset:2048
    v_mfma_f32_16x16x32_bf16 v[176:179], v[80:83], v[32:35], v[176:179]
    ds_read_b64_tr_b16 v[66:67], v19 offset:2560
    v_mfma_f32_16x16x32_bf16 v[180:183], v[76:79], v[36:39], 0
    ds_read_b64_tr_b16 v[68:69], v19 offset:12288
    v_mfma_f32_16x16x32_bf16 v[180:183], v[80:83], v[40:43], v[180:183]
    ds_read_b64_tr_b16 v[70:71], v19 offset:12800
    v_mfma_f32_16x16x32_bf16 v[184:187], v[76:79], v[44:47], 0
    ds_read_b64_tr_b16 v[72:73], v14 offset:0
    v_mfma_f32_16x16x32_bf16 v[184:187], v[80:83], v[48:51], v[184:187]
    ds_read_b64_tr_b16 v[74:75], v14 offset:256
    v_mfma_f32_16x16x32_bf16 v[188:191], v[76:79], v[52:55], 0
    v_mfma_f32_16x16x32_bf16 v[188:191], v[80:83], v[56:59], v[188:191]
    ds_read_b64_tr_b16 v[76:77], v14 offset:10240
    v_mfma_f32_16x16x32_bf16 v[192:195], v[84:87], v[24:27], 0
    ds_read_b64_tr_b16 v[78:79], v14 offset:10496
    v_mfma_f32_16x16x32_bf16 v[192:195], v[88:91], v[32:35], v[192:195]
    ds_read_b64_tr_b16 v[80:81], v15 offset:0
    v_mfma_f32_16x16x32_bf16 v[196:199], v[84:87], v[36:39], 0
    ds_read_b64_tr_b16 v[82:83], v15 offset:256
    v_mfma_f32_16x16x32_bf16 v[196:199], v[88:91], v[40:43], v[196:199]
    s_mov_b64 exec, s[40:41]
    ds_read_b128 v[80:83], v7 offset:0
    s_mov_b64 exec, -1
    v_mfma_f32_16x16x32_bf16 v[200:203], v[84:87], v[44:47], 0
    v_mfma_f32_16x16x32_bf16 v[200:203], v[88:91], v[48:51], v[200:203]
    v_mfma_f32_16x16x32_bf16 v[204:207], v[84:87], v[52:55], 0
    v_mfma_f32_16x16x32_bf16 v[204:207], v[88:91], v[56:59], v[204:207]
    ds_read_b64_tr_b16 v[84:85], v15 offset:10240
    s_waitcnt lgkmcnt(4)
    v_mfma_f32_16x16x32_bf16 v[208:211], v[92:95], v[24:27], 0
    ds_read_b64_tr_b16 v[86:87], v15 offset:10496
    v_mfma_f32_16x16x32_bf16 v[208:211], v[20:23], v[32:35], v[208:211]
    s_mov_b64 exec, s[40:41]
    ds_read_b128 v[84:87], v7 offset:64
    s_mov_b64 exec, -1
    v_mfma_f32_16x16x32_bf16 v[212:215], v[92:95], v[36:39], 0
    v_mfma_f32_16x16x32_bf16 v[212:215], v[20:23], v[40:43], v[212:215]
    v_mfma_f32_16x16x32_bf16 v[216:219], v[92:95], v[44:47], 0
    v_mfma_f32_16x16x32_bf16 v[216:219], v[20:23], v[48:51], v[216:219]
    v_mfma_f32_16x16x32_bf16 v[220:223], v[92:95], v[52:55], 0
    v_mfma_f32_16x16x32_bf16 v[220:223], v[20:23], v[56:59], v[220:223]
    v_mfma_f32_16x16x32_bf16 v[224:227], v[28:31], v[24:27], 0
    v_mfma_f32_16x16x32_bf16 v[224:227], v[60:63], v[32:35], v[224:227]
    v_mfma_f32_16x16x32_bf16 v[228:231], v[28:31], v[36:39], 0
    v_mfma_f32_16x16x32_bf16 v[228:231], v[60:63], v[40:43], v[228:231]
    v_mfma_f32_16x16x32_bf16 v[232:235], v[28:31], v[44:47], 0
    v_mfma_f32_16x16x32_bf16 v[232:235], v[60:63], v[48:51], v[232:235]
    v_mfma_f32_16x16x32_bf16 v[236:239], v[28:31], v[52:55], 0
    v_mfma_f32_16x16x32_bf16 v[236:239], v[60:63], v[56:59], v[236:239]
    v_mfma_f32_16x16x32_bf16 v[240:243], v[64:67], v[24:27], 0
    v_mfma_f32_16x16x32_bf16 v[240:243], v[68:71], v[32:35], v[240:243]
    v_mfma_f32_16x16x32_bf16 v[244:247], v[64:67], v[36:39], 0
    v_mfma_f32_16x16x32_bf16 v[244:247], v[68:71], v[40:43], v[244:247]
    v_mfma_f32_16x16x32_bf16 v[248:251], v[64:67], v[44:47], 0
    v_mfma_f32_16x16x32_bf16 v[248:251], v[68:71], v[48:51], v[248:251]
    v_mfma_f32_16x16x32_bf16 v[252:255], v[64:67], v[52:55], 0
    v_mfma_f32_16x16x32_bf16 v[252:255], v[68:71], v[56:59], v[252:255]
    v_mfma_f32_16x16x32_bf16 v[96:99], v[72:75], v[24:27], 0
    s_waitcnt lgkmcnt(0)
    s_barrier
    ds_read_b64_tr_b16 v[88:89], v16 offset:20736
    v_mfma_f32_16x16x32_bf16 v[96:99], v[76:79], v[32:35], v[96:99]
    ds_read_b64_tr_b16 v[90:91], v16 offset:21248
    v_mfma_f32_16x16x32_bf16 v[100:103], v[72:75], v[36:39], 0
    ds_read_b128 v[92:95], v10 offset:32768
    v_mfma_f32_16x16x32_bf16 v[100:103], v[76:79], v[40:43], v[100:103]
    ds_read_b64_tr_b16 v[20:21], v16 offset:30976
    v_mfma_f32_16x16x32_bf16 v[104:107], v[72:75], v[44:47], 0
    ds_read_b64_tr_b16 v[22:23], v16 offset:31488
    v_mfma_f32_16x16x32_bf16 v[104:107], v[76:79], v[48:51], v[104:107]
    ds_read_b128 v[28:31], v11 offset:32768
    v_mfma_f32_16x16x32_bf16 v[108:111], v[72:75], v[52:55], 0
    ds_read_b128 v[60:63], v10 offset:34816
    v_mfma_f32_16x16x32_bf16 v[108:111], v[76:79], v[56:59], v[108:111]
    ds_read_b128 v[64:67], v11 offset:34816
    v_mfma_f32_16x16x32_bf16 v[112:115], v[80:83], v[24:27], 0
    ds_read_b128 v[68:71], v10 offset:36864
    v_mfma_f32_16x16x32_bf16 v[112:115], v[84:87], v[32:35], v[112:115]
    ds_read_b128 v[72:75], v11 offset:36864
    v_mfma_f32_16x16x32_bf16 v[116:119], v[80:83], v[36:39], 0
    ds_read_b128 v[76:79], v10 offset:38912
    v_mfma_f32_16x16x32_bf16 v[116:119], v[84:87], v[40:43], v[116:119]
    ds_read_b128 v[24:27], v11 offset:38912
    v_mfma_f32_16x16x32_bf16 v[120:123], v[80:83], v[44:47], 0
    ds_read_b64_tr_b16 v[32:33], v16 offset:22784
    v_mfma_f32_16x16x32_bf16 v[120:123], v[84:87], v[48:51], v[120:123]
    ds_read_b64_tr_b16 v[34:35], v16 offset:23296
    v_mfma_f32_16x16x32_bf16 v[124:127], v[80:83], v[52:55], 0
    ds_read_b64_tr_b16 v[36:37], v16 offset:33024
    v_mfma_f32_16x16x32_bf16 v[124:127], v[84:87], v[56:59], v[124:127]
    ds_read_b64_tr_b16 v[38:39], v16 offset:33536
    s_waitcnt lgkmcnt(7)
    v_mfma_f32_16x16x32_bf16 v[128:131], v[88:91], v[92:95], v[128:131]
    ds_read_b64_tr_b16 v[40:41], v17 offset:20736
    v_mfma_f32_16x16x32_bf16 v[128:131], v[20:23], v[28:31], v[128:131]
    ds_read_b64_tr_b16 v[42:43], v17 offset:21248
    v_mfma_f32_16x16x32_bf16 v[132:135], v[88:91], v[60:63], v[132:135]
    ds_read_b64_tr_b16 v[44:45], v17 offset:30976
    v_mfma_f32_16x16x32_bf16 v[132:135], v[20:23], v[64:67], v[132:135]
    ds_read_b64_tr_b16 v[46:47], v17 offset:31488
    v_mfma_f32_16x16x32_bf16 v[136:139], v[88:91], v[68:71], v[136:139]
    ds_read_b64_tr_b16 v[48:49], v17 offset:22784
    s_waitcnt lgkmcnt(7)
    v_mfma_f32_16x16x32_bf16 v[136:139], v[20:23], v[72:75], v[136:139]
    ds_read_b64_tr_b16 v[50:51], v17 offset:23296
    v_mfma_f32_16x16x32_bf16 v[140:143], v[88:91], v[76:79], v[140:143]
    ds_read_b64_tr_b16 v[52:53], v17 offset:33024
    v_mfma_f32_16x16x32_bf16 v[140:143], v[20:23], v[24:27], v[140:143]
    ds_read_b64_tr_b16 v[54:55], v17 offset:33536
    v_mfma_f32_16x16x32_bf16 v[144:147], v[32:35], v[92:95], v[144:147]
    ds_read_b64_tr_b16 v[80:81], v18 offset:20736
    s_waitcnt lgkmcnt(7)
    v_mfma_f32_16x16x32_bf16 v[144:147], v[36:39], v[28:31], v[144:147]
    ds_read_b64_tr_b16 v[82:83], v18 offset:21248
    v_mfma_f32_16x16x32_bf16 v[148:151], v[32:35], v[60:63], v[148:151]
    ds_read_b64_tr_b16 v[56:57], v18 offset:30976
    v_mfma_f32_16x16x32_bf16 v[148:151], v[36:39], v[64:67], v[148:151]
    ds_read_b64_tr_b16 v[58:59], v18 offset:31488
    v_mfma_f32_16x16x32_bf16 v[152:155], v[32:35], v[68:71], v[152:155]
    ds_read_b64_tr_b16 v[84:85], v18 offset:22784
    v_mfma_f32_16x16x32_bf16 v[152:155], v[36:39], v[72:75], v[152:155]
    ds_read_b64_tr_b16 v[86:87], v18 offset:23296
    v_mfma_f32_16x16x32_bf16 v[156:159], v[32:35], v[76:79], v[156:159]
    ds_read_b64_tr_b16 v[88:89], v18 offset:33024
    v_mfma_f32_16x16x32_bf16 v[156:159], v[36:39], v[24:27], v[156:159]
    ds_read_b64_tr_b16 v[90:91], v18 offset:33536
    v_mfma_f32_16x16x32_bf16 v[160:163], v[40:43], v[92:95], v[160:163]
    ds_read_b64_tr_b16 v[20:21], v19 offset:20736
    s_waitcnt lgkmcnt(7)
    v_mfma_f32_16x16x32_bf16 v[160:163], v[44:47], v[28:31], v[160:163]
    ds_read_b64_tr_b16 v[22:23], v19 offset:21248
    v_mfma_f32_16x16x32_bf16 v[164:167], v[40:43], v[60:63], v[164:167]
    ds_read_b64_tr_b16 v[32:33], v19 offset:30976
    v_mfma_f32_16x16x32_bf16 v[164:167], v[44:47], v[64:67], v[164:167]
    ds_read_b64_tr_b16 v[34:35], v19 offset:31488
    v_mfma_f32_16x16x32_bf16 v[168:171], v[40:43], v[68:71], v[168:171]
    ds_read_b64_tr_b16 v[36:37], v19 offset:22784
    v_mfma_f32_16x16x32_bf16 v[168:171], v[44:47], v[72:75], v[168:171]
    ds_read_b64_tr_b16 v[38:39], v19 offset:23296
    v_mfma_f32_16x16x32_bf16 v[172:175], v[40:43], v[76:79], v[172:175]
    v_mfma_f32_16x16x32_bf16 v[172:175], v[44:47], v[24:27], v[172:175]
    ds_read_b64_tr_b16 v[40:41], v19 offset:33024
    v_mfma_f32_16x16x32_bf16 v[176:179], v[48:51], v[92:95], v[176:179]
    ds_read_b64_tr_b16 v[42:43], v19 offset:33536
    v_mfma_f32_16x16x32_bf16 v[176:179], v[52:55], v[28:31], v[176:179]
    ds_read_b64_tr_b16 v[44:45], v14 offset:20736
    v_mfma_f32_16x16x32_bf16 v[180:183], v[48:51], v[60:63], v[180:183]
    ds_read_b64_tr_b16 v[46:47], v14 offset:20992
    v_mfma_f32_16x16x32_bf16 v[180:183], v[52:55], v[64:67], v[180:183]
    v_mfma_f32_16x16x32_bf16 v[184:187], v[48:51], v[68:71], v[184:187]
    v_mfma_f32_16x16x32_bf16 v[184:187], v[52:55], v[72:75], v[184:187]
    v_mfma_f32_16x16x32_bf16 v[188:191], v[48:51], v[76:79], v[188:191]
    v_mfma_f32_16x16x32_bf16 v[188:191], v[52:55], v[24:27], v[188:191]
    ds_read_b64_tr_b16 v[48:49], v14 offset:30976
    v_mfma_f32_16x16x32_bf16 v[192:195], v[80:83], v[92:95], v[192:195]
    ds_read_b64_tr_b16 v[50:51], v14 offset:31232
    s_waitcnt lgkmcnt(3)
    v_mfma_f32_16x16x32_bf16 v[192:195], v[56:59], v[28:31], v[192:195]
    ds_read_b64_tr_b16 v[52:53], v15 offset:20736
    v_mfma_f32_16x16x32_bf16 v[196:199], v[80:83], v[60:63], v[196:199]
    ds_read_b64_tr_b16 v[54:55], v15 offset:20992
    v_mfma_f32_16x16x32_bf16 v[196:199], v[56:59], v[64:67], v[196:199]
    s_mov_b64 exec, s[40:41]
    ds_read_b128 v[52:55], v7 offset:128
    s_mov_b64 exec, -1
    v_mfma_f32_16x16x32_bf16 v[200:203], v[80:83], v[68:71], v[200:203]
    v_mfma_f32_16x16x32_bf16 v[200:203], v[56:59], v[72:75], v[200:203]
    v_mfma_f32_16x16x32_bf16 v[204:207], v[80:83], v[76:79], v[204:207]
    v_mfma_f32_16x16x32_bf16 v[204:207], v[56:59], v[24:27], v[204:207]
    ds_read_b64_tr_b16 v[80:81], v15 offset:30976
    v_mfma_f32_16x16x32_bf16 v[208:211], v[84:87], v[92:95], v[208:211]
    ds_read_b64_tr_b16 v[82:83], v15 offset:31232
    v_mfma_f32_16x16x32_bf16 v[208:211], v[88:91], v[28:31], v[208:211]
    s_mov_b64 exec, s[40:41]
    ds_read_b128 v[80:83], v7 offset:192
    s_mov_b64 exec, -1
    v_mfma_f32_16x16x32_bf16 v[212:215], v[84:87], v[60:63], v[212:215]
    v_mfma_f32_16x16x32_bf16 v[212:215], v[88:91], v[64:67], v[212:215]
    v_mfma_f32_16x16x32_bf16 v[216:219], v[84:87], v[68:71], v[216:219]
    v_mfma_f32_16x16x32_bf16 v[216:219], v[88:91], v[72:75], v[216:219]
    v_mfma_f32_16x16x32_bf16 v[220:223], v[84:87], v[76:79], v[220:223]
    v_mfma_f32_16x16x32_bf16 v[220:223], v[88:91], v[24:27], v[220:223]
    v_mfma_f32_16x16x32_bf16 v[224:227], v[20:23], v[92:95], v[224:227]
    v_mfma_f32_16x16x32_bf16 v[224:227], v[32:35], v[28:31], v[224:227]
    v_mfma_f32_16x16x32_bf16 v[228:231], v[20:23], v[60:63], v[228:231]
    v_mfma_f32_16x16x32_bf16 v[228:231], v[32:35], v[64:67], v[228:231]
    v_mfma_f32_16x16x32_bf16 v[232:235], v[20:23], v[68:71], v[232:235]
    v_mfma_f32_16x16x32_bf16 v[232:235], v[32:35], v[72:75], v[232:235]
    v_mfma_f32_16x16x32_bf16 v[236:239], v[20:23], v[76:79], v[236:239]
    v_mfma_f32_16x16x32_bf16 v[236:239], v[32:35], v[24:27], v[236:239]
    v_mfma_f32_16x16x32_bf16 v[240:243], v[36:39], v[92:95], v[240:243]
    v_mfma_f32_16x16x32_bf16 v[240:243], v[40:43], v[28:31], v[240:243]
    v_mfma_f32_16x16x32_bf16 v[244:247], v[36:39], v[60:63], v[244:247]
    v_mfma_f32_16x16x32_bf16 v[244:247], v[40:43], v[64:67], v[244:247]
    v_mfma_f32_16x16x32_bf16 v[248:251], v[36:39], v[68:71], v[248:251]
    v_mfma_f32_16x16x32_bf16 v[248:251], v[40:43], v[72:75], v[248:251]
    v_mfma_f32_16x16x32_bf16 v[252:255], v[36:39], v[76:79], v[252:255]
    v_mfma_f32_16x16x32_bf16 v[252:255], v[40:43], v[24:27], v[252:255]
    s_waitcnt lgkmcnt(0)
    v_mfma_f32_16x16x32_bf16 v[96:99], v[44:47], v[92:95], v[96:99]
    s_barrier
    ds_read_b64_tr_b16 v[56:57], v16 offset:41472
    v_mfma_f32_16x16x32_bf16 v[96:99], v[48:51], v[28:31], v[96:99]
    ds_read_b64_tr_b16 v[58:59], v16 offset:41984
    v_mfma_f32_16x16x32_bf16 v[100:103], v[44:47], v[60:63], v[100:103]
    ds_read_b128 v[84:87], v12 offset:0
    v_mfma_f32_16x16x32_bf16 v[100:103], v[48:51], v[64:67], v[100:103]
    ds_read_b64_tr_b16 v[88:89], v16 offset:51712
    v_mfma_f32_16x16x32_bf16 v[104:107], v[44:47], v[68:71], v[104:107]
    ds_read_b64_tr_b16 v[90:91], v16 offset:52224
    v_mfma_f32_16x16x32_bf16 v[104:107], v[48:51], v[72:75], v[104:107]
    ds_read_b128 v[20:23], v13 offset:0
    v_mfma_f32_16x16x32_bf16 v[108:111], v[44:47], v[76:79], v[108:111]
    ds_read_b128 v[32:35], v12 offset:2048
    v_mfma_f32_16x16x32_bf16 v[108:111], v[48:51], v[24:27], v[108:111]
    ds_read_b128 v[36:39], v13 offset:2048
    v_mfma_f32_16x16x32_bf16 v[112:115], v[52:55], v[92:95], v[112:115]
    ds_read_b128 v[40:43], v12 offset:4096
    v_mfma_f32_16x16x32_bf16 v[112:115], v[80:83], v[28:31], v[112:115]
    ds_read_b128 v[44:47], v13 offset:4096
    v_mfma_f32_16x16x32_bf16 v[116:119], v[52:55], v[60:63], v[116:119]
    ds_read_b128 v[48:51], v12 offset:6144
    v_mfma_f32_16x16x32_bf16 v[116:119], v[80:83], v[64:67], v[116:119]
    ds_read_b128 v[92:95], v13 offset:6144
    v_mfma_f32_16x16x32_bf16 v[120:123], v[52:55], v[68:71], v[120:123]
    ds_read_b64_tr_b16 v[28:29], v16 offset:43520
    v_mfma_f32_16x16x32_bf16 v[120:123], v[80:83], v[72:75], v[120:123]
    ds_read_b64_tr_b16 v[30:31], v16 offset:44032
    v_mfma_f32_16x16x32_bf16 v[124:127], v[52:55], v[76:79], v[124:127]
    ds_read_b64_tr_b16 v[60:61], v16 offset:53760
    v_mfma_f32_16x16x32_bf16 v[124:127], v[80:83], v[24:27], v[124:127]
    ds_read_b64_tr_b16 v[62:63], v16 offset:54272
    s_waitcnt lgkmcnt(7)
    v_mfma_f32_16x16x32_bf16 v[128:131], v[56:59], v[84:87], v[128:131]
    ds_read_b64_tr_b16 v[64:65], v17 offset:41472
    v_mfma_f32_16x16x32_bf16 v[128:131], v[88:91], v[20:23], v[128:131]
    ds_read_b64_tr_b16 v[66:67], v17 offset:41984
    v_mfma_f32_16x16x32_bf16 v[132:135], v[56:59], v[32:35], v[132:135]
    ds_read_b64_tr_b16 v[68:69], v17 offset:51712
    v_mfma_f32_16x16x32_bf16 v[132:135], v[88:91], v[36:39], v[132:135]
    ds_read_b64_tr_b16 v[70:71], v17 offset:52224
    v_mfma_f32_16x16x32_bf16 v[136:139], v[56:59], v[40:43], v[136:139]
    ds_read_b64_tr_b16 v[72:73], v17 offset:43520
    s_waitcnt lgkmcnt(7)
    v_mfma_f32_16x16x32_bf16 v[136:139], v[88:91], v[44:47], v[136:139]
    ds_read_b64_tr_b16 v[74:75], v17 offset:44032
    v_mfma_f32_16x16x32_bf16 v[140:143], v[56:59], v[48:51], v[140:143]
    ds_read_b64_tr_b16 v[76:77], v17 offset:53760
    v_mfma_f32_16x16x32_bf16 v[140:143], v[88:91], v[92:95], v[140:143]
    ds_read_b64_tr_b16 v[78:79], v17 offset:54272
    v_mfma_f32_16x16x32_bf16 v[144:147], v[28:31], v[84:87], v[144:147]
    ds_read_b64_tr_b16 v[52:53], v18 offset:41472
    s_waitcnt lgkmcnt(7)
    v_mfma_f32_16x16x32_bf16 v[144:147], v[60:63], v[20:23], v[144:147]
    ds_read_b64_tr_b16 v[54:55], v18 offset:41984
    v_mfma_f32_16x16x32_bf16 v[148:151], v[28:31], v[32:35], v[148:151]
    ds_read_b64_tr_b16 v[24:25], v18 offset:51712
    v_mfma_f32_16x16x32_bf16 v[148:151], v[60:63], v[36:39], v[148:151]
    ds_read_b64_tr_b16 v[26:27], v18 offset:52224
    v_mfma_f32_16x16x32_bf16 v[152:155], v[28:31], v[40:43], v[152:155]
    ds_read_b64_tr_b16 v[80:81], v18 offset:43520
    v_mfma_f32_16x16x32_bf16 v[152:155], v[60:63], v[44:47], v[152:155]
    ds_read_b64_tr_b16 v[82:83], v18 offset:44032
    v_mfma_f32_16x16x32_bf16 v[156:159], v[28:31], v[48:51], v[156:159]
    ds_read_b64_tr_b16 v[56:57], v18 offset:53760
    v_mfma_f32_16x16x32_bf16 v[156:159], v[60:63], v[92:95], v[156:159]
    ds_read_b64_tr_b16 v[58:59], v18 offset:54272
    v_mfma_f32_16x16x32_bf16 v[160:163], v[64:67], v[84:87], v[160:163]
    ds_read_b64_tr_b16 v[88:89], v19 offset:41472
    s_waitcnt lgkmcnt(7)
    v_mfma_f32_16x16x32_bf16 v[160:163], v[68:71], v[20:23], v[160:163]
    ds_read_b64_tr_b16 v[90:91], v19 offset:41984
    v_mfma_f32_16x16x32_bf16 v[164:167], v[64:67], v[32:35], v[164:167]
    ds_read_b64_tr_b16 v[28:29], v19 offset:51712
    v_mfma_f32_16x16x32_bf16 v[164:167], v[68:71], v[36:39], v[164:167]
    ds_read_b64_tr_b16 v[30:31], v19 offset:52224
    v_mfma_f32_16x16x32_bf16 v[168:171], v[64:67], v[40:43], v[168:171]
    ds_read_b64_tr_b16 v[60:61], v19 offset:43520
    v_mfma_f32_16x16x32_bf16 v[168:171], v[68:71], v[44:47], v[168:171]
    ds_read_b64_tr_b16 v[62:63], v19 offset:44032
    v_mfma_f32_16x16x32_bf16 v[172:175], v[64:67], v[48:51], v[172:175]
    v_mfma_f32_16x16x32_bf16 v[172:175], v[68:71], v[92:95], v[172:175]
    ds_read_b64_tr_b16 v[64:65], v19 offset:53760
    v_mfma_f32_16x16x32_bf16 v[176:179], v[72:75], v[84:87], v[176:179]
    ds_read_b64_tr_b16 v[66:67], v19 offset:54272
    v_mfma_f32_16x16x32_bf16 v[176:179], v[76:79], v[20:23], v[176:179]
    ds_read_b64_tr_b16 v[68:69], v14 offset:41472
    v_mfma_f32_16x16x32_bf16 v[180:183], v[72:75], v[32:35], v[180:183]
    ds_read_b64_tr_b16 v[70:71], v14 offset:41728
    v_mfma_f32_16x16x32_bf16 v[180:183], v[76:79], v[36:39], v[180:183]
    v_mfma_f32_16x16x32_bf16 v[184:187], v[72:75], v[40:43], v[184:187]
    v_mfma_f32_16x16x32_bf16 v[184:187], v[76:79], v[44:47], v[184:187]
    v_mfma_f32_16x16x32_bf16 v[188:191], v[72:75], v[48:51], v[188:191]
    v_mfma_f32_16x16x32_bf16 v[188:191], v[76:79], v[92:95], v[188:191]
    ds_read_b64_tr_b16 v[72:73], v14 offset:51712
    v_mfma_f32_16x16x32_bf16 v[192:195], v[52:55], v[84:87], v[192:195]
    ds_read_b64_tr_b16 v[74:75], v14 offset:51968
    s_waitcnt lgkmcnt(3)
    v_mfma_f32_16x16x32_bf16 v[192:195], v[24:27], v[20:23], v[192:195]
    ds_read_b64_tr_b16 v[76:77], v15 offset:41472
    v_mfma_f32_16x16x32_bf16 v[196:199], v[52:55], v[32:35], v[196:199]
    ds_read_b64_tr_b16 v[78:79], v15 offset:41728
    v_mfma_f32_16x16x32_bf16 v[196:199], v[24:27], v[36:39], v[196:199]
    s_mov_b64 exec, s[40:41]
    ds_read_b128 v[76:79], v7 offset:256
    s_mov_b64 exec, -1
    v_mfma_f32_16x16x32_bf16 v[200:203], v[52:55], v[40:43], v[200:203]
    v_mfma_f32_16x16x32_bf16 v[200:203], v[24:27], v[44:47], v[200:203]
    v_mfma_f32_16x16x32_bf16 v[204:207], v[52:55], v[48:51], v[204:207]
    v_mfma_f32_16x16x32_bf16 v[204:207], v[24:27], v[92:95], v[204:207]
    ds_read_b64_tr_b16 v[52:53], v15 offset:51712
    v_mfma_f32_16x16x32_bf16 v[208:211], v[80:83], v[84:87], v[208:211]
    ds_read_b64_tr_b16 v[54:55], v15 offset:51968
    v_mfma_f32_16x16x32_bf16 v[208:211], v[56:59], v[20:23], v[208:211]
    s_mov_b64 exec, s[40:41]
    ds_read_b128 v[52:55], v7 offset:320
    s_mov_b64 exec, -1
    v_mfma_f32_16x16x32_bf16 v[212:215], v[80:83], v[32:35], v[212:215]
    v_mfma_f32_16x16x32_bf16 v[212:215], v[56:59], v[36:39], v[212:215]
    v_mfma_f32_16x16x32_bf16 v[216:219], v[80:83], v[40:43], v[216:219]
    v_mfma_f32_16x16x32_bf16 v[216:219], v[56:59], v[44:47], v[216:219]
    v_mfma_f32_16x16x32_bf16 v[220:223], v[80:83], v[48:51], v[220:223]
    v_mfma_f32_16x16x32_bf16 v[220:223], v[56:59], v[92:95], v[220:223]
    v_mfma_f32_16x16x32_bf16 v[224:227], v[88:91], v[84:87], v[224:227]
    v_mfma_f32_16x16x32_bf16 v[224:227], v[28:31], v[20:23], v[224:227]
    v_mfma_f32_16x16x32_bf16 v[228:231], v[88:91], v[32:35], v[228:231]
    v_mfma_f32_16x16x32_bf16 v[228:231], v[28:31], v[36:39], v[228:231]
    v_mfma_f32_16x16x32_bf16 v[232:235], v[88:91], v[40:43], v[232:235]
    v_mfma_f32_16x16x32_bf16 v[232:235], v[28:31], v[44:47], v[232:235]
    v_mfma_f32_16x16x32_bf16 v[236:239], v[88:91], v[48:51], v[236:239]
    v_mfma_f32_16x16x32_bf16 v[236:239], v[28:31], v[92:95], v[236:239]
    v_mfma_f32_16x16x32_bf16 v[240:243], v[60:63], v[84:87], v[240:243]
    v_mfma_f32_16x16x32_bf16 v[240:243], v[64:67], v[20:23], v[240:243]
    v_mfma_f32_16x16x32_bf16 v[244:247], v[60:63], v[32:35], v[244:247]
    v_mfma_f32_16x16x32_bf16 v[244:247], v[64:67], v[36:39], v[244:247]
    v_mfma_f32_16x16x32_bf16 v[248:251], v[60:63], v[40:43], v[248:251]
    v_mfma_f32_16x16x32_bf16 v[248:251], v[64:67], v[44:47], v[248:251]
    v_mfma_f32_16x16x32_bf16 v[252:255], v[60:63], v[48:51], v[252:255]
    v_mfma_f32_16x16x32_bf16 v[252:255], v[64:67], v[92:95], v[252:255]
    s_waitcnt lgkmcnt(0)
    v_mfma_f32_16x16x32_bf16 v[96:99], v[68:71], v[84:87], v[96:99]
    s_barrier
    ds_read_b64_tr_b16 v[24:25], v16 offset:0
    v_mfma_f32_16x16x32_bf16 v[96:99], v[72:75], v[20:23], v[96:99]
    ds_read_b64_tr_b16 v[26:27], v16 offset:512
    v_mfma_f32_16x16x32_bf16 v[100:103], v[68:71], v[32:35], v[100:103]
    ds_read_b128 v[80:83], v10 offset:0
    v_mfma_f32_16x16x32_bf16 v[100:103], v[72:75], v[36:39], v[100:103]
    ds_read_b64_tr_b16 v[56:57], v16 offset:10240
    v_mfma_f32_16x16x32_bf16 v[104:107], v[68:71], v[40:43], v[104:107]
    ds_read_b64_tr_b16 v[58:59], v16 offset:10752
    v_mfma_f32_16x16x32_bf16 v[104:107], v[72:75], v[44:47], v[104:107]
    ds_read_b128 v[88:91], v11 offset:0
    v_mfma_f32_16x16x32_bf16 v[108:111], v[68:71], v[48:51], v[108:111]
    ds_read_b128 v[28:31], v10 offset:2048
    v_mfma_f32_16x16x32_bf16 v[108:111], v[72:75], v[92:95], v[108:111]
    ds_read_b128 v[60:63], v11 offset:2048
    v_mfma_f32_16x16x32_bf16 v[112:115], v[76:79], v[84:87], v[112:115]
    ds_read_b128 v[64:67], v10 offset:4096
    v_mfma_f32_16x16x32_bf16 v[112:115], v[52:55], v[20:23], v[112:115]
    ds_read_b128 v[68:71], v11 offset:4096
    v_mfma_f32_16x16x32_bf16 v[116:119], v[76:79], v[32:35], v[116:119]
    ds_read_b128 v[72:75], v10 offset:6144
    v_mfma_f32_16x16x32_bf16 v[116:119], v[52:55], v[36:39], v[116:119]
    ds_read_b128 v[84:87], v11 offset:6144
    v_mfma_f32_16x16x32_bf16 v[120:123], v[76:79], v[40:43], v[120:123]
    ds_read_b64_tr_b16 v[20:21], v16 offset:2048
    v_mfma_f32_16x16x32_bf16 v[120:123], v[52:55], v[44:47], v[120:123]
    ds_read_b64_tr_b16 v[22:23], v16 offset:2560
    v_mfma_f32_16x16x32_bf16 v[124:127], v[76:79], v[48:51], v[124:127]
    ds_read_b64_tr_b16 v[32:33], v16 offset:12288
    v_mfma_f32_16x16x32_bf16 v[124:127], v[52:55], v[92:95], v[124:127]
    ds_read_b64_tr_b16 v[34:35], v16 offset:12800
    s_waitcnt lgkmcnt(7)
    v_mfma_f32_16x16x32_bf16 v[128:131], v[24:27], v[80:83], v[128:131]
    ds_read_b64_tr_b16 v[36:37], v17 offset:0
    v_mfma_f32_16x16x32_bf16 v[128:131], v[56:59], v[88:91], v[128:131]
    ds_read_b64_tr_b16 v[38:39], v17 offset:512
    v_mfma_f32_16x16x32_bf16 v[132:135], v[24:27], v[28:31], v[132:135]
    ds_read_b64_tr_b16 v[40:41], v17 offset:10240
    v_mfma_f32_16x16x32_bf16 v[132:135], v[56:59], v[60:63], v[132:135]
    ds_read_b64_tr_b16 v[42:43], v17 offset:10752
    v_mfma_f32_16x16x32_bf16 v[136:139], v[24:27], v[64:67], v[136:139]
    ds_read_b64_tr_b16 v[44:45], v17 offset:2048
    s_waitcnt lgkmcnt(7)
    v_mfma_f32_16x16x32_bf16 v[136:139], v[56:59], v[68:71], v[136:139]
    ds_read_b64_tr_b16 v[46:47], v17 offset:2560
    v_mfma_f32_16x16x32_bf16 v[140:143], v[24:27], v[72:75], v[140:143]
    ds_read_b64_tr_b16 v[48:49], v17 offset:12288
    v_mfma_f32_16x16x32_bf16 v[140:143], v[56:59], v[84:87], v[140:143]
    ds_read_b64_tr_b16 v[50:51], v17 offset:12800
    v_mfma_f32_16x16x32_bf16 v[144:147], v[20:23], v[80:83], v[144:147]
    ds_read_b64_tr_b16 v[76:77], v18 offset:0
    s_waitcnt lgkmcnt(7)
    v_mfma_f32_16x16x32_bf16 v[144:147], v[32:35], v[88:91], v[144:147]
    ds_read_b64_tr_b16 v[78:79], v18 offset:512
    v_mfma_f32_16x16x32_bf16 v[148:151], v[20:23], v[28:31], v[148:151]
    ds_read_b64_tr_b16 v[92:93], v18 offset:10240
    v_mfma_f32_16x16x32_bf16 v[148:151], v[32:35], v[60:63], v[148:151]
    ds_read_b64_tr_b16 v[94:95], v18 offset:10752
    v_mfma_f32_16x16x32_bf16 v[152:155], v[20:23], v[64:67], v[152:155]
    ds_read_b64_tr_b16 v[52:53], v18 offset:2048
    v_mfma_f32_16x16x32_bf16 v[152:155], v[32:35], v[68:71], v[152:155]
    ds_read_b64_tr_b16 v[54:55], v18 offset:2560
    v_mfma_f32_16x16x32_bf16 v[156:159], v[20:23], v[72:75], v[156:159]
    ds_read_b64_tr_b16 v[24:25], v18 offset:12288
    v_mfma_f32_16x16x32_bf16 v[156:159], v[32:35], v[84:87], v[156:159]
    ds_read_b64_tr_b16 v[26:27], v18 offset:12800
    v_mfma_f32_16x16x32_bf16 v[160:163], v[36:39], v[80:83], v[160:163]
    ds_read_b64_tr_b16 v[56:57], v19 offset:0
    s_waitcnt lgkmcnt(7)
    v_mfma_f32_16x16x32_bf16 v[160:163], v[40:43], v[88:91], v[160:163]
    ds_read_b64_tr_b16 v[58:59], v19 offset:512
    v_mfma_f32_16x16x32_bf16 v[164:167], v[36:39], v[28:31], v[164:167]
    ds_read_b64_tr_b16 v[20:21], v19 offset:10240
    v_mfma_f32_16x16x32_bf16 v[164:167], v[40:43], v[60:63], v[164:167]
    ds_read_b64_tr_b16 v[22:23], v19 offset:10752
    v_mfma_f32_16x16x32_bf16 v[168:171], v[36:39], v[64:67], v[168:171]
    ds_read_b64_tr_b16 v[32:33], v19 offset:2048
    v_mfma_f32_16x16x32_bf16 v[168:171], v[40:43], v[68:71], v[168:171]
    ds_read_b64_tr_b16 v[34:35], v19 offset:2560
    v_mfma_f32_16x16x32_bf16 v[172:175], v[36:39], v[72:75], v[172:175]
    v_mfma_f32_16x16x32_bf16 v[172:175], v[40:43], v[84:87], v[172:175]
    ds_read_b64_tr_b16 v[36:37], v19 offset:12288
    v_mfma_f32_16x16x32_bf16 v[176:179], v[44:47], v[80:83], v[176:179]
    ds_read_b64_tr_b16 v[38:39], v19 offset:12800
    v_mfma_f32_16x16x32_bf16 v[176:179], v[48:51], v[88:91], v[176:179]
    ds_read_b64_tr_b16 v[40:41], v14 offset:0
    v_mfma_f32_16x16x32_bf16 v[180:183], v[44:47], v[28:31], v[180:183]
    ds_read_b64_tr_b16 v[42:43], v14 offset:256
    v_mfma_f32_16x16x32_bf16 v[180:183], v[48:51], v[60:63], v[180:183]
    v_mfma_f32_16x16x32_bf16 v[184:187], v[44:47], v[64:67], v[184:187]
    v_mfma_f32_16x16x32_bf16 v[184:187], v[48:51], v[68:71], v[184:187]
    v_mfma_f32_16x16x32_bf16 v[188:191], v[44:47], v[72:75], v[188:191]
    v_mfma_f32_16x16x32_bf16 v[188:191], v[48:51], v[84:87], v[188:191]
    ds_read_b64_tr_b16 v[44:45], v14 offset:10240
    v_mfma_f32_16x16x32_bf16 v[192:195], v[76:79], v[80:83], v[192:195]
    ds_read_b64_tr_b16 v[46:47], v14 offset:10496
    s_waitcnt lgkmcnt(3)
    v_mfma_f32_16x16x32_bf16 v[192:195], v[92:95], v[88:91], v[192:195]
    ds_read_b64_tr_b16 v[48:49], v15 offset:0
    v_mfma_f32_16x16x32_bf16 v[196:199], v[76:79], v[28:31], v[196:199]
    ds_read_b64_tr_b16 v[50:51], v15 offset:256
    v_mfma_f32_16x16x32_bf16 v[196:199], v[92:95], v[60:63], v[196:199]
    s_mov_b64 exec, s[40:41]
    ds_read_b128 v[48:51], v7 offset:384
    s_mov_b64 exec, -1
    v_mfma_f32_16x16x32_bf16 v[200:203], v[76:79], v[64:67], v[200:203]
    v_mfma_f32_16x16x32_bf16 v[200:203], v[92:95], v[68:71], v[200:203]
    v_mfma_f32_16x16x32_bf16 v[204:207], v[76:79], v[72:75], v[204:207]
    v_mfma_f32_16x16x32_bf16 v[204:207], v[92:95], v[84:87], v[204:207]
    ds_read_b64_tr_b16 v[76:77], v15 offset:10240
    v_mfma_f32_16x16x32_bf16 v[208:211], v[52:55], v[80:83], v[208:211]
    ds_read_b64_tr_b16 v[78:79], v15 offset:10496
    v_mfma_f32_16x16x32_bf16 v[208:211], v[24:27], v[88:91], v[208:211]
    s_mov_b64 exec, s[40:41]
    ds_read_b128 v[76:79], v7 offset:448
    s_mov_b64 exec, -1
    v_mfma_f32_16x16x32_bf16 v[212:215], v[52:55], v[28:31], v[212:215]
    v_mfma_f32_16x16x32_bf16 v[212:215], v[24:27], v[60:63], v[212:215]
    v_mfma_f32_16x16x32_bf16 v[216:219], v[52:55], v[64:67], v[216:219]
    v_mfma_f32_16x16x32_bf16 v[216:219], v[24:27], v[68:71], v[216:219]
    v_mfma_f32_16x16x32_bf16 v[220:223], v[52:55], v[72:75], v[220:223]
    v_mfma_f32_16x16x32_bf16 v[220:223], v[24:27], v[84:87], v[220:223]
    v_mfma_f32_16x16x32_bf16 v[224:227], v[56:59], v[80:83], v[224:227]
    v_mfma_f32_16x16x32_bf16 v[224:227], v[20:23], v[88:91], v[224:227]
    v_mfma_f32_16x16x32_bf16 v[228:231], v[56:59], v[28:31], v[228:231]
    v_mfma_f32_16x16x32_bf16 v[228:231], v[20:23], v[60:63], v[228:231]
    v_mfma_f32_16x16x32_bf16 v[232:235], v[56:59], v[64:67], v[232:235]
    v_mfma_f32_16x16x32_bf16 v[232:235], v[20:23], v[68:71], v[232:235]
    v_mfma_f32_16x16x32_bf16 v[236:239], v[56:59], v[72:75], v[236:239]
    v_mfma_f32_16x16x32_bf16 v[236:239], v[20:23], v[84:87], v[236:239]
    v_mfma_f32_16x16x32_bf16 v[240:243], v[32:35], v[80:83], v[240:243]
    v_mfma_f32_16x16x32_bf16 v[240:243], v[36:39], v[88:91], v[240:243]
    v_mfma_f32_16x16x32_bf16 v[244:247], v[32:35], v[28:31], v[244:247]
    v_mfma_f32_16x16x32_bf16 v[244:247], v[36:39], v[60:63], v[244:247]
    v_mfma_f32_16x16x32_bf16 v[248:251], v[32:35], v[64:67], v[248:251]
    v_mfma_f32_16x16x32_bf16 v[248:251], v[36:39], v[68:71], v[248:251]
    v_mfma_f32_16x16x32_bf16 v[252:255], v[32:35], v[72:75], v[252:255]
    v_mfma_f32_16x16x32_bf16 v[252:255], v[36:39], v[84:87], v[252:255]
    s_waitcnt lgkmcnt(0)
    v_mfma_f32_16x16x32_bf16 v[96:99], v[40:43], v[80:83], v[96:99]
    s_barrier
    ds_read_b64_tr_b16 v[92:93], v16 offset:20736
    v_mfma_f32_16x16x32_bf16 v[96:99], v[44:47], v[88:91], v[96:99]
    ds_read_b64_tr_b16 v[94:95], v16 offset:21248
    v_mfma_f32_16x16x32_bf16 v[100:103], v[40:43], v[28:31], v[100:103]
    ds_read_b128 v[52:55], v10 offset:32768
    v_mfma_f32_16x16x32_bf16 v[100:103], v[44:47], v[60:63], v[100:103]
    ds_read_b64_tr_b16 v[24:25], v16 offset:30976
    v_mfma_f32_16x16x32_bf16 v[104:107], v[40:43], v[64:67], v[104:107]
    ds_read_b64_tr_b16 v[26:27], v16 offset:31488
    v_mfma_f32_16x16x32_bf16 v[104:107], v[44:47], v[68:71], v[104:107]
    ds_read_b128 v[56:59], v11 offset:32768
    v_mfma_f32_16x16x32_bf16 v[108:111], v[40:43], v[72:75], v[108:111]
    ds_read_b128 v[20:23], v10 offset:34816
    v_mfma_f32_16x16x32_bf16 v[108:111], v[44:47], v[84:87], v[108:111]
    ds_read_b128 v[32:35], v11 offset:34816
    v_mfma_f32_16x16x32_bf16 v[112:115], v[48:51], v[80:83], v[112:115]
    ds_read_b128 v[36:39], v10 offset:36864
    v_mfma_f32_16x16x32_bf16 v[112:115], v[76:79], v[88:91], v[112:115]
    ds_read_b128 v[40:43], v11 offset:36864
    v_mfma_f32_16x16x32_bf16 v[116:119], v[48:51], v[28:31], v[116:119]
    ds_read_b128 v[44:47], v10 offset:38912
    v_mfma_f32_16x16x32_bf16 v[116:119], v[76:79], v[60:63], v[116:119]
    ds_read_b128 v[80:83], v11 offset:38912
    v_mfma_f32_16x16x32_bf16 v[120:123], v[48:51], v[64:67], v[120:123]
    ds_read_b64_tr_b16 v[88:89], v16 offset:22784
    v_mfma_f32_16x16x32_bf16 v[120:123], v[76:79], v[68:71], v[120:123]
    ds_read_b64_tr_b16 v[90:91], v16 offset:23296
    v_mfma_f32_16x16x32_bf16 v[124:127], v[48:51], v[72:75], v[124:127]
    ds_read_b64_tr_b16 v[28:29], v16 offset:33024
    v_mfma_f32_16x16x32_bf16 v[124:127], v[76:79], v[84:87], v[124:127]
    ds_read_b64_tr_b16 v[30:31], v16 offset:33536
    s_waitcnt lgkmcnt(7)
    v_mfma_f32_16x16x32_bf16 v[128:131], v[92:95], v[52:55], v[128:131]
    ds_read_b64_tr_b16 v[60:61], v17 offset:20736
    v_mfma_f32_16x16x32_bf16 v[128:131], v[24:27], v[56:59], v[128:131]
    ds_read_b64_tr_b16 v[62:63], v17 offset:21248
    v_mfma_f32_16x16x32_bf16 v[132:135], v[92:95], v[20:23], v[132:135]
    ds_read_b64_tr_b16 v[64:65], v17 offset:30976
    v_mfma_f32_16x16x32_bf16 v[132:135], v[24:27], v[32:35], v[132:135]
    ds_read_b64_tr_b16 v[66:67], v17 offset:31488
    v_mfma_f32_16x16x32_bf16 v[136:139], v[92:95], v[36:39], v[136:139]
    ds_read_b64_tr_b16 v[68:69], v17 offset:22784
    s_waitcnt lgkmcnt(7)
    v_mfma_f32_16x16x32_bf16 v[136:139], v[24:27], v[40:43], v[136:139]
    ds_read_b64_tr_b16 v[70:71], v17 offset:23296
    v_mfma_f32_16x16x32_bf16 v[140:143], v[92:95], v[44:47], v[140:143]
    ds_read_b64_tr_b16 v[72:73], v17 offset:33024
    v_mfma_f32_16x16x32_bf16 v[140:143], v[24:27], v[80:83], v[140:143]
    ds_read_b64_tr_b16 v[74:75], v17 offset:33536
    v_mfma_f32_16x16x32_bf16 v[144:147], v[88:91], v[52:55], v[144:147]
    ds_read_b64_tr_b16 v[48:49], v18 offset:20736
    s_waitcnt lgkmcnt(7)
    v_mfma_f32_16x16x32_bf16 v[144:147], v[28:31], v[56:59], v[144:147]
    ds_read_b64_tr_b16 v[50:51], v18 offset:21248
    v_mfma_f32_16x16x32_bf16 v[148:151], v[88:91], v[20:23], v[148:151]
    ds_read_b64_tr_b16 v[84:85], v18 offset:30976
    v_mfma_f32_16x16x32_bf16 v[148:151], v[28:31], v[32:35], v[148:151]
    ds_read_b64_tr_b16 v[86:87], v18 offset:31488
    v_mfma_f32_16x16x32_bf16 v[152:155], v[88:91], v[36:39], v[152:155]
    ds_read_b64_tr_b16 v[76:77], v18 offset:22784
    v_mfma_f32_16x16x32_bf16 v[152:155], v[28:31], v[40:43], v[152:155]
    ds_read_b64_tr_b16 v[78:79], v18 offset:23296
    v_mfma_f32_16x16x32_bf16 v[156:159], v[88:91], v[44:47], v[156:159]
    ds_read_b64_tr_b16 v[92:93], v18 offset:33024
    v_mfma_f32_16x16x32_bf16 v[156:159], v[28:31], v[80:83], v[156:159]
    ds_read_b64_tr_b16 v[94:95], v18 offset:33536
    v_mfma_f32_16x16x32_bf16 v[160:163], v[60:63], v[52:55], v[160:163]
    ds_read_b64_tr_b16 v[24:25], v19 offset:20736
    s_waitcnt lgkmcnt(7)
    v_mfma_f32_16x16x32_bf16 v[160:163], v[64:67], v[56:59], v[160:163]
    ds_read_b64_tr_b16 v[26:27], v19 offset:21248
    v_mfma_f32_16x16x32_bf16 v[164:167], v[60:63], v[20:23], v[164:167]
    ds_read_b64_tr_b16 v[88:89], v19 offset:30976
    v_mfma_f32_16x16x32_bf16 v[164:167], v[64:67], v[32:35], v[164:167]
    ds_read_b64_tr_b16 v[90:91], v19 offset:31488
    v_mfma_f32_16x16x32_bf16 v[168:171], v[60:63], v[36:39], v[168:171]
    ds_read_b64_tr_b16 v[28:29], v19 offset:22784
    v_mfma_f32_16x16x32_bf16 v[168:171], v[64:67], v[40:43], v[168:171]
    ds_read_b64_tr_b16 v[30:31], v19 offset:23296
    v_mfma_f32_16x16x32_bf16 v[172:175], v[60:63], v[44:47], v[172:175]
    v_mfma_f32_16x16x32_bf16 v[172:175], v[64:67], v[80:83], v[172:175]
    ds_read_b64_tr_b16 v[60:61], v19 offset:33024
    v_mfma_f32_16x16x32_bf16 v[176:179], v[68:71], v[52:55], v[176:179]
    ds_read_b64_tr_b16 v[62:63], v19 offset:33536
    v_mfma_f32_16x16x32_bf16 v[176:179], v[72:75], v[56:59], v[176:179]
    ds_read_b64_tr_b16 v[64:65], v14 offset:20736
    v_mfma_f32_16x16x32_bf16 v[180:183], v[68:71], v[20:23], v[180:183]
    ds_read_b64_tr_b16 v[66:67], v14 offset:20992
    v_mfma_f32_16x16x32_bf16 v[180:183], v[72:75], v[32:35], v[180:183]
    v_mfma_f32_16x16x32_bf16 v[184:187], v[68:71], v[36:39], v[184:187]
    v_mfma_f32_16x16x32_bf16 v[184:187], v[72:75], v[40:43], v[184:187]
    v_mfma_f32_16x16x32_bf16 v[188:191], v[68:71], v[44:47], v[188:191]
    v_mfma_f32_16x16x32_bf16 v[188:191], v[72:75], v[80:83], v[188:191]
    ds_read_b64_tr_b16 v[68:69], v14 offset:30976
    v_mfma_f32_16x16x32_bf16 v[192:195], v[48:51], v[52:55], v[192:195]
    ds_read_b64_tr_b16 v[70:71], v14 offset:31232
    s_waitcnt lgkmcnt(3)
    v_mfma_f32_16x16x32_bf16 v[192:195], v[84:87], v[56:59], v[192:195]
    ds_read_b64_tr_b16 v[72:73], v15 offset:20736
    v_mfma_f32_16x16x32_bf16 v[196:199], v[48:51], v[20:23], v[196:199]
    ds_read_b64_tr_b16 v[74:75], v15 offset:20992
    v_mfma_f32_16x16x32_bf16 v[196:199], v[84:87], v[32:35], v[196:199]
    s_mov_b64 exec, s[40:41]
    ds_read_b128 v[72:75], v7 offset:512
    s_mov_b64 exec, -1
    v_mfma_f32_16x16x32_bf16 v[200:203], v[48:51], v[36:39], v[200:203]
    v_mfma_f32_16x16x32_bf16 v[200:203], v[84:87], v[40:43], v[200:203]
    v_mfma_f32_16x16x32_bf16 v[204:207], v[48:51], v[44:47], v[204:207]
    v_mfma_f32_16x16x32_bf16 v[204:207], v[84:87], v[80:83], v[204:207]
    ds_read_b64_tr_b16 v[48:49], v15 offset:30976
    v_mfma_f32_16x16x32_bf16 v[208:211], v[76:79], v[52:55], v[208:211]
    ds_read_b64_tr_b16 v[50:51], v15 offset:31232
    v_mfma_f32_16x16x32_bf16 v[208:211], v[92:95], v[56:59], v[208:211]
    s_mov_b64 exec, s[40:41]
    ds_read_b128 v[48:51], v7 offset:576
    s_mov_b64 exec, -1
    v_mfma_f32_16x16x32_bf16 v[212:215], v[76:79], v[20:23], v[212:215]
    v_mfma_f32_16x16x32_bf16 v[212:215], v[92:95], v[32:35], v[212:215]
    v_mfma_f32_16x16x32_bf16 v[216:219], v[76:79], v[36:39], v[216:219]
    v_mfma_f32_16x16x32_bf16 v[216:219], v[92:95], v[40:43], v[216:219]
    v_mfma_f32_16x16x32_bf16 v[220:223], v[76:79], v[44:47], v[220:223]
    v_mfma_f32_16x16x32_bf16 v[220:223], v[92:95], v[80:83], v[220:223]
    v_mfma_f32_16x16x32_bf16 v[224:227], v[24:27], v[52:55], v[224:227]
    v_mfma_f32_16x16x32_bf16 v[224:227], v[88:91], v[56:59], v[224:227]
    v_mfma_f32_16x16x32_bf16 v[228:231], v[24:27], v[20:23], v[228:231]
    v_mfma_f32_16x16x32_bf16 v[228:231], v[88:91], v[32:35], v[228:231]
    v_mfma_f32_16x16x32_bf16 v[232:235], v[24:27], v[36:39], v[232:235]
    v_mfma_f32_16x16x32_bf16 v[232:235], v[88:91], v[40:43], v[232:235]
    v_mfma_f32_16x16x32_bf16 v[236:239], v[24:27], v[44:47], v[236:239]
    v_mfma_f32_16x16x32_bf16 v[236:239], v[88:91], v[80:83], v[236:239]
    v_mfma_f32_16x16x32_bf16 v[240:243], v[28:31], v[52:55], v[240:243]
    v_mfma_f32_16x16x32_bf16 v[240:243], v[60:63], v[56:59], v[240:243]
    v_mfma_f32_16x16x32_bf16 v[244:247], v[28:31], v[20:23], v[244:247]
    v_mfma_f32_16x16x32_bf16 v[244:247], v[60:63], v[32:35], v[244:247]
    v_mfma_f32_16x16x32_bf16 v[248:251], v[28:31], v[36:39], v[248:251]
    v_mfma_f32_16x16x32_bf16 v[248:251], v[60:63], v[40:43], v[248:251]
    v_mfma_f32_16x16x32_bf16 v[252:255], v[28:31], v[44:47], v[252:255]
    v_mfma_f32_16x16x32_bf16 v[252:255], v[60:63], v[80:83], v[252:255]
    s_waitcnt lgkmcnt(0)
    v_mfma_f32_16x16x32_bf16 v[96:99], v[64:67], v[52:55], v[96:99]
    s_barrier
    ds_read_b64_tr_b16 v[84:85], v16 offset:41472
    v_mfma_f32_16x16x32_bf16 v[96:99], v[68:71], v[56:59], v[96:99]
    ds_read_b64_tr_b16 v[86:87], v16 offset:41984
    v_mfma_f32_16x16x32_bf16 v[100:103], v[64:67], v[20:23], v[100:103]
    ds_read_b128 v[76:79], v12 offset:0
    v_mfma_f32_16x16x32_bf16 v[100:103], v[68:71], v[32:35], v[100:103]
    ds_read_b64_tr_b16 v[92:93], v16 offset:51712
    v_mfma_f32_16x16x32_bf16 v[104:107], v[64:67], v[36:39], v[104:107]
    ds_read_b64_tr_b16 v[94:95], v16 offset:52224
    v_mfma_f32_16x16x32_bf16 v[104:107], v[68:71], v[40:43], v[104:107]
    ds_read_b128 v[24:27], v13 offset:0
    v_mfma_f32_16x16x32_bf16 v[108:111], v[64:67], v[44:47], v[108:111]
    ds_read_b128 v[88:91], v12 offset:2048
    v_mfma_f32_16x16x32_bf16 v[108:111], v[68:71], v[80:83], v[108:111]
    ds_read_b128 v[28:31], v13 offset:2048
    v_mfma_f32_16x16x32_bf16 v[112:115], v[72:75], v[52:55], v[112:115]
    ds_read_b128 v[60:63], v12 offset:4096
    v_mfma_f32_16x16x32_bf16 v[112:115], v[48:51], v[56:59], v[112:115]
    ds_read_b128 v[64:67], v13 offset:4096
    v_mfma_f32_16x16x32_bf16 v[116:119], v[72:75], v[20:23], v[116:119]
    ds_read_b128 v[68:71], v12 offset:6144
    v_mfma_f32_16x16x32_bf16 v[116:119], v[48:51], v[32:35], v[116:119]
    ds_read_b128 v[52:55], v13 offset:6144
    v_mfma_f32_16x16x32_bf16 v[120:123], v[72:75], v[36:39], v[120:123]
    ds_read_b64_tr_b16 v[56:57], v16 offset:43520
    v_mfma_f32_16x16x32_bf16 v[120:123], v[48:51], v[40:43], v[120:123]
    ds_read_b64_tr_b16 v[58:59], v16 offset:44032
    v_mfma_f32_16x16x32_bf16 v[124:127], v[72:75], v[44:47], v[124:127]
    ds_read_b64_tr_b16 v[20:21], v16 offset:53760
    v_mfma_f32_16x16x32_bf16 v[124:127], v[48:51], v[80:83], v[124:127]
    ds_read_b64_tr_b16 v[22:23], v16 offset:54272
    s_waitcnt lgkmcnt(7)
    v_mfma_f32_16x16x32_bf16 v[128:131], v[84:87], v[76:79], v[128:131]
    ds_read_b64_tr_b16 v[32:33], v17 offset:41472
    v_mfma_f32_16x16x32_bf16 v[128:131], v[92:95], v[24:27], v[128:131]
    ds_read_b64_tr_b16 v[34:35], v17 offset:41984
    v_mfma_f32_16x16x32_bf16 v[132:135], v[84:87], v[88:91], v[132:135]
    ds_read_b64_tr_b16 v[36:37], v17 offset:51712
    v_mfma_f32_16x16x32_bf16 v[132:135], v[92:95], v[28:31], v[132:135]
    ds_read_b64_tr_b16 v[38:39], v17 offset:52224
    v_mfma_f32_16x16x32_bf16 v[136:139], v[84:87], v[60:63], v[136:139]
    ds_read_b64_tr_b16 v[40:41], v17 offset:43520
    s_waitcnt lgkmcnt(7)
    v_mfma_f32_16x16x32_bf16 v[136:139], v[92:95], v[64:67], v[136:139]
    ds_read_b64_tr_b16 v[42:43], v17 offset:44032
    v_mfma_f32_16x16x32_bf16 v[140:143], v[84:87], v[68:71], v[140:143]
    ds_read_b64_tr_b16 v[44:45], v17 offset:53760
    v_mfma_f32_16x16x32_bf16 v[140:143], v[92:95], v[52:55], v[140:143]
    ds_read_b64_tr_b16 v[46:47], v17 offset:54272
    v_mfma_f32_16x16x32_bf16 v[144:147], v[56:59], v[76:79], v[144:147]
    ds_read_b64_tr_b16 v[72:73], v18 offset:41472
    s_waitcnt lgkmcnt(7)
    v_mfma_f32_16x16x32_bf16 v[144:147], v[20:23], v[24:27], v[144:147]
    ds_read_b64_tr_b16 v[74:75], v18 offset:41984
    v_mfma_f32_16x16x32_bf16 v[148:151], v[56:59], v[88:91], v[148:151]
    ds_read_b64_tr_b16 v[80:81], v18 offset:51712
    v_mfma_f32_16x16x32_bf16 v[148:151], v[20:23], v[28:31], v[148:151]
    ds_read_b64_tr_b16 v[82:83], v18 offset:52224
    v_mfma_f32_16x16x32_bf16 v[152:155], v[56:59], v[60:63], v[152:155]
    ds_read_b64_tr_b16 v[48:49], v18 offset:43520
    v_mfma_f32_16x16x32_bf16 v[152:155], v[20:23], v[64:67], v[152:155]
    ds_read_b64_tr_b16 v[50:51], v18 offset:44032
    v_mfma_f32_16x16x32_bf16 v[156:159], v[56:59], v[68:71], v[156:159]
    ds_read_b64_tr_b16 v[84:85], v18 offset:53760
    v_mfma_f32_16x16x32_bf16 v[156:159], v[20:23], v[52:55], v[156:159]
    ds_read_b64_tr_b16 v[86:87], v18 offset:54272
    v_mfma_f32_16x16x32_bf16 v[160:163], v[32:35], v[76:79], v[160:163]
    ds_read_b64_tr_b16 v[92:93], v19 offset:41472
    s_waitcnt lgkmcnt(7)
    v_mfma_f32_16x16x32_bf16 v[160:163], v[36:39], v[24:27], v[160:163]
    ds_read_b64_tr_b16 v[94:95], v19 offset:41984
    v_mfma_f32_16x16x32_bf16 v[164:167], v[32:35], v[88:91], v[164:167]
    ds_read_b64_tr_b16 v[56:57], v19 offset:51712
    v_mfma_f32_16x16x32_bf16 v[164:167], v[36:39], v[28:31], v[164:167]
    ds_read_b64_tr_b16 v[58:59], v19 offset:52224
    v_mfma_f32_16x16x32_bf16 v[168:171], v[32:35], v[60:63], v[168:171]
    ds_read_b64_tr_b16 v[20:21], v19 offset:43520
    v_mfma_f32_16x16x32_bf16 v[168:171], v[36:39], v[64:67], v[168:171]
    ds_read_b64_tr_b16 v[22:23], v19 offset:44032
    v_mfma_f32_16x16x32_bf16 v[172:175], v[32:35], v[68:71], v[172:175]
    v_mfma_f32_16x16x32_bf16 v[172:175], v[36:39], v[52:55], v[172:175]
    ds_read_b64_tr_b16 v[32:33], v19 offset:53760
    v_mfma_f32_16x16x32_bf16 v[176:179], v[40:43], v[76:79], v[176:179]
    ds_read_b64_tr_b16 v[34:35], v19 offset:54272
    v_mfma_f32_16x16x32_bf16 v[176:179], v[44:47], v[24:27], v[176:179]
    ds_read_b64_tr_b16 v[36:37], v14 offset:41472
    v_mfma_f32_16x16x32_bf16 v[180:183], v[40:43], v[88:91], v[180:183]
    ds_read_b64_tr_b16 v[38:39], v14 offset:41728
    v_mfma_f32_16x16x32_bf16 v[180:183], v[44:47], v[28:31], v[180:183]
    v_mfma_f32_16x16x32_bf16 v[184:187], v[40:43], v[60:63], v[184:187]
    v_mfma_f32_16x16x32_bf16 v[184:187], v[44:47], v[64:67], v[184:187]
    v_mfma_f32_16x16x32_bf16 v[188:191], v[40:43], v[68:71], v[188:191]
    s_mov_b64 exec, 1
    buffer_load_dword v4, v1, s[44:47], 0 offen
    s_mov_b64 exec, -1
    s_add_u32 s72, s63, s69
    s_add_u32 s73, s64, s69
    v_mfma_f32_16x16x32_bf16 v[188:191], v[44:47], v[52:55], v[188:191]
    ds_read_b64_tr_b16 v[40:41], v14 offset:51712
    v_mfma_f32_16x16x32_bf16 v[192:195], v[72:75], v[76:79], v[192:195]
    ds_read_b64_tr_b16 v[42:43], v14 offset:51968
    s_waitcnt lgkmcnt(3)
    v_mfma_f32_16x16x32_bf16 v[192:195], v[80:83], v[24:27], v[192:195]
    ds_read_b64_tr_b16 v[44:45], v15 offset:41472
    v_mfma_f32_16x16x32_bf16 v[196:199], v[72:75], v[88:91], v[196:199]
    ds_read_b64_tr_b16 v[46:47], v15 offset:41728
    v_mfma_f32_16x16x32_bf16 v[196:199], v[80:83], v[28:31], v[196:199]
    s_mov_b64 exec, s[40:41]
    ds_read_b128 v[44:47], v7 offset:640
    s_mov_b64 exec, -1
    v_mfma_f32_16x16x32_bf16 v[200:203], v[72:75], v[60:63], v[200:203]
    v_mfma_f32_16x16x32_bf16 v[200:203], v[80:83], v[64:67], v[200:203]
    v_mfma_f32_16x16x32_bf16 v[204:207], v[72:75], v[68:71], v[204:207]
    v_mfma_f32_16x16x32_bf16 v[204:207], v[80:83], v[52:55], v[204:207]
    ds_read_b64_tr_b16 v[72:73], v15 offset:51712
    v_mfma_f32_16x16x32_bf16 v[208:211], v[48:51], v[76:79], v[208:211]
    ds_read_b64_tr_b16 v[74:75], v15 offset:51968
    v_mfma_f32_16x16x32_bf16 v[208:211], v[84:87], v[24:27], v[208:211]
    s_mov_b64 exec, s[40:41]
    ds_read_b128 v[72:75], v7 offset:704
    s_mov_b64 exec, -1
    v_mfma_f32_16x16x32_bf16 v[212:215], v[48:51], v[88:91], v[212:215]
    v_mfma_f32_16x16x32_bf16 v[212:215], v[84:87], v[28:31], v[212:215]
    v_mfma_f32_16x16x32_bf16 v[216:219], v[48:51], v[60:63], v[216:219]
    v_mfma_f32_16x16x32_bf16 v[216:219], v[84:87], v[64:67], v[216:219]
    v_mfma_f32_16x16x32_bf16 v[220:223], v[48:51], v[68:71], v[220:223]
    v_mfma_f32_16x16x32_bf16 v[220:223], v[84:87], v[52:55], v[220:223]
    v_mfma_f32_16x16x32_bf16 v[224:227], v[92:95], v[76:79], v[224:227]
    v_mfma_f32_16x16x32_bf16 v[224:227], v[56:59], v[24:27], v[224:227]
    v_mfma_f32_16x16x32_bf16 v[228:231], v[92:95], v[88:91], v[228:231]
    v_mfma_f32_16x16x32_bf16 v[228:231], v[56:59], v[28:31], v[228:231]
    v_mfma_f32_16x16x32_bf16 v[232:235], v[92:95], v[60:63], v[232:235]
    v_mfma_f32_16x16x32_bf16 v[232:235], v[56:59], v[64:67], v[232:235]
    v_mfma_f32_16x16x32_bf16 v[236:239], v[92:95], v[68:71], v[236:239]
    v_mfma_f32_16x16x32_bf16 v[236:239], v[56:59], v[52:55], v[236:239]
    v_mfma_f32_16x16x32_bf16 v[240:243], v[20:23], v[76:79], v[240:243]
    v_mfma_f32_16x16x32_bf16 v[240:243], v[32:35], v[24:27], v[240:243]
    v_mfma_f32_16x16x32_bf16 v[244:247], v[20:23], v[88:91], v[244:247]
    v_mfma_f32_16x16x32_bf16 v[244:247], v[32:35], v[28:31], v[244:247]
    v_mfma_f32_16x16x32_bf16 v[248:251], v[20:23], v[60:63], v[248:251]
    v_mfma_f32_16x16x32_bf16 v[248:251], v[32:35], v[64:67], v[248:251]
    v_mfma_f32_16x16x32_bf16 v[252:255], v[20:23], v[68:71], v[252:255]
    v_mfma_f32_16x16x32_bf16 v[252:255], v[32:35], v[52:55], v[252:255]
    s_waitcnt lgkmcnt(0)
    v_mfma_f32_16x16x32_bf16 v[96:99], v[36:39], v[76:79], v[96:99]
    s_barrier
    ds_read_b64_tr_b16 v[80:81], v16 offset:0
    v_mfma_f32_16x16x32_bf16 v[96:99], v[40:43], v[24:27], v[96:99]
    ds_read_b64_tr_b16 v[82:83], v16 offset:512
    v_mfma_f32_16x16x32_bf16 v[100:103], v[36:39], v[88:91], v[100:103]
    ds_read_b128 v[48:51], v10 offset:0
    v_mfma_f32_16x16x32_bf16 v[100:103], v[40:43], v[28:31], v[100:103]
    ds_read_b64_tr_b16 v[84:85], v16 offset:10240
    v_mfma_f32_16x16x32_bf16 v[104:107], v[36:39], v[60:63], v[104:107]
    ds_read_b64_tr_b16 v[86:87], v16 offset:10752
    v_mfma_f32_16x16x32_bf16 v[104:107], v[40:43], v[64:67], v[104:107]
    ds_read_b128 v[92:95], v11 offset:0
    v_mfma_f32_16x16x32_bf16 v[108:111], v[36:39], v[68:71], v[108:111]
    ds_read_b128 v[56:59], v10 offset:2048
    v_mfma_f32_16x16x32_bf16 v[108:111], v[40:43], v[52:55], v[108:111]
    ds_read_b128 v[20:23], v11 offset:2048
    v_mfma_f32_16x16x32_bf16 v[112:115], v[44:47], v[76:79], v[112:115]
    ds_read_b128 v[32:35], v10 offset:4096
    v_mfma_f32_16x16x32_bf16 v[112:115], v[72:75], v[24:27], v[112:115]
    ds_read_b128 v[36:39], v11 offset:4096
    v_mfma_f32_16x16x32_bf16 v[116:119], v[44:47], v[88:91], v[116:119]
    ds_read_b128 v[40:43], v10 offset:6144
    v_mfma_f32_16x16x32_bf16 v[116:119], v[72:75], v[28:31], v[116:119]
    ds_read_b128 v[76:79], v11 offset:6144
    v_mfma_f32_16x16x32_bf16 v[120:123], v[44:47], v[60:63], v[120:123]
    ds_read_b64_tr_b16 v[24:25], v16 offset:2048
    v_mfma_f32_16x16x32_bf16 v[120:123], v[72:75], v[64:67], v[120:123]
    ds_read_b64_tr_b16 v[26:27], v16 offset:2560
    v_mfma_f32_16x16x32_bf16 v[124:127], v[44:47], v[68:71], v[124:127]
    ds_read_b64_tr_b16 v[88:89], v16 offset:12288
    v_mfma_f32_16x16x32_bf16 v[124:127], v[72:75], v[52:55], v[124:127]
    ds_read_b64_tr_b16 v[90:91], v16 offset:12800
    s_waitcnt lgkmcnt(7)
    v_mfma_f32_16x16x32_bf16 v[128:131], v[80:83], v[48:51], v[128:131]
    ds_read_b64_tr_b16 v[28:29], v17 offset:0
    v_mfma_f32_16x16x32_bf16 v[128:131], v[84:87], v[92:95], v[128:131]
    ds_read_b64_tr_b16 v[30:31], v17 offset:512
    v_mfma_f32_16x16x32_bf16 v[132:135], v[80:83], v[56:59], v[132:135]
    ds_read_b64_tr_b16 v[60:61], v17 offset:10240
    v_mfma_f32_16x16x32_bf16 v[132:135], v[84:87], v[20:23], v[132:135]
    ds_read_b64_tr_b16 v[62:63], v17 offset:10752
    v_mfma_f32_16x16x32_bf16 v[136:139], v[80:83], v[32:35], v[136:139]
    ds_read_b64_tr_b16 v[64:65], v17 offset:2048
    s_waitcnt lgkmcnt(7)
    v_mfma_f32_16x16x32_bf16 v[136:139], v[84:87], v[36:39], v[136:139]
    ds_read_b64_tr_b16 v[66:67], v17 offset:2560
    v_mfma_f32_16x16x32_bf16 v[140:143], v[80:83], v[40:43], v[140:143]
    ds_read_b64_tr_b16 v[68:69], v17 offset:12288
    v_mfma_f32_16x16x32_bf16 v[140:143], v[84:87], v[76:79], v[140:143]
    ds_read_b64_tr_b16 v[70:71], v17 offset:12800
    v_mfma_f32_16x16x32_bf16 v[144:147], v[24:27], v[48:51], v[144:147]
    ds_read_b64_tr_b16 v[44:45], v18 offset:0
    s_waitcnt lgkmcnt(7)
    v_mfma_f32_16x16x32_bf16 v[144:147], v[88:91], v[92:95], v[144:147]
    ds_read_b64_tr_b16 v[46:47], v18 offset:512
    v_mfma_f32_16x16x32_bf16 v[148:151], v[24:27], v[56:59], v[148:151]
    ds_read_b64_tr_b16 v[52:53], v18 offset:10240
    v_mfma_f32_16x16x32_bf16 v[148:151], v[88:91], v[20:23], v[148:151]
    ds_read_b64_tr_b16 v[54:55], v18 offset:10752
    v_mfma_f32_16x16x32_bf16 v[152:155], v[24:27], v[32:35], v[152:155]
    ds_read_b64_tr_b16 v[72:73], v18 offset:2048
    v_mfma_f32_16x16x32_bf16 v[152:155], v[88:91], v[36:39], v[152:155]
    ds_read_b64_tr_b16 v[74:75], v18 offset:2560
    v_mfma_f32_16x16x32_bf16 v[156:159], v[24:27], v[40:43], v[156:159]
    ds_read_b64_tr_b16 v[80:81], v18 offset:12288
    v_mfma_f32_16x16x32_bf16 v[156:159], v[88:91], v[76:79], v[156:159]
    ds_read_b64_tr_b16 v[82:83], v18 offset:12800
    v_mfma_f32_16x16x32_bf16 v[160:163], v[28:31], v[48:51], v[160:163]
    ds_read_b64_tr_b16 v[84:85], v19 offset:0
    s_waitcnt lgkmcnt(7)
    v_mfma_f32_16x16x32_bf16 v[160:163], v[60:63], v[92:95], v[160:163]
    ds_read_b64_tr_b16 v[86:87], v19 offset:512
    v_mfma_f32_16x16x32_bf16 v[164:167], v[28:31], v[56:59], v[164:167]
    ds_read_b64_tr_b16 v[24:25], v19 offset:10240
    v_mfma_f32_16x16x32_bf16 v[164:167], v[60:63], v[20:23], v[164:167]
    ds_read_b64_tr_b16 v[26:27], v19 offset:10752
    v_mul_f32 v128, s80, v128
    v_mul_f32 v129, s81, v129
    v_mul_f32 v130, s80, v130
    v_mfma_f32_16x16x32_bf16 v[168:171], v[28:31], v[32:35], v[168:171]
    ds_read_b64_tr_b16 v[88:89], v19 offset:2048
    v_mul_f32 v131, s81, v131
    v_mul_f32 v132, s80, v132
    v_mul_f32 v133, s81, v133
    v_mfma_f32_16x16x32_bf16 v[168:171], v[60:63], v[36:39], v[168:171]
    ds_read_b64_tr_b16 v[90:91], v19 offset:2560
    v_mul_f32 v134, s80, v134
    v_mul_f32 v135, s81, v135
    v_exp_f32 v128, v128
    v_mfma_f32_16x16x32_bf16 v[172:175], v[28:31], v[40:43], v[172:175]
    v_exp_f32 v129, v129
    v_exp_f32 v130, v130
    v_exp_f32 v131, v131
    v_mfma_f32_16x16x32_bf16 v[172:175], v[60:63], v[76:79], v[172:175]
    ds_read_b64_tr_b16 v[28:29], v19 offset:12288
    v_exp_f32 v132, v132
    v_exp_f32 v133, v133
    v_exp_f32 v134, v134
    v_mfma_f32_16x16x32_bf16 v[176:179], v[64:67], v[48:51], v[176:179]
    ds_read_b64_tr_b16 v[30:31], v19 offset:12800
    v_exp_f32 v135, v135
    v_add_f32 v128, 1.0, v128
    v_add_f32 v129, 1.0, v129
    v_mfma_f32_16x16x32_bf16 v[176:179], v[68:71], v[92:95], v[176:179]
    ds_read_b64_tr_b16 v[60:61], v14 offset:0
    v_add_f32 v130, 1.0, v130
    v_add_f32 v131, 1.0, v131
    v_add_f32 v132, 1.0, v132
    v_mfma_f32_16x16x32_bf16 v[180:183], v[64:67], v[56:59], v[180:183]
    ds_read_b64_tr_b16 v[62:63], v14 offset:256
    v_add_f32 v133, 1.0, v133
    v_add_f32 v134, 1.0, v134
    v_add_f32 v135, 1.0, v135
    v_mfma_f32_16x16x32_bf16 v[180:183], v[68:71], v[20:23], v[180:183]
    v_rcp_f32 v128, v128
    v_rcp_f32 v129, v129
    v_rcp_f32 v130, v130
    v_mfma_f32_16x16x32_bf16 v[184:187], v[64:67], v[32:35], v[184:187]
    v_rcp_f32 v131, v131
    v_rcp_f32 v132, v132
    v_rcp_f32 v133, v133
    v_mfma_f32_16x16x32_bf16 v[184:187], v[68:71], v[36:39], v[184:187]
    v_rcp_f32 v134, v134
    v_rcp_f32 v135, v135
    v_mul_f32 v128, v128, v144
    v_mfma_f32_16x16x32_bf16 v[188:191], v[64:67], v[40:43], v[188:191]
    v_mul_f32 v129, v129, v145
    v_mul_f32 v130, v130, v146
    v_mul_f32 v131, v131, v147
    v_mfma_f32_16x16x32_bf16 v[188:191], v[68:71], v[76:79], v[188:191]
    ds_read_b64_tr_b16 v[64:65], v14 offset:10240
    v_mul_f32 v132, v132, v148
    v_mul_f32 v133, v133, v149
    v_mul_f32 v134, v134, v150
    v_mfma_f32_16x16x32_bf16 v[192:195], v[44:47], v[48:51], v[192:195]
    ds_read_b64_tr_b16 v[66:67], v14 offset:10496
    v_mul_f32 v135, v135, v151
    v_cvt_pk_bf16_f32 v144, v128, v129
    v_cvt_pk_bf16_f32 v146, v132, v133
    s_waitcnt lgkmcnt(3)
    v_mfma_f32_16x16x32_bf16 v[192:195], v[52:55], v[92:95], v[192:195]
    ds_read_b64_tr_b16 v[68:69], v15 offset:0
    v_cvt_pk_bf16_f32 v145, v130, v131
    v_cvt_pk_bf16_f32 v147, v134, v135
    v_permlane32_swap_b32 v144, v146
    v_mfma_f32_16x16x32_bf16 v[196:199], v[44:47], v[56:59], v[196:199]
    ds_read_b64_tr_b16 v[70:71], v15 offset:256
    v_permlane32_swap_b32 v145, v147
    buffer_store_dwordx4 v[144:147], v1, s[28:31], s72 offen offset:0 sc1
    v_mfma_f32_16x16x32_bf16 v[196:199], v[52:55], v[20:23], v[196:199]
    s_mov_b64 exec, s[40:41]
    ds_read_b128 v[68:71], v7 offset:768
    s_mov_b64 exec, -1
    v_mul_f32 v136, s80, v136
    v_mul_f32 v137, s81, v137
    v_mul_f32 v138, s80, v138
    v_mfma_f32_16x16x32_bf16 v[200:203], v[44:47], v[32:35], v[200:203]
    v_mul_f32 v139, s81, v139
    v_mul_f32 v140, s80, v140
    v_mul_f32 v141, s81, v141
    v_mfma_f32_16x16x32_bf16 v[200:203], v[52:55], v[36:39], v[200:203]
    v_mul_f32 v142, s80, v142
    v_mul_f32 v143, s81, v143
    v_exp_f32 v136, v136
    v_mfma_f32_16x16x32_bf16 v[204:207], v[44:47], v[40:43], v[204:207]
    v_exp_f32 v137, v137
    v_exp_f32 v138, v138
    v_exp_f32 v139, v139
    v_mfma_f32_16x16x32_bf16 v[204:207], v[52:55], v[76:79], v[204:207]
    ds_read_b64_tr_b16 v[44:45], v15 offset:10240
    v_exp_f32 v140, v140
    v_exp_f32 v141, v141
    v_exp_f32 v142, v142
    v_mfma_f32_16x16x32_bf16 v[208:211], v[72:75], v[48:51], v[208:211]
    ds_read_b64_tr_b16 v[46:47], v15 offset:10496
    v_exp_f32 v143, v143
    v_add_f32 v136, 1.0, v136
    v_add_f32 v137, 1.0, v137
    v_mfma_f32_16x16x32_bf16 v[208:211], v[80:83], v[92:95], v[208:211]
    s_mov_b64 exec, s[40:41]
    ds_read_b128 v[44:47], v7 offset:832
    s_mov_b64 exec, -1
    ds_read_b64_tr_b16 v[12:13], v6 offset:0
    ds_read_b64_tr_b16 v[14:15], v6 offset:320
    ds_read_b64_tr_b16 v[16:17], v6 offset:1280
    ds_read_b64_tr_b16 v[18:19], v6 offset:1600
    v_add_f32 v138, 1.0, v138
    v_add_f32 v139, 1.0, v139
    v_add_f32 v140, 1.0, v140
    v_mfma_f32_16x16x32_bf16 v[212:215], v[72:75], v[56:59], v[212:215]
    v_add_f32 v141, 1.0, v141
    v_add_f32 v142, 1.0, v142
    v_add_f32 v143, 1.0, v143
    v_mfma_f32_16x16x32_bf16 v[212:215], v[80:83], v[20:23], v[212:215]
    v_rcp_f32 v136, v136
    v_rcp_f32 v137, v137
    v_rcp_f32 v138, v138
    v_mfma_f32_16x16x32_bf16 v[216:219], v[72:75], v[32:35], v[216:219]
    v_rcp_f32 v139, v139
    v_rcp_f32 v140, v140
    v_rcp_f32 v141, v141
    v_mfma_f32_16x16x32_bf16 v[216:219], v[80:83], v[36:39], v[216:219]
    v_rcp_f32 v142, v142
    v_rcp_f32 v143, v143
    v_mul_f32 v136, v136, v152
    v_mfma_f32_16x16x32_bf16 v[220:223], v[72:75], v[40:43], v[220:223]
    v_mul_f32 v137, v137, v153
    v_mul_f32 v138, v138, v154
    v_mul_f32 v139, v139, v155
    v_mfma_f32_16x16x32_bf16 v[220:223], v[80:83], v[76:79], v[220:223]
    v_mul_f32 v140, v140, v156
    v_mul_f32 v141, v141, v157
    v_mul_f32 v142, v142, v158
    v_mfma_f32_16x16x32_bf16 v[224:227], v[84:87], v[48:51], v[224:227]
    v_mul_f32 v143, v143, v159
    v_cvt_pk_bf16_f32 v152, v136, v137
    v_cvt_pk_bf16_f32 v154, v140, v141
    v_mfma_f32_16x16x32_bf16 v[224:227], v[24:27], v[92:95], v[224:227]
    v_cvt_pk_bf16_f32 v153, v138, v139
    v_cvt_pk_bf16_f32 v155, v142, v143
    v_permlane32_swap_b32 v152, v154
    v_mfma_f32_16x16x32_bf16 v[228:231], v[84:87], v[56:59], v[228:231]
    v_permlane32_swap_b32 v153, v155
    buffer_store_dwordx4 v[152:155], v1, s[28:31], s73 offen offset:0 sc1
    s_add_u32 s72, s72, 4096
    s_add_u32 s73, s73, 4096
    v_mfma_f32_16x16x32_bf16 v[228:231], v[24:27], v[20:23], v[228:231]
    v_mul_f32 v160, s80, v160
    v_mul_f32 v161, s81, v161
    v_mul_f32 v162, s80, v162
    v_mfma_f32_16x16x32_bf16 v[232:235], v[84:87], v[32:35], v[232:235]
    v_mul_f32 v163, s81, v163
    v_mul_f32 v164, s80, v164
    v_mul_f32 v165, s81, v165
    v_mfma_f32_16x16x32_bf16 v[232:235], v[24:27], v[36:39], v[232:235]
    v_mul_f32 v166, s80, v166
    v_mul_f32 v167, s81, v167
    v_exp_f32 v160, v160
    v_mfma_f32_16x16x32_bf16 v[236:239], v[84:87], v[40:43], v[236:239]
    v_exp_f32 v161, v161
    v_exp_f32 v162, v162
    v_exp_f32 v163, v163
    v_mfma_f32_16x16x32_bf16 v[236:239], v[24:27], v[76:79], v[236:239]
    v_exp_f32 v164, v164
    v_exp_f32 v165, v165
    v_exp_f32 v166, v166
    v_mfma_f32_16x16x32_bf16 v[240:243], v[88:91], v[48:51], v[240:243]
    v_exp_f32 v167, v167
    v_add_f32 v160, 1.0, v160
    v_add_f32 v161, 1.0, v161
    v_mfma_f32_16x16x32_bf16 v[240:243], v[28:31], v[92:95], v[240:243]
    v_add_f32 v162, 1.0, v162
    v_add_f32 v163, 1.0, v163
    v_add_f32 v164, 1.0, v164
    v_mfma_f32_16x16x32_bf16 v[244:247], v[88:91], v[56:59], v[244:247]
    v_add_f32 v165, 1.0, v165
    v_add_f32 v166, 1.0, v166
    v_add_f32 v167, 1.0, v167
    v_mfma_f32_16x16x32_bf16 v[244:247], v[28:31], v[20:23], v[244:247]
    v_rcp_f32 v160, v160
    v_rcp_f32 v161, v161
    v_rcp_f32 v162, v162
    v_mfma_f32_16x16x32_bf16 v[248:251], v[88:91], v[32:35], v[248:251]
    v_rcp_f32 v163, v163
    v_rcp_f32 v164, v164
    v_rcp_f32 v165, v165
    v_mfma_f32_16x16x32_bf16 v[248:251], v[28:31], v[36:39], v[248:251]
    v_rcp_f32 v166, v166
    v_rcp_f32 v167, v167
    v_mul_f32 v160, v160, v176
    v_mfma_f32_16x16x32_bf16 v[252:255], v[88:91], v[40:43], v[252:255]
    v_mul_f32 v161, v161, v177
    v_mul_f32 v162, v162, v178
    v_mul_f32 v163, v163, v179
    v_mfma_f32_16x16x32_bf16 v[252:255], v[28:31], v[76:79], v[252:255]
    v_mul_f32 v164, v164, v180
    v_mul_f32 v165, v165, v181
    v_mul_f32 v166, v166, v182
    s_waitcnt lgkmcnt(4)
    v_mfma_f32_16x16x32_bf16 v[96:99], v[60:63], v[48:51], v[96:99]
    v_mul_f32 v167, v167, v183
    v_cvt_pk_bf16_f32 v176, v160, v161
    v_cvt_pk_bf16_f32 v178, v164, v165
    v_mfma_f32_16x16x32_bf16 v[96:99], v[64:67], v[92:95], v[96:99]
    v_cvt_pk_bf16_f32 v177, v162, v163
    v_cvt_pk_bf16_f32 v179, v166, v167
    v_permlane32_swap_b32 v176, v178
    v_mfma_f32_16x16x32_bf16 v[100:103], v[60:63], v[56:59], v[100:103]
    v_permlane32_swap_b32 v177, v179
    buffer_store_dwordx4 v[176:179], v1, s[28:31], s72 offen offset:0 sc1
    v_mfma_f32_16x16x32_bf16 v[100:103], v[64:67], v[20:23], v[100:103]
    v_mul_f32 v168, s80, v168
    v_mul_f32 v169, s81, v169
    v_mul_f32 v170, s80, v170
    v_mfma_f32_16x16x32_bf16 v[104:107], v[60:63], v[32:35], v[104:107]
    v_mul_f32 v171, s81, v171
    v_mul_f32 v172, s80, v172
    v_mul_f32 v173, s81, v173
    v_mfma_f32_16x16x32_bf16 v[104:107], v[64:67], v[36:39], v[104:107]
    v_mul_f32 v174, s80, v174
    v_mul_f32 v175, s81, v175
    v_exp_f32 v168, v168
    v_mfma_f32_16x16x32_bf16 v[108:111], v[60:63], v[40:43], v[108:111]
    v_exp_f32 v169, v169
    v_exp_f32 v170, v170
    v_exp_f32 v171, v171
    v_mfma_f32_16x16x32_bf16 v[108:111], v[64:67], v[76:79], v[108:111]
    v_exp_f32 v172, v172
    v_exp_f32 v173, v173
    v_exp_f32 v174, v174
    v_mfma_f32_16x16x32_bf16 v[112:115], v[68:71], v[48:51], v[112:115]
    v_exp_f32 v175, v175
    v_add_f32 v168, 1.0, v168
    v_add_f32 v169, 1.0, v169
    v_mfma_f32_16x16x32_bf16 v[112:115], v[44:47], v[92:95], v[112:115]
    v_add_f32 v170, 1.0, v170
    v_add_f32 v171, 1.0, v171
    v_add_f32 v172, 1.0, v172
    v_mfma_f32_16x16x32_bf16 v[116:119], v[68:71], v[56:59], v[116:119]
    v_add_f32 v173, 1.0, v173
    v_add_f32 v174, 1.0, v174
    v_add_f32 v175, 1.0, v175
    v_mfma_f32_16x16x32_bf16 v[116:119], v[44:47], v[20:23], v[116:119]
    v_rcp_f32 v168, v168
    v_rcp_f32 v169, v169
    v_rcp_f32 v170, v170
    v_mfma_f32_16x16x32_bf16 v[120:123], v[68:71], v[32:35], v[120:123]
    v_rcp_f32 v171, v171
    v_rcp_f32 v172, v172
    v_rcp_f32 v173, v173
    v_mfma_f32_16x16x32_bf16 v[120:123], v[44:47], v[36:39], v[120:123]
    v_rcp_f32 v174, v174
    v_rcp_f32 v175, v175
    v_mul_f32 v168, v168, v184
    v_mfma_f32_16x16x32_bf16 v[124:127], v[68:71], v[40:43], v[124:127]
    v_mul_f32 v169, v169, v185
    v_mul_f32 v170, v170, v186
    v_mul_f32 v171, v171, v187
    v_mfma_f32_16x16x32_bf16 v[124:127], v[44:47], v[76:79], v[124:127]
    v_mul_f32 v172, v172, v188
    v_mul_f32 v173, v173, v189
    v_mul_f32 v174, v174, v190
    v_mov_b32 v2, 1
    s_mov_b64 exec, 1
    ds_add_u32 v5, v2 offset:4
    s_mov_b64 exec, -1
    v_mul_f32 v175, v175, v191
    v_cvt_pk_bf16_f32 v184, v168, v169
    v_cvt_pk_bf16_f32 v186, v172, v173
    v_cvt_pk_bf16_f32 v185, v170, v171
    v_cvt_pk_bf16_f32 v187, v174, v175
    v_permlane32_swap_b32 v184, v186
    s_nop 0
    v_permlane32_swap_b32 v185, v187
    buffer_store_dwordx4 v[184:187], v1, s[28:31], s73 offen offset:0 sc1
    s_add_u32 s72, s72, 4096
    s_add_u32 s73, s73, 4096
    s_waitcnt vmcnt(4)
    s_mov_b32 s3, 200000
    s_branch L_44
L_43:
    s_mov_b64 exec, 1
    buffer_load_dword v4, v1, s[44:47], 0 offen sc1
    s_mov_b64 exec, -1
    s_sub_u32 s3, s3, 1
    s_waitcnt vmcnt(0)
    s_cbranch_scc1 L_45
L_44:
    v_readfirstlane_b32 s0, v4
    s_nop 0
    s_cmp_eq_u32 s0, 0
    s_cbranch_scc1 L_43
L_45:
    s_not_b32 s1, s0
    v_pk_mul_f32 v[192:193], v[192:193], s[80:81]
    v_pk_mul_f32 v[194:195], v[194:195], s[80:81]
    v_pk_mul_f32 v[196:197], v[196:197], s[80:81]
    v_pk_mul_f32 v[198:199], v[198:199], s[80:81]
    v_exp_f32 v192, v192
    v_exp_f32 v193, v193
    v_exp_f32 v194, v194
    v_exp_f32 v195, v195
    v_exp_f32 v196, v196
    v_exp_f32 v197, v197
    v_exp_f32 v198, v198
    v_exp_f32 v199, v199
    v_pk_add_f32 v[192:193], v[192:193], 1.0 op_sel_hi:[1,0]
    v_pk_add_f32 v[194:195], v[194:195], 1.0 op_sel_hi:[1,0]
    v_pk_add_f32 v[196:197], v[196:197], 1.0 op_sel_hi:[1,0]
    v_pk_add_f32 v[198:199], v[198:199], 1.0 op_sel_hi:[1,0]
    v_rcp_f32 v192, v192
    v_rcp_f32 v193, v193
    v_rcp_f32 v194, v194
    v_rcp_f32 v195, v195
    v_rcp_f32 v196, v196
    v_rcp_f32 v197, v197
    v_rcp_f32 v198, v198
    v_rcp_f32 v199, v199
    v_pk_mul_f32 v[192:193], v[192:193], v[208:209]
    v_pk_mul_f32 v[194:195], v[194:195], v[210:211]
    v_pk_mul_f32 v[196:197], v[196:197], v[212:213]
    v_pk_mul_f32 v[198:199], v[198:199], v[214:215]
    v_cvt_pk_bf16_f32 v208, v192, v193
    v_cvt_pk_bf16_f32 v210, v196, v197
    v_cvt_pk_bf16_f32 v209, v194, v195
    v_cvt_pk_bf16_f32 v211, v198, v199
    v_permlane32_swap_b32 v208, v210
    s_nop 0
    v_permlane32_swap_b32 v209, v211
    buffer_store_dwordx4 v[208:211], v1, s[28:31], s72 offen offset:0 sc1
    v_pk_mul_f32 v[200:201], v[200:201], s[80:81]
    v_pk_mul_f32 v[202:203], v[202:203], s[80:81]
    v_pk_mul_f32 v[204:205], v[204:205], s[80:81]
    v_pk_mul_f32 v[206:207], v[206:207], s[80:81]
    v_exp_f32 v200, v200
    v_exp_f32 v201, v201
    v_exp_f32 v202, v202
    v_exp_f32 v203, v203
    v_exp_f32 v204, v204
    v_exp_f32 v205, v205
    v_exp_f32 v206, v206
    v_exp_f32 v207, v207
    v_pk_add_f32 v[200:201], v[200:201], 1.0 op_sel_hi:[1,0]
    v_pk_add_f32 v[202:203], v[202:203], 1.0 op_sel_hi:[1,0]
    v_pk_add_f32 v[204:205], v[204:205], 1.0 op_sel_hi:[1,0]
    v_pk_add_f32 v[206:207], v[206:207], 1.0 op_sel_hi:[1,0]
    v_rcp_f32 v200, v200
    v_rcp_f32 v201, v201
    v_rcp_f32 v202, v202
    v_rcp_f32 v203, v203
    v_rcp_f32 v204, v204
    v_rcp_f32 v205, v205
    v_rcp_f32 v206, v206
    v_rcp_f32 v207, v207
    v_pk_mul_f32 v[200:201], v[200:201], v[216:217]
    v_pk_mul_f32 v[202:203], v[202:203], v[218:219]
    v_pk_mul_f32 v[204:205], v[204:205], v[220:221]
    v_pk_mul_f32 v[206:207], v[206:207], v[222:223]
    v_cvt_pk_bf16_f32 v216, v200, v201
    v_cvt_pk_bf16_f32 v218, v204, v205
    v_cvt_pk_bf16_f32 v217, v202, v203
    v_cvt_pk_bf16_f32 v219, v206, v207
    v_permlane32_swap_b32 v216, v218
    s_nop 0
    v_permlane32_swap_b32 v217, v219
    buffer_store_dwordx4 v[216:219], v1, s[28:31], s73 offen offset:0 sc1
    s_add_u32 s72, s72, 4096
    s_add_u32 s73, s73, 4096
    s_waitcnt vmcnt(2)
    v_mov_b32 v2, s0
    v_mov_b32 v3, s1
    s_mov_b64 exec, 4
    buffer_store_dwordx2 v[2:3], v8, s[28:31], 0 offen sc1
    s_mov_b64 exec, -1
    v_pk_mul_f32 v[224:225], v[224:225], s[80:81]
    v_pk_mul_f32 v[226:227], v[226:227], s[80:81]
    v_pk_mul_f32 v[228:229], v[228:229], s[80:81]
    v_pk_mul_f32 v[230:231], v[230:231], s[80:81]
    v_exp_f32 v224, v224
    v_exp_f32 v225, v225
    v_exp_f32 v226, v226
    v_exp_f32 v227, v227
    v_exp_f32 v228, v228
    v_exp_f32 v229, v229
    v_exp_f32 v230, v230
    v_exp_f32 v231, v231
    v_pk_add_f32 v[224:225], v[224:225], 1.0 op_sel_hi:[1,0]
    v_pk_add_f32 v[226:227], v[226:227], 1.0 op_sel_hi:[1,0]
    v_pk_add_f32 v[228:229], v[228:229], 1.0 op_sel_hi:[1,0]
    v_pk_add_f32 v[230:231], v[230:231], 1.0 op_sel_hi:[1,0]
    v_rcp_f32 v224, v224
    v_rcp_f32 v225, v225
    v_rcp_f32 v226, v226
    v_rcp_f32 v227, v227
    v_rcp_f32 v228, v228
    v_rcp_f32 v229, v229
    v_rcp_f32 v230, v230
    v_rcp_f32 v231, v231
    v_pk_mul_f32 v[224:225], v[224:225], v[240:241]
    v_pk_mul_f32 v[226:227], v[226:227], v[242:243]
    v_pk_mul_f32 v[228:229], v[228:229], v[244:245]
    v_pk_mul_f32 v[230:231], v[230:231], v[246:247]
    v_cvt_pk_bf16_f32 v240, v224, v225
    v_cvt_pk_bf16_f32 v242, v228, v229
    v_cvt_pk_bf16_f32 v241, v226, v227
    v_cvt_pk_bf16_f32 v243, v230, v231
    v_permlane32_swap_b32 v240, v242
    s_nop 0
    v_permlane32_swap_b32 v241, v243
    buffer_store_dwordx4 v[240:243], v1, s[28:31], s72 offen offset:0 sc1
    v_pk_mul_f32 v[232:233], v[232:233], s[80:81]
    v_pk_mul_f32 v[234:235], v[234:235], s[80:81]
    v_pk_mul_f32 v[236:237], v[236:237], s[80:81]
    v_pk_mul_f32 v[238:239], v[238:239], s[80:81]
    v_exp_f32 v232, v232
    v_exp_f32 v233, v233
    v_exp_f32 v234, v234
    v_exp_f32 v235, v235
    v_exp_f32 v236, v236
    v_exp_f32 v237, v237
    v_exp_f32 v238, v238
    v_exp_f32 v239, v239
    v_pk_add_f32 v[232:233], v[232:233], 1.0 op_sel_hi:[1,0]
    v_pk_add_f32 v[234:235], v[234:235], 1.0 op_sel_hi:[1,0]
    v_pk_add_f32 v[236:237], v[236:237], 1.0 op_sel_hi:[1,0]
    v_pk_add_f32 v[238:239], v[238:239], 1.0 op_sel_hi:[1,0]
    v_rcp_f32 v232, v232
    v_rcp_f32 v233, v233
    v_rcp_f32 v234, v234
    v_rcp_f32 v235, v235
    v_rcp_f32 v236, v236
    v_rcp_f32 v237, v237
    v_rcp_f32 v238, v238
    v_rcp_f32 v239, v239
    v_pk_mul_f32 v[232:233], v[232:233], v[248:249]
    v_pk_mul_f32 v[234:235], v[234:235], v[250:251]
    v_pk_mul_f32 v[236:237], v[236:237], v[252:253]
    v_pk_mul_f32 v[238:239], v[238:239], v[254:255]
    v_cvt_pk_bf16_f32 v248, v232, v233
    v_cvt_pk_bf16_f32 v250, v236, v237
    v_cvt_pk_bf16_f32 v249, v234, v235
    v_cvt_pk_bf16_f32 v251, v238, v239
    v_permlane32_swap_b32 v248, v250
    s_nop 0
    v_permlane32_swap_b32 v249, v251
    buffer_store_dwordx4 v[248:251], v1, s[28:31], s73 offen offset:0 sc1
    s_add_u32 s72, s72, 4096
    s_add_u32 s73, s73, 4096
    v_mov_b32 v22, v112
    v_mov_b32 v20, v116
    v_mov_b32 v23, v120
    v_mov_b32 v21, v124
    v_permlane16_swap_b32 v22, v20
    s_nop 0
    v_permlane16_swap_b32 v23, v21
    v_mov_b32 v22, v20
    v_mov_b32 v23, v21
    s_lshl_b32 s70, s76, 8
    s_lshl_b32 s71, s52, 13
    v_permlane32_swap_b32 v22, v20
    v_permlane32_swap_b32 v23, v21
    v_min_f32 v20, 0x42200000, v20
    v_min_f32 v21, 0x42200000, v21
    v_mul_f32 v20, s82, v20
    v_mul_f32 v21, s82, v21
    v_exp_f32 v20, v20
    v_exp_f32 v21, v21
    s_add_u32 s70, s70, s71
    v_cndmask_b32 v22, v20, v21, s[78:79]
    v_add_f32 v22, 1.0, v22
    v_rcp_f32 v22, v22
    s_add_u32 s70, s70, 10485760
    s_cmp_eq_u32 s51, 0
    s_cselect_b32 s70, s70, 0x7fff0000
    v_lshlrev_b32 v23, 2, v0
    buffer_store_dword v22, v23, s[28:31], s70 offen sc1
    v_cvt_pk_bf16_f32 v64, v96, v97
    v_cvt_pk_bf16_f32 v65, v98, v99
    v_cvt_pk_bf16_f32 v66, v100, v101
    v_cvt_pk_bf16_f32 v67, v102, v103
    v_cvt_pk_bf16_f32 v80, v104, v105
    v_cvt_pk_bf16_f32 v81, v106, v107
    v_cvt_pk_bf16_f32 v82, v108, v109
    v_cvt_pk_bf16_f32 v83, v110, v111
    v_cvt_pk_bf16_f32 v68, v112, v113
    v_cvt_pk_bf16_f32 v69, v114, v115
    v_cvt_pk_bf16_f32 v70, v116, v117
    v_cvt_pk_bf16_f32 v71, v118, v119
    v_cvt_pk_bf16_f32 v84, v120, v121
    v_cvt_pk_bf16_f32 v85, v122, v123
    v_cvt_pk_bf16_f32 v86, v124, v125
    v_cvt_pk_bf16_f32 v87, v126, v127
    v_permlane16_swap_b32 v64, v66
    v_permlane16_swap_b32 v65, v67
    v_permlane16_swap_b32 v80, v82
    v_permlane16_swap_b32 v81, v83
    v_permlane16_swap_b32 v68, v70
    v_permlane16_swap_b32 v69, v71
    v_permlane16_swap_b32 v84, v86
    v_permlane16_swap_b32 v85, v87
    s_waitcnt lgkmcnt(1)
    v_mfma_f32_32x32x16_bf16 v[96:111], v[12:15], v[64:67], 0
    v_mfma_f32_32x32x16_bf16 v[96:111], v[16:19], v[68:71], v[96:111]
    v_mfma_f32_32x32x16_bf16 v[112:127], v[12:15], v[80:83], 0
    v_mfma_f32_32x32x16_bf16 v[112:127], v[16:19], v[84:87], v[112:127]
    s_nop 9
    v_max3_f32 v56, v96, v97, v98
    s_nop 0
    v_max3_f32 v60, v112, v113, v114
    v_min3_f32 v57, v96, v97, v98
    v_min3_f32 v61, v112, v113, v114
    v_max3_f32 v56, v56, v99, v100
    v_max3_f32 v60, v60, v115, v116
    v_min3_f32 v57, v57, v99, v100
    v_min3_f32 v61, v61, v115, v116
    v_max3_f32 v56, v56, v101, v102
    v_max3_f32 v60, v60, v117, v118
    v_min3_f32 v57, v57, v101, v102
    v_min3_f32 v61, v61, v117, v118
    v_max3_f32 v56, v56, v103, v104
    v_max3_f32 v60, v60, v119, v120
    v_min3_f32 v57, v57, v103, v104
    v_min3_f32 v61, v61, v119, v120
    v_max3_f32 v56, v56, v105, v106
    v_max3_f32 v60, v60, v121, v122
    v_min3_f32 v57, v57, v105, v106
    v_min3_f32 v61, v61, v121, v122
    v_max3_f32 v56, v56, v107, v108
    v_max3_f32 v60, v60, v123, v124
    v_min3_f32 v57, v57, v107, v108
    v_min3_f32 v61, v61, v123, v124
    v_max_f32 v56, v56, v109
    v_max_f32 v60, v60, v125
    v_min_f32 v57, v57, v109
    v_min_f32 v61, v61, v125
    v_mul_f32 v56, s80, v56
    v_mul_f32 v60, s80, v60
    v_mul_f32 v57, s82, v57
    v_mul_f32 v61, s82, v61
    s_nop 0
    v_permlane32_swap_b32 v56, v57
    v_permlane32_swap_b32 v60, v61
    v_min_f32 v56, v56, v57
    v_min_f32 v60, v60, v61
    v_mov_b32 v58, v56
    v_mov_b32 v62, v60
    s_nop 0
    v_permlane32_swap_b32 v56, v58
    v_permlane32_swap_b32 v60, v62
    v_pk_fma_f32 v[24:25], v[96:97], s[82:83], v[56:57] op_sel_hi:[1,1,0]
    v_pk_fma_f32 v[40:41], v[112:113], s[82:83], v[60:61] op_sel_hi:[1,1,0]
    v_pk_fma_f32 v[96:97], v[96:97], s[80:81], v[58:59] op_sel_hi:[1,1,0]
    v_pk_fma_f32 v[112:113], v[112:113], s[80:81], v[62:63] op_sel_hi:[1,1,0]
    v_pk_fma_f32 v[26:27], v[98:99], s[82:83], v[56:57] op_sel_hi:[1,1,0]
    v_pk_fma_f32 v[42:43], v[114:115], s[82:83], v[60:61] op_sel_hi:[1,1,0]
    v_pk_fma_f32 v[98:99], v[98:99], s[80:81], v[58:59] op_sel_hi:[1,1,0]
    v_pk_fma_f32 v[114:115], v[114:115], s[80:81], v[62:63] op_sel_hi:[1,1,0]
    v_pk_fma_f32 v[28:29], v[100:101], s[82:83], v[56:57] op_sel_hi:[1,1,0]
    v_pk_fma_f32 v[44:45], v[116:117], s[82:83], v[60:61] op_sel_hi:[1,1,0]
    v_pk_fma_f32 v[100:101], v[100:101], s[80:81], v[58:59] op_sel_hi:[1,1,0]
    v_pk_fma_f32 v[116:117], v[116:117], s[80:81], v[62:63] op_sel_hi:[1,1,0]
    v_pk_fma_f32 v[30:31], v[102:103], s[82:83], v[56:57] op_sel_hi:[1,1,0]
    v_pk_fma_f32 v[46:47], v[118:119], s[82:83], v[60:61] op_sel_hi:[1,1,0]
    v_pk_fma_f32 v[102:103], v[102:103], s[80:81], v[58:59] op_sel_hi:[1,1,0]
    v_pk_fma_f32 v[118:119], v[118:119], s[80:81], v[62:63] op_sel_hi:[1,1,0]
    v_pk_fma_f32 v[32:33], v[104:105], s[82:83], v[56:57] op_sel_hi:[1,1,0]
    v_pk_fma_f32 v[48:49], v[120:121], s[82:83], v[60:61] op_sel_hi:[1,1,0]
    v_pk_fma_f32 v[104:105], v[104:105], s[80:81], v[58:59] op_sel_hi:[1,1,0]
    v_pk_fma_f32 v[120:121], v[120:121], s[80:81], v[62:63] op_sel_hi:[1,1,0]
    v_pk_fma_f32 v[34:35], v[106:107], s[82:83], v[56:57] op_sel_hi:[1,1,0]
    v_pk_fma_f32 v[50:51], v[122:123], s[82:83], v[60:61] op_sel_hi:[1,1,0]
    v_pk_fma_f32 v[106:107], v[106:107], s[80:81], v[58:59] op_sel_hi:[1,1,0]
    v_pk_fma_f32 v[122:123], v[122:123], s[80:81], v[62:63] op_sel_hi:[1,1,0]
    v_pk_fma_f32 v[36:37], v[108:109], s[82:83], v[56:57] op_sel_hi:[1,1,0]
    v_pk_fma_f32 v[52:53], v[124:125], s[82:83], v[60:61] op_sel_hi:[1,1,0]
    v_pk_fma_f32 v[108:109], v[108:109], s[80:81], v[58:59] op_sel_hi:[1,1,0]
    v_pk_fma_f32 v[124:125], v[124:125], s[80:81], v[62:63] op_sel_hi:[1,1,0]
    v_exp_f32 v24, v24
    v_exp_f32 v40, v40
    v_exp_f32 v96, v96
    v_exp_f32 v112, v112
    v_exp_f32 v25, v25
    v_exp_f32 v41, v41
    v_exp_f32 v97, v97
    v_exp_f32 v113, v113
    v_exp_f32 v26, v26
    v_exp_f32 v42, v42
    v_exp_f32 v98, v98
    v_exp_f32 v114, v114
    v_exp_f32 v27, v27
    v_exp_f32 v43, v43
    v_exp_f32 v99, v99
    v_exp_f32 v115, v115
    v_exp_f32 v28, v28
    v_exp_f32 v44, v44
    v_exp_f32 v100, v100
    v_exp_f32 v116, v116
    v_exp_f32 v29, v29
    v_exp_f32 v45, v45
    v_exp_f32 v101, v101
    v_exp_f32 v117, v117
    v_exp_f32 v30, v30
    v_exp_f32 v46, v46
    s_waitcnt vmcnt(0)
    v_mov_b32 v2, s0
    v_mov_b32 v3, s1
    s_mov_b64 exec, 1
    buffer_store_dwordx2 v[2:3], v8, s[28:31], 0 offen sc1
    s_mov_b64 exec, -1
    v_exp_f32 v102, v102
    v_exp_f32 v118, v118
    v_exp_f32 v31, v31
    v_exp_f32 v47, v47
    v_exp_f32 v103, v103
    v_exp_f32 v119, v119
    v_exp_f32 v32, v32
    v_exp_f32 v48, v48
    v_exp_f32 v104, v104
    v_exp_f32 v120, v120
    v_exp_f32 v33, v33
    v_exp_f32 v49, v49
    v_exp_f32 v105, v105
    v_exp_f32 v121, v121
    v_exp_f32 v34, v34
    v_exp_f32 v50, v50
    v_exp_f32 v106, v106
    v_exp_f32 v122, v122
    v_exp_f32 v35, v35
    v_exp_f32 v51, v51
    v_exp_f32 v107, v107
    v_exp_f32 v123, v123
    v_exp_f32 v36, v36
    v_exp_f32 v52, v52
    v_exp_f32 v108, v108
    v_exp_f32 v124, v124
    v_exp_f32 v37, v37
    v_exp_f32 v53, v53
    v_exp_f32 v109, v109
    v_exp_f32 v125, v125
    v_pk_add_f32 v[56:57], v[24:25], v[26:27]
    v_pk_add_f32 v[60:61], v[40:41], v[42:43]
    v_pk_add_f32 v[58:59], v[96:97], v[98:99]
    v_pk_add_f32 v[62:63], v[112:113], v[114:115]
    v_pk_add_f32 v[56:57], v[56:57], v[28:29]
    v_pk_add_f32 v[60:61], v[60:61], v[44:45]
    v_pk_add_f32 v[58:59], v[58:59], v[100:101]
    v_pk_add_f32 v[62:63], v[62:63], v[116:117]
    v_pk_add_f32 v[56:57], v[56:57], v[30:31]
    v_pk_add_f32 v[60:61], v[60:61], v[46:47]
    v_pk_add_f32 v[58:59], v[58:59], v[102:103]
    v_pk_add_f32 v[62:63], v[62:63], v[118:119]
    v_pk_add_f32 v[56:57], v[56:57], v[32:33]
    v_pk_add_f32 v[60:61], v[60:61], v[48:49]
    v_pk_add_f32 v[58:59], v[58:59], v[104:105]
    v_pk_add_f32 v[62:63], v[62:63], v[120:121]
    v_pk_add_f32 v[56:57], v[56:57], v[34:35]
    v_pk_add_f32 v[60:61], v[60:61], v[50:51]
    v_pk_add_f32 v[58:59], v[58:59], v[106:107]
    v_pk_add_f32 v[62:63], v[62:63], v[122:123]
    v_pk_add_f32 v[56:57], v[56:57], v[36:37]
    v_pk_add_f32 v[60:61], v[60:61], v[52:53]
    v_pk_add_f32 v[58:59], v[58:59], v[108:109]
    v_pk_add_f32 v[62:63], v[62:63], v[124:125]
    v_add_f32 v56, v56, v57
    v_add_f32 v60, v60, v61
    v_add_f32 v57, v58, v59
    v_add_f32 v61, v62, v63
    s_nop 0
    v_permlane32_swap_b32 v56, v57
    v_permlane32_swap_b32 v60, v61
    v_add_f32 v56, v56, v57
    v_add_f32 v60, v60, v61
    v_rcp_f32 v56, v56
    v_rcp_f32 v60, v60
    v_mov_b32 v58, v56
    v_mov_b32 v62, v60
    s_nop 0
    v_permlane32_swap_b32 v56, v58
    v_permlane32_swap_b32 v60, v62
    v_pk_mul_f32 v[24:25], v[24:25], v[56:57] op_sel_hi:[1,0]
    v_pk_mul_f32 v[40:41], v[40:41], v[60:61] op_sel_hi:[1,0]
    v_pk_mul_f32 v[96:97], v[96:97], v[58:59] op_sel_hi:[1,0]
    v_pk_mul_f32 v[112:113], v[112:113], v[62:63] op_sel_hi:[1,0]
    v_pk_mul_f32 v[26:27], v[26:27], v[56:57] op_sel_hi:[1,0]
    v_pk_mul_f32 v[42:43], v[42:43], v[60:61] op_sel_hi:[1,0]
    v_pk_mul_f32 v[98:99], v[98:99], v[58:59] op_sel_hi:[1,0]
    v_pk_mul_f32 v[114:115], v[114:115], v[62:63] op_sel_hi:[1,0]
    v_pk_mul_f32 v[28:29], v[28:29], v[56:57] op_sel_hi:[1,0]
    v_pk_mul_f32 v[44:45], v[44:45], v[60:61] op_sel_hi:[1,0]
    v_pk_mul_f32 v[100:101], v[100:101], v[58:59] op_sel_hi:[1,0]
    v_pk_mul_f32 v[116:117], v[116:117], v[62:63] op_sel_hi:[1,0]
    v_pk_mul_f32 v[30:31], v[30:31], v[56:57] op_sel_hi:[1,0]
    v_pk_mul_f32 v[46:47], v[46:47], v[60:61] op_sel_hi:[1,0]
    v_pk_mul_f32 v[102:103], v[102:103], v[58:59] op_sel_hi:[1,0]
    v_pk_mul_f32 v[118:119], v[118:119], v[62:63] op_sel_hi:[1,0]
    v_pk_mul_f32 v[32:33], v[32:33], v[56:57] op_sel_hi:[1,0]
    v_pk_mul_f32 v[48:49], v[48:49], v[60:61] op_sel_hi:[1,0]
    v_pk_mul_f32 v[104:105], v[104:105], v[58:59] op_sel_hi:[1,0]
    v_pk_mul_f32 v[120:121], v[120:121], v[62:63] op_sel_hi:[1,0]
    v_pk_mul_f32 v[34:35], v[34:35], v[56:57] op_sel_hi:[1,0]
    v_pk_mul_f32 v[50:51], v[50:51], v[60:61] op_sel_hi:[1,0]
    v_pk_mul_f32 v[106:107], v[106:107], v[58:59] op_sel_hi:[1,0]
    v_pk_mul_f32 v[122:123], v[122:123], v[62:63] op_sel_hi:[1,0]
    v_pk_mul_f32 v[36:37], v[36:37], v[56:57] op_sel_hi:[1,0]
    v_pk_mul_f32 v[52:53], v[52:53], v[60:61] op_sel_hi:[1,0]
    v_pk_mul_f32 v[108:109], v[108:109], v[58:59] op_sel_hi:[1,0]
    v_pk_mul_f32 v[124:125], v[124:125], v[62:63] op_sel_hi:[1,0]
    v_cvt_pk_bf16_f32 v64, v24, v25
    v_cvt_pk_bf16_f32 v80, v40, v41
    v_cvt_pk_bf16_f32 v72, v96, v97
    v_cvt_pk_bf16_f32 v88, v112, v113
    v_cvt_pk_bf16_f32 v65, v26, v27
    v_cvt_pk_bf16_f32 v81, v42, v43
    v_cvt_pk_bf16_f32 v73, v98, v99
    v_cvt_pk_bf16_f32 v89, v114, v115
    v_cvt_pk_bf16_f32 v66, v28, v29
    v_cvt_pk_bf16_f32 v82, v44, v45
    v_cvt_pk_bf16_f32 v74, v100, v101
    v_cvt_pk_bf16_f32 v90, v116, v117
    v_cvt_pk_bf16_f32 v67, v30, v31
    v_cvt_pk_bf16_f32 v83, v46, v47
    v_cvt_pk_bf16_f32 v75, v102, v103
    v_cvt_pk_bf16_f32 v91, v118, v119
    v_cvt_pk_bf16_f32 v68, v32, v33
    v_cvt_pk_bf16_f32 v84, v48, v49
    v_cvt_pk_bf16_f32 v76, v104, v105
    v_cvt_pk_bf16_f32 v92, v120, v121
    v_cvt_pk_bf16_f32 v69, v34, v35
    v_cvt_pk_bf16_f32 v85, v50, v51
    v_cvt_pk_bf16_f32 v77, v106, v107
    v_cvt_pk_bf16_f32 v93, v122, v123
    v_cvt_pk_bf16_f32 v70, v36, v37
    v_cvt_pk_bf16_f32 v86, v52, v53
    v_cvt_pk_bf16_f32 v78, v108, v109
    v_cvt_pk_bf16_f32 v94, v124, v125
    v_mov_b32 v71, 0
    v_mov_b32 v87, 0
    v_mov_b32 v79, 0
    v_mov_b32 v95, 0
    s_lshl_b32 s70, s54, 5
    s_add_u32 s70, s70, s48
    s_lshl_b32 s70, s70, 11
    s_add_u32 s75, s70, 9437184
    s_lshl_b32 s70, s48, 2
    s_add_u32 s70, s70, s52
    s_lshl_b32 s70, s70, 2
    s_sub_u32 s70, s70, s51
    s_add_u32 s70, s70, 83971
    s_lshl_b32 s70, s70, 7
    s_add_u32 s18, s28, s70
    s_addc_u32 s19, s29, 0
    s_lshl_b32 s70, s48, 10
    s_add_u32 s70, s70, 135424
    v_and_b32 v24, 15, v0
    v_mul_u32_u24 v25, 37, v24
    v_lshrrev_b32 v25, 8, v25
    v_mul_u32_u24 v26, 7, v25
    v_sub_u32 v26, v24, v26
    v_and_b32 v24, 4, v26
    v_add_u32 v26, v26, v24
    v_and_b32 v24, 2, v25
    v_lshl_add_u32 v26, v24, 3, v26
    v_and_b32 v24, 1, v25
    v_lshl_add_u32 v26, v24, 2, v26
    v_bfe_u32 v24, v0, 4, 1
    v_lshl_add_u32 v26, v24, 5, v26
    v_lshrrev_b32 v24, 5, v0
    v_lshl_add_u32 v26, v26, 1, v24
    v_lshl_add_u32 v14, v26, 3, s70
    v_and_b32 v24, 15, v0
    v_add_u32 v24, 16, v24
    v_mul_u32_u24 v25, 37, v24
    v_lshrrev_b32 v25, 8, v25
    v_mul_u32_u24 v26, 7, v25
    v_sub_u32 v26, v24, v26
    v_cmp_lt_u32 vcc, 27, v24
    s_nop 1
    v_cndmask_b32 v25, v25, v26, vcc
    v_cndmask_b32 v26, v26, 7, vcc
    v_and_b32 v24, 4, v26
    v_add_u32 v26, v26, v24
    v_and_b32 v24, 2, v25
    v_lshl_add_u32 v26, v24, 3, v26
    v_and_b32 v24, 1, v25
    v_lshl_add_u32 v26, v24, 2, v26
    v_bfe_u32 v24, v0, 4, 1
    v_lshl_add_u32 v26, v24, 5, v26
    v_lshrrev_b32 v24, 5, v0
    v_lshl_add_u32 v26, v26, 1, v24
    v_lshl_add_u32 v15, v26, 3, s70
    v_add_u32 v22, 135424, v1
    s_lshl_b32 s70, s54, 11
    s_add_u32 s70, s70, 114688
    s_add_u32 s63, s63, s70
    s_add_u32 s64, s64, s70
    s_xor_b32 s70, s49, 0
    s_and_b32 s70, s70, 1
    s_lshl_b32 s70, s70, 15
    s_xor_b32 s71, s70, 0x8000
    s_add_u32 s12, s18, s71
    s_addc_u32 s13, s19, 0
    s_add_u32 s18, s18, s70
    s_addc_u32 s19, s19, 0
    s_add_u32 s14, s75, s71
    s_add_u32 s75, s75, s70
    s_and_b32 s59, s0, 0x1fff
    s_or_b32 s59, s59, 0x4000
    s_lshl_b32 s61, s59, 16
    s_load_dword s4, s[18:19], 0 glc
    s_load_dword s5, s[18:19], 8192 glc
    s_load_dword s6, s[18:19], 16384 glc
    s_load_dword s7, s[18:19], 24576 glc
    s_load_dword s8, s[12:13], 0 glc
    s_load_dword s9, s[12:13], 8192 glc
    s_load_dword s10, s[12:13], 16384 glc
    s_load_dword s11, s[12:13], 24576 glc
    s_mov_b32 s3, 200000
    s_waitcnt lgkmcnt(0)
L_47:
    s_cmp_lg_u32 s4, s0
    s_cbranch_scc1 L_46
L_48:
    s_add_u32 s70, s75, 0
    buffer_load_dwordx4 v[96:99], v1, s[28:31], s70 offen offset:0 sc1
    buffer_load_dwordx4 v[100:103], v1, s[28:31], s70 offen offset:1024 sc1
L_50:
    s_cmp_lg_u32 s5, s0
    s_cbranch_scc1 L_49
L_51:
    s_add_u32 s70, s75, 8192
    buffer_load_dwordx4 v[104:107], v1, s[28:31], s70 offen offset:0 sc1
    buffer_load_dwordx4 v[108:111], v1, s[28:31], s70 offen offset:1024 sc1
L_53:
    s_cmp_lg_u32 s6, s0
    s_cbranch_scc1 L_52
L_54:
    s_add_u32 s70, s75, 16384
    buffer_load_dwordx4 v[112:115], v1, s[28:31], s70 offen offset:0 sc1
    buffer_load_dwordx4 v[116:119], v1, s[28:31], s70 offen offset:1024 sc1
L_56:
    s_cmp_lg_u32 s7, s0
    s_cbranch_scc1 L_55
L_57:
    s_add_u32 s70, s75, 24576
    buffer_load_dwordx4 v[120:123], v1, s[28:31], s70 offen offset:0 sc1
    buffer_load_dwordx4 v[124:127], v1, s[28:31], s70 offen offset:1024 sc1
L_59:
    s_cmp_lg_u32 s8, s0
    s_cbranch_scc1 L_58
L_60:
    s_add_u32 s70, s14, 0
    buffer_load_dwordx4 v[32:35], v1, s[28:31], s70 offen offset:0 sc1
    buffer_load_dwordx4 v[36:39], v1, s[28:31], s70 offen offset:1024 sc1
L_62:
    s_cmp_lg_u32 s9, s0
    s_cbranch_scc1 L_61
L_63:
    s_add_u32 s70, s14, 8192
    buffer_load_dwordx4 v[40:43], v1, s[28:31], s70 offen offset:0 sc1
    buffer_load_dwordx4 v[44:47], v1, s[28:31], s70 offen offset:1024 sc1
L_65:
    s_cmp_lg_u32 s10, s0
    s_cbranch_scc1 L_64
L_66:
    s_add_u32 s70, s14, 16384
    buffer_load_dwordx4 v[48:51], v1, s[28:31], s70 offen offset:0 sc1
    buffer_load_dwordx4 v[52:55], v1, s[28:31], s70 offen offset:1024 sc1
L_68:
    s_cmp_lg_u32 s11, s0
    s_cbranch_scc1 L_67
L_69:
    s_add_u32 s70, s14, 24576
    buffer_load_dwordx4 v[56:59], v1, s[28:31], s70 offen offset:0 sc1
    buffer_load_dwordx4 v[60:63], v1, s[28:31], s70 offen offset:1024 sc1
    s_and_b32 s74, s0, 0xff
    s_mov_b32 s3, 200000
L_kvsum:
    s_waitcnt vmcnt(14)
    v_xor_b32 v96, s74, v96
    v_xor_b32 v99, s74, v99
    v_xor_b32 v100, s74, v100
    v_xor_b32 v103, s74, v103
    v_or3_b32 v9, 0, v96, v99
    v_or3_b32 v9, v9, v100, v103
    s_waitcnt vmcnt(12)
    v_xor_b32 v104, s74, v104
    v_xor_b32 v107, s74, v107
    v_xor_b32 v108, s74, v108
    v_xor_b32 v111, s74, v111
    v_or3_b32 v9, v9, v104, v107
    v_or3_b32 v9, v9, v108, v111
    v_add_f32 v24, v96, v104
    v_add_f32 v25, v97, v105
    v_add_f32 v26, v98, v106
    v_add_f32 v27, v99, v107
    v_add_f32 v28, v100, v108
    v_add_f32 v29, v101, v109
    v_add_f32 v30, v102, v110
    v_add_f32 v31, v103, v111
    s_waitcnt vmcnt(10)
    v_xor_b32 v112, s74, v112
    v_xor_b32 v115, s74, v115
    v_xor_b32 v116, s74, v116
    v_xor_b32 v119, s74, v119
    v_or3_b32 v9, v9, v112, v115
    v_or3_b32 v9, v9, v116, v119
    v_add_f32 v24, v24, v112
    v_add_f32 v25, v25, v113
    v_add_f32 v26, v26, v114
    v_add_f32 v27, v27, v115
    v_add_f32 v28, v28, v116
    v_add_f32 v29, v29, v117
    v_add_f32 v30, v30, v118
    v_add_f32 v31, v31, v119
    s_waitcnt vmcnt(8)
    v_xor_b32 v120, s74, v120
    v_xor_b32 v123, s74, v123
    v_xor_b32 v124, s74, v124
    v_xor_b32 v127, s74, v127
    v_or3_b32 v9, v9, v120, v123
    v_or3_b32 v9, v9, v124, v127
    v_add_f32 v24, v24, v120
    v_add_f32 v25, v25, v121
    v_add_f32 v26, v26, v122
    v_add_f32 v27, v27, v123
    v_add_f32 v28, v28, v124
    v_add_f32 v29, v29, v125
    v_add_f32 v30, v30, v126
    v_add_f32 v31, v31, v127
    s_waitcnt vmcnt(6)
    v_xor_b32 v32, s74, v32
    v_xor_b32 v35, s74, v35
    v_xor_b32 v36, s74, v36
    v_xor_b32 v39, s74, v39
    v_or3_b32 v9, v9, v32, v35
    v_or3_b32 v9, v9, v36, v39
    v_add_f32 v24, v24, v32
    v_add_f32 v25, v25, v33
    v_add_f32 v26, v26, v34
    v_add_f32 v27, v27, v35
    v_add_f32 v28, v28, v36
    v_add_f32 v29, v29, v37
    v_add_f32 v30, v30, v38
    v_add_f32 v31, v31, v39
    s_waitcnt vmcnt(4)
    v_xor_b32 v40, s74, v40
    v_xor_b32 v43, s74, v43
    v_xor_b32 v44, s74, v44
    v_xor_b32 v47, s74, v47
    v_or3_b32 v9, v9, v40, v43
    v_or3_b32 v9, v9, v44, v47
    v_add_f32 v24, v24, v40
    v_add_f32 v25, v25, v41
    v_add_f32 v26, v26, v42
    v_add_f32 v27, v27, v43
    v_add_f32 v28, v28, v44
    v_add_f32 v29, v29, v45
    v_add_f32 v30, v30, v46
    v_add_f32 v31, v31, v47
    s_waitcnt vmcnt(2)
    v_xor_b32 v48, s74, v48
    v_xor_b32 v51, s74, v51
    v_xor_b32 v52, s74, v52
    v_xor_b32 v55, s74, v55
    v_or3_b32 v9, v9, v48, v51
    v_or3_b32 v9, v9, v52, v55
    v_add_f32 v24, v24, v48
    v_add_f32 v25, v25, v49
    v_add_f32 v26, v26, v50
    v_add_f32 v27, v27, v51
    v_add_f32 v28, v28, v52
    v_add_f32 v29, v29, v53
    v_add_f32 v30, v30, v54
    v_add_f32 v31, v31, v55
    s_waitcnt vmcnt(0)
    v_xor_b32 v56, s74, v56
    v_xor_b32 v59, s74, v59
    v_xor_b32 v60, s74, v60
    v_xor_b32 v63, s74, v63
    v_or3_b32 v9, v9, v56, v59
    v_or3_b32 v9, v9, v60, v63
    v_add_f32 v24, v24, v56
    v_add_f32 v25, v25, v57
    v_add_f32 v26, v26, v58
    v_add_f32 v27, v27, v59
    v_add_f32 v28, v28, v60
    v_add_f32 v29, v29, v61
    v_add_f32 v30, v30, v62
    v_add_f32 v31, v31, v63
    v_and_b32 v9, 0xff, v9
    v_cmp_ne_u32 vcc, 0, v9
    s_nop 0
    s_cbranch_vccz L_kvok
    s_add_u32 s70, s75, 0
    buffer_load_dwordx4 v[96:99], v1, s[28:31], s70 offen offset:0 sc1
    buffer_load_dwordx4 v[100:103], v1, s[28:31], s70 offen offset:1024 sc1
    s_add_u32 s70, s75, 8192
    buffer_load_dwordx4 v[104:107], v1, s[28:31], s70 offen offset:0 sc1
    buffer_load_dwordx4 v[108:111], v1, s[28:31], s70 offen offset:1024 sc1
    s_add_u32 s70, s75, 16384
    buffer_load_dwordx4 v[112:115], v1, s[28:31], s70 offen offset:0 sc1
    buffer_load_dwordx4 v[116:119], v1, s[28:31], s70 offen offset:1024 sc1
    s_add_u32 s70, s75, 24576
    buffer_load_dwordx4 v[120:123], v1, s[28:31], s70 offen offset:0 sc1
    buffer_load_dwordx4 v[124:127], v1, s[28:31], s70 offen offset:1024 sc1
    s_add_u32 s70, s14, 0
    buffer_load_dwordx4 v[32:35], v1, s[28:31], s70 offen offset:0 sc1
    buffer_load_dwordx4 v[36:39], v1, s[28:31], s70 offen offset:1024 sc1
    s_add_u32 s70, s14, 8192
    buffer_load_dwordx4 v[40:43], v1, s[28:31], s70 offen offset:0 sc1
    buffer_load_dwordx4 v[44:47], v1, s[28:31], s70 offen offset:1024 sc1
    s_add_u32 s70, s14, 16384
    buffer_load_dwordx4 v[48:51], v1, s[28:31], s70 offen offset:0 sc1
    buffer_load_dwordx4 v[52:55], v1, s[28:31], s70 offen offset:1024 sc1
    s_add_u32 s70, s14, 24576
    buffer_load_dwordx4 v[56:59], v1, s[28:31], s70 offen offset:0 sc1
    buffer_load_dwordx4 v[60:63], v1, s[28:31], s70 offen offset:1024 sc1
    s_sub_u32 s3, s3, 1
    s_waitcnt vmcnt(0)
    s_cbranch_scc0 L_kvsum
L_kvok:
    v_cvt_pk_bf16_f32 v24, v24, v25
    v_cvt_pk_bf16_f32 v25, v26, v27
    v_cvt_pk_bf16_f32 v26, v28, v29
    v_cvt_pk_bf16_f32 v27, v30, v31
    ds_write_b64 v14, v[24:25]
    ds_write_b64 v15, v[26:27]
    v_mov_b32 v2, 1
    s_mov_b64 exec, 1
    ds_add_u32 v5, v2 offset:0
    s_mov_b64 exec, -1
    s_mov_b32 s3, 200000
L_70:
    ds_read_b32 v2, v5 offset:0
    ds_read_b128 v[32:35], v22 offset:0
    ds_read_b128 v[36:39], v22 offset:1024
    ds_read_b128 v[40:43], v22 offset:2048
    ds_read_b128 v[44:47], v22 offset:3072
    s_sub_u32 s3, s3, 1
    s_waitcnt lgkmcnt(0)
    s_cbranch_scc1 L_71
    v_cmp_gt_u32 vcc, 4, v2
    s_nop 0
    s_cbranch_vccnz L_70
L_71:
    v_mfma_f32_32x32x16_bf16 v[96:111], v[32:35], v[64:67], 0
    v_mfma_f32_32x32x16_bf16 v[96:111], v[36:39], v[68:71], v[96:111]
    v_mfma_f32_32x32x16_bf16 v[96:111], v[40:43], v[72:75], v[96:111]
    v_mfma_f32_32x32x16_bf16 v[96:111], v[44:47], v[76:79], v[96:111]
    v_mfma_f32_32x32x16_bf16 v[112:127], v[32:35], v[80:83], 0
    v_mfma_f32_32x32x16_bf16 v[112:127], v[36:39], v[84:87], v[112:127]
    v_mfma_f32_32x32x16_bf16 v[112:127], v[40:43], v[88:91], v[112:127]
    v_mfma_f32_32x32x16_bf16 v[112:127], v[44:47], v[92:95], v[112:127]
    s_nop 7
    v_add_f32 v103, 0x358637bd, v103
    v_rcp_f32 v103, v103
    s_nop 0
    v_mul_f32 v103, v103, v20
    v_mul_f32 v96, v96, v103
    v_mul_f32 v97, v97, v103
    v_mul_f32 v98, v98, v103
    v_mul_f32 v99, v99, v103
    v_mul_f32 v100, v100, v103
    v_mul_f32 v101, v101, v103
    v_mul_f32 v102, v102, v103
    v_cvt_pk_bf16_f32 v96, v96, v97
    v_cvt_pk_bf16_f32 v97, v98, v99
    v_cvt_pk_bf16_f32 v98, v100, v101
    v_cvt_pk_bf16_f32 v99, v102, s61
    buffer_store_dwordx4 v[96:99], v1, s[28:31], s63 offen offset:0 sc1
    v_mul_f32 v104, v104, v103
    v_mul_f32 v105, v105, v103
    v_mul_f32 v106, v106, v103
    v_mul_f32 v107, v107, v103
    v_mul_f32 v108, v108, v103
    v_mul_f32 v109, v109, v103
    v_mul_f32 v110, v110, v103
    v_cvt_pk_bf16_f32 v104, v104, v105
    v_cvt_pk_bf16_f32 v105, v106, v107
    v_cvt_pk_bf16_f32 v106, v108, v109
    v_cvt_pk_bf16_f32 v107, v110, s61
    buffer_store_dwordx4 v[104:107], v1, s[28:31], s63 offen offset:1024 sc1
    v_add_f32 v119, 0x358637bd, v119
    v_rcp_f32 v119, v119
    s_nop 0
    v_mul_f32 v119, v119, v21
    v_mul_f32 v112, v112, v119
    v_mul_f32 v113, v113, v119
    v_mul_f32 v114, v114, v119
    v_mul_f32 v115, v115, v119
    v_mul_f32 v116, v116, v119
    v_mul_f32 v117, v117, v119
    v_mul_f32 v118, v118, v119
    v_cvt_pk_bf16_f32 v112, v112, v113
    v_cvt_pk_bf16_f32 v113, v114, v115
    v_cvt_pk_bf16_f32 v114, v116, v117
    v_cvt_pk_bf16_f32 v115, v118, s61
    buffer_store_dwordx4 v[112:115], v1, s[28:31], s64 offen offset:0 sc1
    v_mul_f32 v120, v120, v119
    v_mul_f32 v121, v121, v119
    v_mul_f32 v122, v122, v119
    v_mul_f32 v123, v123, v119
    v_mul_f32 v124, v124, v119
    v_mul_f32 v125, v125, v119
    v_mul_f32 v126, v126, v119
    v_cvt_pk_bf16_f32 v120, v120, v121
    v_cvt_pk_bf16_f32 v121, v122, v123
    v_cvt_pk_bf16_f32 v122, v124, v125
    v_cvt_pk_bf16_f32 v123, v126, s61
    buffer_store_dwordx4 v[120:123], v1, s[28:31], s64 offen offset:1024 sc1
    v_mov_b32 v2, s0
    v_mov_b32 v3, s1
    s_mov_b64 exec, 2
    buffer_store_dwordx2 v[2:3], v8, s[28:31], 0 offen sc1
    s_mov_b64 exec, -1
    s_branch L_cfin
L_46:
    s_load_dword s4, s[18:19], 0 glc
    s_load_dword s5, s[18:19], 8192 glc
    s_load_dword s6, s[18:19], 16384 glc
    s_load_dword s7, s[18:19], 24576 glc
    s_load_dword s8, s[12:13], 0 glc
    s_load_dword s9, s[12:13], 8192 glc
    s_load_dword s10, s[12:13], 16384 glc
    s_load_dword s11, s[12:13], 24576 glc
    s_sub_u32 s3, s3, 1
    s_waitcnt lgkmcnt(0)
    s_cbranch_scc0 L_47
    s_mov_b32 s3, 0
    s_branch L_48
L_49:
    s_load_dword s5, s[18:19], 8192 glc
    s_load_dword s6, s[18:19], 16384 glc
    s_load_dword s7, s[18:19], 24576 glc
    s_load_dword s8, s[12:13], 0 glc
    s_load_dword s9, s[12:13], 8192 glc
    s_load_dword s10, s[12:13], 16384 glc
    s_load_dword s11, s[12:13], 24576 glc
    s_sub_u32 s3, s3, 1
    s_waitcnt lgkmcnt(0)
    s_cbranch_scc0 L_50
    s_mov_b32 s3, 0
    s_branch L_51
L_52:
    s_load_dword s6, s[18:19], 16384 glc
    s_load_dword s7, s[18:19], 24576 glc
    s_load_dword s8, s[12:13], 0 glc
    s_load_dword s9, s[12:13], 8192 glc
    s_load_dword s10, s[12:13], 16384 glc
    s_load_dword s11, s[12:13], 24576 glc
    s_sub_u32 s3, s3, 1
    s_waitcnt lgkmcnt(0)
    s_cbranch_scc0 L_53
    s_mov_b32 s3, 0
    s_branch L_54
L_55:
    s_load_dword s7, s[18:19], 24576 glc
    s_load_dword s8, s[12:13], 0 glc
    s_load_dword s9, s[12:13], 8192 glc
    s_load_dword s10, s[12:13], 16384 glc
    s_load_dword s11, s[12:13], 24576 glc
    s_sub_u32 s3, s3, 1
    s_waitcnt lgkmcnt(0)
    s_cbranch_scc0 L_56
    s_mov_b32 s3, 0
    s_branch L_57
L_58:
    s_load_dword s8, s[12:13], 0 glc
    s_load_dword s9, s[12:13], 8192 glc
    s_load_dword s10, s[12:13], 16384 glc
    s_load_dword s11, s[12:13], 24576 glc
    s_sub_u32 s3, s3, 1
    s_waitcnt lgkmcnt(0)
    s_cbranch_scc0 L_59
    s_mov_b32 s3, 0
    s_branch L_60
L_61:
    s_load_dword s9, s[12:13], 8192 glc
    s_load_dword s10, s[12:13], 16384 glc
    s_load_dword s11, s[12:13], 24576 glc
    s_sub_u32 s3, s3, 1
    s_waitcnt lgkmcnt(0)
    s_cbranch_scc0 L_62
    s_mov_b32 s3, 0
    s_branch L_63
L_64:
    s_load_dword s10, s[12:13], 16384 glc
    s_load_dword s11, s[12:13], 24576 glc
    s_sub_u32 s3, s3, 1
    s_waitcnt lgkmcnt(0)
    s_cbranch_scc0 L_65
    s_mov_b32 s3, 0
    s_branch L_66
L_67:
    s_load_dword s11, s[12:13], 24576 glc
    s_sub_u32 s3, s3, 1
    s_waitcnt lgkmcnt(0)
    s_cbranch_scc0 L_68
    s_mov_b32 s3, 0
    s_branch L_69
L_compA:
    v_bfe_u32 v44, v0, 2, 2
    v_bfe_u32 v45, v0, 4, 1
    v_and_b32 v46, 3, v0
    v_lshl_add_u32 v49, v45, 3, v44
    v_mul_u32_u24 v48, 1024, v43
    v_lshl_add_u32 v47, v49, 6, v48
    v_lshl_add_u32 v47, v45, 5, v47
    v_lshl_add_u32 v47, v46, 3, v47
    v_add_u32 v14, 98304, v47
    v_xor_b32 v15, 32, v14
    v_cmp_eq_u32 vcc, 3, v46
    v_mov_b32 v47, 0x30000
    s_nop 0
    v_cndmask_b32 v15, v15, v47, vcc
    v_lshl_add_u32 v47, v45, 2, v44
    v_lshl_add_u32 v47, v43, 4, v47
    v_mul_u32_u24 v47, 96, v47
    v_lshl_add_u32 v47, v46, 3, v47
    v_add_u32 v16, 106496, v47
    v_and_b32 v47, 31, v0
    v_mul_u32_u24 v47, 200, v47
    v_lshl_add_u32 v47, v43, 3, v47
    v_and_b32 v48, 15, v0
    v_mul_u32_u24 v48, 200, v48
    v_lshrrev_b32 v49, 4, v0
    v_lshl_add_u32 v48, v49, 3, v48
    v_lshl_add_u32 v47, v48, 16, v47
    s_mul_i32 s70, s60, 0x10001
    v_add_u32 v7, s70, v47
    s_mov_b32 s40, 0
    s_mov_b32 s41, 0xffff0000
    s_lshl_b32 s70, s54, 1
    s_lshr_b32 s70, 3789665481, s70
    s_and_b32 s70, s70, 3
    s_mul_i32 s71, s52, 12
    s_add_u32 s70, s70, s71
    s_lshl_b32 s69, s70, 10
    s_add_u32 s69, s69, 65536
    s_waitcnt lgkmcnt(0)
    s_barrier
    ds_read_b64_tr_b16 v[20:21], v14 offset:4096
    ds_read_b64_tr_b16 v[22:23], v14 offset:4352
    ds_read_b128 v[24:27], v10 offset:0
    ds_read_b64_tr_b16 v[28:29], v14 offset:6144
    ds_read_b64_tr_b16 v[30:31], v14 offset:6400
    ds_read_b128 v[32:35], v11 offset:0
    ds_read_b128 v[36:39], v10 offset:2048
    ds_read_b128 v[40:43], v11 offset:2048
    ds_read_b128 v[44:47], v10 offset:4096
    ds_read_b128 v[48:51], v11 offset:4096
    ds_read_b128 v[52:55], v10 offset:6144
    ds_read_b128 v[56:59], v11 offset:6144
    s_waitcnt lgkmcnt(9)
    v_mfma_f32_16x16x32_bf16 v[128:131], v[20:23], v[24:27], 0
    ds_read_b64_tr_b16 v[60:61], v15 offset:4096
    s_waitcnt lgkmcnt(7)
    v_mfma_f32_16x16x32_bf16 v[128:131], v[28:31], v[32:35], v[128:131]
    ds_read_b64_tr_b16 v[62:63], v15 offset:4352
    s_waitcnt lgkmcnt(7)
    v_mfma_f32_16x16x32_bf16 v[132:135], v[20:23], v[36:39], 0
    ds_read_b64_tr_b16 v[64:65], v15 offset:6144
    s_waitcnt lgkmcnt(7)
    v_mfma_f32_16x16x32_bf16 v[132:135], v[28:31], v[40:43], v[132:135]
    ds_read_b64_tr_b16 v[66:67], v15 offset:6400
    s_waitcnt lgkmcnt(7)
    v_mfma_f32_16x16x32_bf16 v[136:139], v[20:23], v[44:47], 0
    ds_read_b64_tr_b16 v[68:69], v14 offset:0
    s_waitcnt lgkmcnt(7)
    v_mfma_f32_16x16x32_bf16 v[136:139], v[28:31], v[48:51], v[136:139]
    ds_read_b64_tr_b16 v[70:71], v14 offset:256
    s_waitcnt lgkmcnt(7)
    v_mfma_f32_16x16x32_bf16 v[140:143], v[20:23], v[52:55], 0
    ds_read_b64_tr_b16 v[72:73], v14 offset:2048
    s_waitcnt lgkmcnt(7)
    v_mfma_f32_16x16x32_bf16 v[140:143], v[28:31], v[56:59], v[140:143]
    ds_read_b64_tr_b16 v[74:75], v14 offset:2304
    s_waitcnt lgkmcnt(6)
    v_mfma_f32_16x16x32_bf16 v[144:147], v[60:63], v[24:27], 0
    ds_read_b64_tr_b16 v[76:77], v15 offset:0
    s_waitcnt lgkmcnt(5)
    v_mfma_f32_16x16x32_bf16 v[144:147], v[64:67], v[32:35], v[144:147]
    ds_read_b64_tr_b16 v[78:79], v15 offset:256
    v_mfma_f32_16x16x32_bf16 v[148:151], v[60:63], v[36:39], 0
    ds_read_b64_tr_b16 v[80:81], v15 offset:2048
    v_mfma_f32_16x16x32_bf16 v[148:151], v[64:67], v[40:43], v[148:151]
    ds_read_b64_tr_b16 v[82:83], v15 offset:2304
    v_mfma_f32_16x16x32_bf16 v[152:155], v[60:63], v[44:47], 0
    ds_read_b64_tr_b16 v[84:85], v16 offset:0
    v_mfma_f32_16x16x32_bf16 v[152:155], v[64:67], v[48:51], v[152:155]
    ds_read_b64_tr_b16 v[86:87], v16 offset:768
    v_mfma_f32_16x16x32_bf16 v[156:159], v[60:63], v[52:55], 0
    ds_read_b64_tr_b16 v[88:89], v16 offset:3072
    v_mfma_f32_16x16x32_bf16 v[156:159], v[64:67], v[56:59], v[156:159]
    ds_read_b64_tr_b16 v[90:91], v16 offset:3840
    s_waitcnt lgkmcnt(7)
    v_mfma_f32_16x16x32_bf16 v[96:99], v[68:71], v[24:27], 0
    ds_read_b64_tr_b16 v[92:93], v16 offset:6272
    v_mfma_f32_16x16x32_bf16 v[96:99], v[72:75], v[32:35], v[96:99]
    ds_read_b64_tr_b16 v[94:95], v16 offset:7040
    v_mfma_f32_16x16x32_bf16 v[100:103], v[68:71], v[36:39], 0
    ds_read_b64_tr_b16 v[20:21], v16 offset:9344
    v_mfma_f32_16x16x32_bf16 v[100:103], v[72:75], v[40:43], v[100:103]
    ds_read_b64_tr_b16 v[22:23], v16 offset:10112
    v_mfma_f32_16x16x32_bf16 v[104:107], v[68:71], v[44:47], 0
    ds_read_b64_tr_b16 v[28:29], v16 offset:32
    v_mfma_f32_16x16x32_bf16 v[104:107], v[72:75], v[48:51], v[104:107]
    ds_read_b64_tr_b16 v[30:31], v16 offset:800
    v_mfma_f32_16x16x32_bf16 v[108:111], v[68:71], v[52:55], 0
    ds_read_b64_tr_b16 v[60:61], v16 offset:3104
    v_mfma_f32_16x16x32_bf16 v[108:111], v[72:75], v[56:59], v[108:111]
    ds_read_b64_tr_b16 v[62:63], v16 offset:3872
    s_waitcnt lgkmcnt(7)
    v_mfma_f32_16x16x32_bf16 v[112:115], v[76:79], v[24:27], 0
    ds_read_b64_tr_b16 v[64:65], v16 offset:6304
    v_mfma_f32_16x16x32_bf16 v[112:115], v[80:83], v[32:35], v[112:115]
    ds_read_b64_tr_b16 v[66:67], v16 offset:7072
    v_mfma_f32_16x16x32_bf16 v[116:119], v[76:79], v[36:39], 0
    ds_read_b64_tr_b16 v[68:69], v16 offset:9376
    v_mfma_f32_16x16x32_bf16 v[116:119], v[80:83], v[40:43], v[116:119]
    ds_read_b64_tr_b16 v[70:71], v16 offset:10144
    v_mfma_f32_16x16x32_bf16 v[120:123], v[76:79], v[44:47], 0
    ds_read_b64_tr_b16 v[72:73], v16 offset:64
    v_mfma_f32_16x16x32_bf16 v[120:123], v[80:83], v[48:51], v[120:123]
    ds_read_b64_tr_b16 v[74:75], v16 offset:832
    v_mfma_f32_16x16x32_bf16 v[124:127], v[76:79], v[52:55], 0
    v_mfma_f32_16x16x32_bf16 v[124:127], v[80:83], v[56:59], v[124:127]
    ds_read_b64_tr_b16 v[76:77], v16 offset:3136
    v_mfma_f32_16x16x32_bf16 v[160:163], v[84:87], v[24:27], 0
    ds_read_b64_tr_b16 v[78:79], v16 offset:3904
    v_mfma_f32_16x16x32_bf16 v[160:163], v[88:91], v[32:35], v[160:163]
    ds_read_b64_tr_b16 v[80:81], v16 offset:6336
    v_mfma_f32_16x16x32_bf16 v[164:167], v[84:87], v[36:39], 0
    ds_read_b64_tr_b16 v[82:83], v16 offset:7104
    v_mfma_f32_16x16x32_bf16 v[164:167], v[88:91], v[40:43], v[164:167]
    v_mfma_f32_16x16x32_bf16 v[168:171], v[84:87], v[44:47], 0
    v_mfma_f32_16x16x32_bf16 v[168:171], v[88:91], v[48:51], v[168:171]
    v_mfma_f32_16x16x32_bf16 v[172:175], v[84:87], v[52:55], 0
    v_mfma_f32_16x16x32_bf16 v[172:175], v[88:91], v[56:59], v[172:175]
    ds_read_b64_tr_b16 v[84:85], v16 offset:9408
    s_waitcnt lgkmcnt(3)
    v_mfma_f32_16x16x32_bf16 v[176:179], v[92:95], v[24:27], 0
    ds_read_b64_tr_b16 v[86:87], v16 offset:10176
    v_mfma_f32_16x16x32_bf16 v[176:179], v[20:23], v[32:35], v[176:179]
    v_mfma_f32_16x16x32_bf16 v[180:183], v[92:95], v[36:39], 0
    v_mfma_f32_16x16x32_bf16 v[180:183], v[20:23], v[40:43], v[180:183]
    v_mfma_f32_16x16x32_bf16 v[184:187], v[92:95], v[44:47], 0
    v_mfma_f32_16x16x32_bf16 v[184:187], v[20:23], v[48:51], v[184:187]
    v_mfma_f32_16x16x32_bf16 v[188:191], v[92:95], v[52:55], 0
    v_mfma_f32_16x16x32_bf16 v[188:191], v[20:23], v[56:59], v[188:191]
    v_mfma_f32_16x16x32_bf16 v[192:195], v[28:31], v[24:27], 0
    v_mfma_f32_16x16x32_bf16 v[192:195], v[60:63], v[32:35], v[192:195]
    v_mfma_f32_16x16x32_bf16 v[196:199], v[28:31], v[36:39], 0
    v_mfma_f32_16x16x32_bf16 v[196:199], v[60:63], v[40:43], v[196:199]
    v_mfma_f32_16x16x32_bf16 v[200:203], v[28:31], v[44:47], 0
    v_mfma_f32_16x16x32_bf16 v[200:203], v[60:63], v[48:51], v[200:203]
    v_mfma_f32_16x16x32_bf16 v[204:207], v[28:31], v[52:55], 0
    v_mfma_f32_16x16x32_bf16 v[204:207], v[60:63], v[56:59], v[204:207]
    v_mfma_f32_16x16x32_bf16 v[208:211], v[64:67], v[24:27], 0
    v_mfma_f32_16x16x32_bf16 v[208:211], v[68:71], v[32:35], v[208:211]
    v_mfma_f32_16x16x32_bf16 v[212:215], v[64:67], v[36:39], 0
    v_mfma_f32_16x16x32_bf16 v[212:215], v[68:71], v[40:43], v[212:215]
    v_mfma_f32_16x16x32_bf16 v[216:219], v[64:67], v[44:47], 0
    v_mfma_f32_16x16x32_bf16 v[216:219], v[68:71], v[48:51], v[216:219]
    v_mfma_f32_16x16x32_bf16 v[220:223], v[64:67], v[52:55], 0
    v_mfma_f32_16x16x32_bf16 v[220:223], v[68:71], v[56:59], v[220:223]
    v_mfma_f32_16x16x32_bf16 v[224:227], v[72:75], v[24:27], 0
    s_waitcnt lgkmcnt(0)
    s_barrier
    ds_read_b64_tr_b16 v[88:89], v14 offset:24832
    v_mfma_f32_16x16x32_bf16 v[224:227], v[76:79], v[32:35], v[224:227]
    ds_read_b64_tr_b16 v[90:91], v14 offset:25088
    v_mfma_f32_16x16x32_bf16 v[228:231], v[72:75], v[36:39], 0
    ds_read_b128 v[92:95], v10 offset:32768
    v_mfma_f32_16x16x32_bf16 v[228:231], v[76:79], v[40:43], v[228:231]
    ds_read_b64_tr_b16 v[20:21], v14 offset:26880
    v_mfma_f32_16x16x32_bf16 v[232:235], v[72:75], v[44:47], 0
    ds_read_b64_tr_b16 v[22:23], v14 offset:27136
    v_mfma_f32_16x16x32_bf16 v[232:235], v[76:79], v[48:51], v[232:235]
    ds_read_b128 v[28:31], v11 offset:32768
    v_mfma_f32_16x16x32_bf16 v[236:239], v[72:75], v[52:55], 0
    ds_read_b128 v[60:63], v10 offset:34816
    v_mfma_f32_16x16x32_bf16 v[236:239], v[76:79], v[56:59], v[236:239]
    ds_read_b128 v[64:67], v11 offset:34816
    v_mfma_f32_16x16x32_bf16 v[240:243], v[80:83], v[24:27], 0
    ds_read_b128 v[68:71], v10 offset:36864
    v_mfma_f32_16x16x32_bf16 v[240:243], v[84:87], v[32:35], v[240:243]
    ds_read_b128 v[72:75], v11 offset:36864
    v_mfma_f32_16x16x32_bf16 v[244:247], v[80:83], v[36:39], 0
    ds_read_b128 v[76:79], v10 offset:38912
    v_mfma_f32_16x16x32_bf16 v[244:247], v[84:87], v[40:43], v[244:247]
    ds_read_b128 v[24:27], v11 offset:38912
    v_mfma_f32_16x16x32_bf16 v[248:251], v[80:83], v[44:47], 0
    ds_read_b64_tr_b16 v[32:33], v15 offset:24832
    v_mfma_f32_16x16x32_bf16 v[248:251], v[84:87], v[48:51], v[248:251]
    ds_read_b64_tr_b16 v[34:35], v15 offset:25088
    v_mfma_f32_16x16x32_bf16 v[252:255], v[80:83], v[52:55], 0
    ds_read_b64_tr_b16 v[36:37], v15 offset:26880
    v_mfma_f32_16x16x32_bf16 v[252:255], v[84:87], v[56:59], v[252:255]
    ds_read_b64_tr_b16 v[38:39], v15 offset:27136
    s_waitcnt lgkmcnt(7)
    v_mfma_f32_16x16x32_bf16 v[128:131], v[88:91], v[92:95], v[128:131]
    ds_read_b64_tr_b16 v[40:41], v14 offset:20736
    v_mfma_f32_16x16x32_bf16 v[128:131], v[20:23], v[28:31], v[128:131]
    ds_read_b64_tr_b16 v[42:43], v14 offset:20992
    v_mfma_f32_16x16x32_bf16 v[132:135], v[88:91], v[60:63], v[132:135]
    ds_read_b64_tr_b16 v[44:45], v14 offset:22784
    v_mfma_f32_16x16x32_bf16 v[132:135], v[20:23], v[64:67], v[132:135]
    ds_read_b64_tr_b16 v[46:47], v14 offset:23040
    v_mfma_f32_16x16x32_bf16 v[136:139], v[88:91], v[68:71], v[136:139]
    ds_read_b64_tr_b16 v[48:49], v15 offset:20736
    s_waitcnt lgkmcnt(7)
    v_mfma_f32_16x16x32_bf16 v[136:139], v[20:23], v[72:75], v[136:139]
    ds_read_b64_tr_b16 v[50:51], v15 offset:20992
    v_mfma_f32_16x16x32_bf16 v[140:143], v[88:91], v[76:79], v[140:143]
    ds_read_b64_tr_b16 v[52:53], v15 offset:22784
    v_mfma_f32_16x16x32_bf16 v[140:143], v[20:23], v[24:27], v[140:143]
    ds_read_b64_tr_b16 v[54:55], v15 offset:23040
    v_mfma_f32_16x16x32_bf16 v[144:147], v[32:35], v[92:95], v[144:147]
    ds_read_b64_tr_b16 v[80:81], v16 offset:20736
    s_waitcnt lgkmcnt(7)
    v_mfma_f32_16x16x32_bf16 v[144:147], v[36:39], v[28:31], v[144:147]
    ds_read_b64_tr_b16 v[82:83], v16 offset:21504
    v_mfma_f32_16x16x32_bf16 v[148:151], v[32:35], v[60:63], v[148:151]
    ds_read_b64_tr_b16 v[56:57], v16 offset:23808
    v_mfma_f32_16x16x32_bf16 v[148:151], v[36:39], v[64:67], v[148:151]
    ds_read_b64_tr_b16 v[58:59], v16 offset:24576
    v_mfma_f32_16x16x32_bf16 v[152:155], v[32:35], v[68:71], v[152:155]
    ds_read_b64_tr_b16 v[84:85], v16 offset:27008
    v_mfma_f32_16x16x32_bf16 v[152:155], v[36:39], v[72:75], v[152:155]
    ds_read_b64_tr_b16 v[86:87], v16 offset:27776
    v_mfma_f32_16x16x32_bf16 v[156:159], v[32:35], v[76:79], v[156:159]
    ds_read_b64_tr_b16 v[88:89], v16 offset:30080
    v_mfma_f32_16x16x32_bf16 v[156:159], v[36:39], v[24:27], v[156:159]
    ds_read_b64_tr_b16 v[90:91], v16 offset:30848
    v_mfma_f32_16x16x32_bf16 v[96:99], v[40:43], v[92:95], v[96:99]
    ds_read_b64_tr_b16 v[20:21], v16 offset:20768
    s_waitcnt lgkmcnt(7)
    v_mfma_f32_16x16x32_bf16 v[96:99], v[44:47], v[28:31], v[96:99]
    ds_read_b64_tr_b16 v[22:23], v16 offset:21536
    v_mfma_f32_16x16x32_bf16 v[100:103], v[40:43], v[60:63], v[100:103]
    ds_read_b64_tr_b16 v[32:33], v16 offset:23840
    v_mfma_f32_16x16x32_bf16 v[100:103], v[44:47], v[64:67], v[100:103]
    ds_read_b64_tr_b16 v[34:35], v16 offset:24608
    v_mfma_f32_16x16x32_bf16 v[104:107], v[40:43], v[68:71], v[104:107]
    ds_read_b64_tr_b16 v[36:37], v16 offset:27040
    v_mfma_f32_16x16x32_bf16 v[104:107], v[44:47], v[72:75], v[104:107]
    ds_read_b64_tr_b16 v[38:39], v16 offset:27808
    v_mfma_f32_16x16x32_bf16 v[108:111], v[40:43], v[76:79], v[108:111]
    v_mfma_f32_16x16x32_bf16 v[108:111], v[44:47], v[24:27], v[108:111]
    ds_read_b64_tr_b16 v[40:41], v16 offset:30112
    v_mfma_f32_16x16x32_bf16 v[112:115], v[48:51], v[92:95], v[112:115]
    ds_read_b64_tr_b16 v[42:43], v16 offset:30880
    v_mfma_f32_16x16x32_bf16 v[112:115], v[52:55], v[28:31], v[112:115]
    ds_read_b64_tr_b16 v[44:45], v16 offset:20800
    v_mfma_f32_16x16x32_bf16 v[116:119], v[48:51], v[60:63], v[116:119]
    ds_read_b64_tr_b16 v[46:47], v16 offset:21568
    v_mfma_f32_16x16x32_bf16 v[116:119], v[52:55], v[64:67], v[116:119]
    v_mfma_f32_16x16x32_bf16 v[120:123], v[48:51], v[68:71], v[120:123]
    v_mfma_f32_16x16x32_bf16 v[120:123], v[52:55], v[72:75], v[120:123]
    v_mfma_f32_16x16x32_bf16 v[124:127], v[48:51], v[76:79], v[124:127]
    v_mfma_f32_16x16x32_bf16 v[124:127], v[52:55], v[24:27], v[124:127]
    ds_read_b64_tr_b16 v[48:49], v16 offset:23872
    v_mfma_f32_16x16x32_bf16 v[160:163], v[80:83], v[92:95], v[160:163]
    ds_read_b64_tr_b16 v[50:51], v16 offset:24640
    s_waitcnt lgkmcnt(3)
    v_mfma_f32_16x16x32_bf16 v[160:163], v[56:59], v[28:31], v[160:163]
    ds_read_b64_tr_b16 v[52:53], v16 offset:27072
    v_mfma_f32_16x16x32_bf16 v[164:167], v[80:83], v[60:63], v[164:167]
    ds_read_b64_tr_b16 v[54:55], v16 offset:27840
    v_mfma_f32_16x16x32_bf16 v[164:167], v[56:59], v[64:67], v[164:167]
    v_mfma_f32_16x16x32_bf16 v[168:171], v[80:83], v[68:71], v[168:171]
    v_mfma_f32_16x16x32_bf16 v[168:171], v[56:59], v[72:75], v[168:171]
    v_mfma_f32_16x16x32_bf16 v[172:175], v[80:83], v[76:79], v[172:175]
    v_mfma_f32_16x16x32_bf16 v[172:175], v[56:59], v[24:27], v[172:175]
    ds_read_b64_tr_b16 v[80:81], v16 offset:30144
    v_mfma_f32_16x16x32_bf16 v[176:179], v[84:87], v[92:95], v[176:179]
    ds_read_b64_tr_b16 v[82:83], v16 offset:30912
    v_mfma_f32_16x16x32_bf16 v[176:179], v[88:91], v[28:31], v[176:179]
    v_mfma_f32_16x16x32_bf16 v[180:183], v[84:87], v[60:63], v[180:183]
    v_mfma_f32_16x16x32_bf16 v[180:183], v[88:91], v[64:67], v[180:183]
    v_mfma_f32_16x16x32_bf16 v[184:187], v[84:87], v[68:71], v[184:187]
    v_mfma_f32_16x16x32_bf16 v[184:187], v[88:91], v[72:75], v[184:187]
    v_mfma_f32_16x16x32_bf16 v[188:191], v[84:87], v[76:79], v[188:191]
    v_mfma_f32_16x16x32_bf16 v[188:191], v[88:91], v[24:27], v[188:191]
    v_mfma_f32_16x16x32_bf16 v[192:195], v[20:23], v[92:95], v[192:195]
    v_mfma_f32_16x16x32_bf16 v[192:195], v[32:35], v[28:31], v[192:195]
    v_mfma_f32_16x16x32_bf16 v[196:199], v[20:23], v[60:63], v[196:199]
    v_mfma_f32_16x16x32_bf16 v[196:199], v[32:35], v[64:67], v[196:199]
    v_mfma_f32_16x16x32_bf16 v[200:203], v[20:23], v[68:71], v[200:203]
    v_mfma_f32_16x16x32_bf16 v[200:203], v[32:35], v[72:75], v[200:203]
    v_mfma_f32_16x16x32_bf16 v[204:207], v[20:23], v[76:79], v[204:207]
    v_mfma_f32_16x16x32_bf16 v[204:207], v[32:35], v[24:27], v[204:207]
    v_mfma_f32_16x16x32_bf16 v[208:211], v[36:39], v[92:95], v[208:211]
    v_mfma_f32_16x16x32_bf16 v[208:211], v[40:43], v[28:31], v[208:211]
    v_mfma_f32_16x16x32_bf16 v[212:215], v[36:39], v[60:63], v[212:215]
    v_mfma_f32_16x16x32_bf16 v[212:215], v[40:43], v[64:67], v[212:215]
    v_mfma_f32_16x16x32_bf16 v[216:219], v[36:39], v[68:71], v[216:219]
    v_mfma_f32_16x16x32_bf16 v[216:219], v[40:43], v[72:75], v[216:219]
    v_mfma_f32_16x16x32_bf16 v[220:223], v[36:39], v[76:79], v[220:223]
    v_mfma_f32_16x16x32_bf16 v[220:223], v[40:43], v[24:27], v[220:223]
    s_waitcnt lgkmcnt(0)
    v_mfma_f32_16x16x32_bf16 v[224:227], v[44:47], v[92:95], v[224:227]
    s_barrier
    ds_read_b64_tr_b16 v[56:57], v14 offset:45568
    v_mfma_f32_16x16x32_bf16 v[224:227], v[48:51], v[28:31], v[224:227]
    ds_read_b64_tr_b16 v[58:59], v14 offset:45824
    v_mfma_f32_16x16x32_bf16 v[228:231], v[44:47], v[60:63], v[228:231]
    ds_read_b128 v[84:87], v12 offset:0
    v_mfma_f32_16x16x32_bf16 v[228:231], v[48:51], v[64:67], v[228:231]
    ds_read_b64_tr_b16 v[88:89], v14 offset:47616
    v_mfma_f32_16x16x32_bf16 v[232:235], v[44:47], v[68:71], v[232:235]
    ds_read_b64_tr_b16 v[90:91], v14 offset:47872
    v_mfma_f32_16x16x32_bf16 v[232:235], v[48:51], v[72:75], v[232:235]
    ds_read_b128 v[20:23], v13 offset:0
    v_mfma_f32_16x16x32_bf16 v[236:239], v[44:47], v[76:79], v[236:239]
    ds_read_b128 v[32:35], v12 offset:2048
    v_mfma_f32_16x16x32_bf16 v[236:239], v[48:51], v[24:27], v[236:239]
    ds_read_b128 v[36:39], v13 offset:2048
    v_mfma_f32_16x16x32_bf16 v[240:243], v[52:55], v[92:95], v[240:243]
    ds_read_b128 v[40:43], v12 offset:4096
    v_mfma_f32_16x16x32_bf16 v[240:243], v[80:83], v[28:31], v[240:243]
    ds_read_b128 v[44:47], v13 offset:4096
    v_mfma_f32_16x16x32_bf16 v[244:247], v[52:55], v[60:63], v[244:247]
    ds_read_b128 v[48:51], v12 offset:6144
    v_mfma_f32_16x16x32_bf16 v[244:247], v[80:83], v[64:67], v[244:247]
    ds_read_b128 v[92:95], v13 offset:6144
    v_mfma_f32_16x16x32_bf16 v[248:251], v[52:55], v[68:71], v[248:251]
    ds_read_b64_tr_b16 v[28:29], v15 offset:45568
    v_mfma_f32_16x16x32_bf16 v[248:251], v[80:83], v[72:75], v[248:251]
    ds_read_b64_tr_b16 v[30:31], v15 offset:45824
    v_mfma_f32_16x16x32_bf16 v[252:255], v[52:55], v[76:79], v[252:255]
    ds_read_b64_tr_b16 v[60:61], v15 offset:47616
    v_mfma_f32_16x16x32_bf16 v[252:255], v[80:83], v[24:27], v[252:255]
    ds_read_b64_tr_b16 v[62:63], v15 offset:47872
    s_waitcnt lgkmcnt(7)
    v_mfma_f32_16x16x32_bf16 v[128:131], v[56:59], v[84:87], v[128:131]
    ds_read_b64_tr_b16 v[64:65], v14 offset:41472
    v_mfma_f32_16x16x32_bf16 v[128:131], v[88:91], v[20:23], v[128:131]
    ds_read_b64_tr_b16 v[66:67], v14 offset:41728
    v_mfma_f32_16x16x32_bf16 v[132:135], v[56:59], v[32:35], v[132:135]
    ds_read_b64_tr_b16 v[68:69], v14 offset:43520
    v_mfma_f32_16x16x32_bf16 v[132:135], v[88:91], v[36:39], v[132:135]
    ds_read_b64_tr_b16 v[70:71], v14 offset:43776
    v_mfma_f32_16x16x32_bf16 v[136:139], v[56:59], v[40:43], v[136:139]
    ds_read_b64_tr_b16 v[72:73], v15 offset:41472
    s_waitcnt lgkmcnt(7)
    v_mfma_f32_16x16x32_bf16 v[136:139], v[88:91], v[44:47], v[136:139]
    ds_read_b64_tr_b16 v[74:75], v15 offset:41728
    v_mfma_f32_16x16x32_bf16 v[140:143], v[56:59], v[48:51], v[140:143]
    ds_read_b64_tr_b16 v[76:77], v15 offset:43520
    v_mfma_f32_16x16x32_bf16 v[140:143], v[88:91], v[92:95], v[140:143]
    ds_read_b64_tr_b16 v[78:79], v15 offset:43776
    v_mfma_f32_16x16x32_bf16 v[144:147], v[28:31], v[84:87], v[144:147]
    ds_read_b64_tr_b16 v[52:53], v16 offset:41472
    s_waitcnt lgkmcnt(7)
    v_mfma_f32_16x16x32_bf16 v[144:147], v[60:63], v[20:23], v[144:147]
    ds_read_b64_tr_b16 v[54:55], v16 offset:42240
    v_mfma_f32_16x16x32_bf16 v[148:151], v[28:31], v[32:35], v[148:151]
    ds_read_b64_tr_b16 v[24:25], v16 offset:44544
    v_mfma_f32_16x16x32_bf16 v[148:151], v[60:63], v[36:39], v[148:151]
    ds_read_b64_tr_b16 v[26:27], v16 offset:45312
    v_mfma_f32_16x16x32_bf16 v[152:155], v[28:31], v[40:43], v[152:155]
    ds_read_b64_tr_b16 v[80:81], v16 offset:47744
    v_mfma_f32_16x16x32_bf16 v[152:155], v[60:63], v[44:47], v[152:155]
    ds_read_b64_tr_b16 v[82:83], v16 offset:48512
    v_mfma_f32_16x16x32_bf16 v[156:159], v[28:31], v[48:51], v[156:159]
    ds_read_b64_tr_b16 v[56:57], v16 offset:50816
    v_mfma_f32_16x16x32_bf16 v[156:159], v[60:63], v[92:95], v[156:159]
    ds_read_b64_tr_b16 v[58:59], v16 offset:51584
    v_mfma_f32_16x16x32_bf16 v[96:99], v[64:67], v[84:87], v[96:99]
    ds_read_b64_tr_b16 v[88:89], v16 offset:41504
    s_waitcnt lgkmcnt(7)
    v_mfma_f32_16x16x32_bf16 v[96:99], v[68:71], v[20:23], v[96:99]
    ds_read_b64_tr_b16 v[90:91], v16 offset:42272
    v_mfma_f32_16x16x32_bf16 v[100:103], v[64:67], v[32:35], v[100:103]
    ds_read_b64_tr_b16 v[28:29], v16 offset:44576
    v_mfma_f32_16x16x32_bf16 v[100:103], v[68:71], v[36:39], v[100:103]
    ds_read_b64_tr_b16 v[30:31], v16 offset:45344
    v_mfma_f32_16x16x32_bf16 v[104:107], v[64:67], v[40:43], v[104:107]
    ds_read_b64_tr_b16 v[60:61], v16 offset:47776
    v_mfma_f32_16x16x32_bf16 v[104:107], v[68:71], v[44:47], v[104:107]
    ds_read_b64_tr_b16 v[62:63], v16 offset:48544
    v_mfma_f32_16x16x32_bf16 v[108:111], v[64:67], v[48:51], v[108:111]
    v_mfma_f32_16x16x32_bf16 v[108:111], v[68:71], v[92:95], v[108:111]
    ds_read_b64_tr_b16 v[64:65], v16 offset:50848
    v_mfma_f32_16x16x32_bf16 v[112:115], v[72:75], v[84:87], v[112:115]
    ds_read_b64_tr_b16 v[66:67], v16 offset:51616
    v_mfma_f32_16x16x32_bf16 v[112:115], v[76:79], v[20:23], v[112:115]
    ds_read_b64_tr_b16 v[68:69], v16 offset:41536
    v_mfma_f32_16x16x32_bf16 v[116:119], v[72:75], v[32:35], v[116:119]
    ds_read_b64_tr_b16 v[70:71], v16 offset:42304
    v_mfma_f32_16x16x32_bf16 v[116:119], v[76:79], v[36:39], v[116:119]
    v_mfma_f32_16x16x32_bf16 v[120:123], v[72:75], v[40:43], v[120:123]
    v_mfma_f32_16x16x32_bf16 v[120:123], v[76:79], v[44:47], v[120:123]
    v_mfma_f32_16x16x32_bf16 v[124:127], v[72:75], v[48:51], v[124:127]
    v_mfma_f32_16x16x32_bf16 v[124:127], v[76:79], v[92:95], v[124:127]
    ds_read_b64_tr_b16 v[72:73], v16 offset:44608
    v_mfma_f32_16x16x32_bf16 v[160:163], v[52:55], v[84:87], v[160:163]
    ds_read_b64_tr_b16 v[74:75], v16 offset:45376
    s_waitcnt lgkmcnt(3)
    v_mfma_f32_16x16x32_bf16 v[160:163], v[24:27], v[20:23], v[160:163]
    ds_read_b64_tr_b16 v[76:77], v16 offset:47808
    v_mfma_f32_16x16x32_bf16 v[164:167], v[52:55], v[32:35], v[164:167]
    ds_read_b64_tr_b16 v[78:79], v16 offset:48576
    v_mfma_f32_16x16x32_bf16 v[164:167], v[24:27], v[36:39], v[164:167]
    v_mfma_f32_16x16x32_bf16 v[168:171], v[52:55], v[40:43], v[168:171]
    v_mfma_f32_16x16x32_bf16 v[168:171], v[24:27], v[44:47], v[168:171]
    v_mfma_f32_16x16x32_bf16 v[172:175], v[52:55], v[48:51], v[172:175]
    v_mfma_f32_16x16x32_bf16 v[172:175], v[24:27], v[92:95], v[172:175]
    ds_read_b64_tr_b16 v[52:53], v16 offset:50880
    v_mfma_f32_16x16x32_bf16 v[176:179], v[80:83], v[84:87], v[176:179]
    ds_read_b64_tr_b16 v[54:55], v16 offset:51648
    v_mfma_f32_16x16x32_bf16 v[176:179], v[56:59], v[20:23], v[176:179]
    v_mfma_f32_16x16x32_bf16 v[180:183], v[80:83], v[32:35], v[180:183]
    v_mfma_f32_16x16x32_bf16 v[180:183], v[56:59], v[36:39], v[180:183]
    v_mfma_f32_16x16x32_bf16 v[184:187], v[80:83], v[40:43], v[184:187]
    v_mfma_f32_16x16x32_bf16 v[184:187], v[56:59], v[44:47], v[184:187]
    v_mfma_f32_16x16x32_bf16 v[188:191], v[80:83], v[48:51], v[188:191]
    v_mfma_f32_16x16x32_bf16 v[188:191], v[56:59], v[92:95], v[188:191]
    v_mfma_f32_16x16x32_bf16 v[192:195], v[88:91], v[84:87], v[192:195]
    v_mfma_f32_16x16x32_bf16 v[192:195], v[28:31], v[20:23], v[192:195]
    v_mfma_f32_16x16x32_bf16 v[196:199], v[88:91], v[32:35], v[196:199]
    v_mfma_f32_16x16x32_bf16 v[196:199], v[28:31], v[36:39], v[196:199]
    v_mfma_f32_16x16x32_bf16 v[200:203], v[88:91], v[40:43], v[200:203]
    v_mfma_f32_16x16x32_bf16 v[200:203], v[28:31], v[44:47], v[200:203]
    v_mfma_f32_16x16x32_bf16 v[204:207], v[88:91], v[48:51], v[204:207]
    v_mfma_f32_16x16x32_bf16 v[204:207], v[28:31], v[92:95], v[204:207]
    v_mfma_f32_16x16x32_bf16 v[208:211], v[60:63], v[84:87], v[208:211]
    v_mfma_f32_16x16x32_bf16 v[208:211], v[64:67], v[20:23], v[208:211]
    v_mfma_f32_16x16x32_bf16 v[212:215], v[60:63], v[32:35], v[212:215]
    v_mfma_f32_16x16x32_bf16 v[212:215], v[64:67], v[36:39], v[212:215]
    v_mfma_f32_16x16x32_bf16 v[216:219], v[60:63], v[40:43], v[216:219]
    v_mfma_f32_16x16x32_bf16 v[216:219], v[64:67], v[44:47], v[216:219]
    v_mfma_f32_16x16x32_bf16 v[220:223], v[60:63], v[48:51], v[220:223]
    v_mfma_f32_16x16x32_bf16 v[220:223], v[64:67], v[92:95], v[220:223]
    s_waitcnt lgkmcnt(0)
    v_mfma_f32_16x16x32_bf16 v[224:227], v[68:71], v[84:87], v[224:227]
    s_barrier
    ds_read_b64_tr_b16 v[24:25], v14 offset:4096
    v_mfma_f32_16x16x32_bf16 v[224:227], v[72:75], v[20:23], v[224:227]
    ds_read_b64_tr_b16 v[26:27], v14 offset:4352
    v_mfma_f32_16x16x32_bf16 v[228:231], v[68:71], v[32:35], v[228:231]
    ds_read_b128 v[80:83], v10 offset:0
    v_mfma_f32_16x16x32_bf16 v[228:231], v[72:75], v[36:39], v[228:231]
    ds_read_b64_tr_b16 v[56:57], v14 offset:6144
    v_mfma_f32_16x16x32_bf16 v[232:235], v[68:71], v[40:43], v[232:235]
    ds_read_b64_tr_b16 v[58:59], v14 offset:6400
    v_mfma_f32_16x16x32_bf16 v[232:235], v[72:75], v[44:47], v[232:235]
    ds_read_b128 v[88:91], v11 offset:0
    v_mfma_f32_16x16x32_bf16 v[236:239], v[68:71], v[48:51], v[236:239]
    ds_read_b128 v[28:31], v10 offset:2048
    v_mfma_f32_16x16x32_bf16 v[236:239], v[72:75], v[92:95], v[236:239]
    ds_read_b128 v[60:63], v11 offset:2048
    v_mfma_f32_16x16x32_bf16 v[240:243], v[76:79], v[84:87], v[240:243]
    ds_read_b128 v[64:67], v10 offset:4096
    v_mfma_f32_16x16x32_bf16 v[240:243], v[52:55], v[20:23], v[240:243]
    ds_read_b128 v[68:71], v11 offset:4096
    v_mfma_f32_16x16x32_bf16 v[244:247], v[76:79], v[32:35], v[244:247]
    ds_read_b128 v[72:75], v10 offset:6144
    v_mfma_f32_16x16x32_bf16 v[244:247], v[52:55], v[36:39], v[244:247]
    ds_read_b128 v[84:87], v11 offset:6144
    v_mfma_f32_16x16x32_bf16 v[248:251], v[76:79], v[40:43], v[248:251]
    ds_read_b64_tr_b16 v[20:21], v15 offset:4096
    v_mfma_f32_16x16x32_bf16 v[248:251], v[52:55], v[44:47], v[248:251]
    ds_read_b64_tr_b16 v[22:23], v15 offset:4352
    v_mfma_f32_16x16x32_bf16 v[252:255], v[76:79], v[48:51], v[252:255]
    ds_read_b64_tr_b16 v[32:33], v15 offset:6144
    v_mfma_f32_16x16x32_bf16 v[252:255], v[52:55], v[92:95], v[252:255]
    ds_read_b64_tr_b16 v[34:35], v15 offset:6400
    s_waitcnt lgkmcnt(7)
    v_mfma_f32_16x16x32_bf16 v[128:131], v[24:27], v[80:83], v[128:131]
    ds_read_b64_tr_b16 v[36:37], v14 offset:0
    v_mfma_f32_16x16x32_bf16 v[128:131], v[56:59], v[88:91], v[128:131]
    ds_read_b64_tr_b16 v[38:39], v14 offset:256
    v_mfma_f32_16x16x32_bf16 v[132:135], v[24:27], v[28:31], v[132:135]
    ds_read_b64_tr_b16 v[40:41], v14 offset:2048
    v_mfma_f32_16x16x32_bf16 v[132:135], v[56:59], v[60:63], v[132:135]
    ds_read_b64_tr_b16 v[42:43], v14 offset:2304
    v_mfma_f32_16x16x32_bf16 v[136:139], v[24:27], v[64:67], v[136:139]
    ds_read_b64_tr_b16 v[44:45], v15 offset:0
    s_waitcnt lgkmcnt(7)
    v_mfma_f32_16x16x32_bf16 v[136:139], v[56:59], v[68:71], v[136:139]
    ds_read_b64_tr_b16 v[46:47], v15 offset:256
    v_mfma_f32_16x16x32_bf16 v[140:143], v[24:27], v[72:75], v[140:143]
    ds_read_b64_tr_b16 v[48:49], v15 offset:2048
    v_mfma_f32_16x16x32_bf16 v[140:143], v[56:59], v[84:87], v[140:143]
    ds_read_b64_tr_b16 v[50:51], v15 offset:2304
    v_mfma_f32_16x16x32_bf16 v[144:147], v[20:23], v[80:83], v[144:147]
    ds_read_b64_tr_b16 v[76:77], v16 offset:0
    s_waitcnt lgkmcnt(7)
    v_mfma_f32_16x16x32_bf16 v[144:147], v[32:35], v[88:91], v[144:147]
    ds_read_b64_tr_b16 v[78:79], v16 offset:768
    v_mfma_f32_16x16x32_bf16 v[148:151], v[20:23], v[28:31], v[148:151]
    ds_read_b64_tr_b16 v[92:93], v16 offset:3072
    v_mfma_f32_16x16x32_bf16 v[148:151], v[32:35], v[60:63], v[148:151]
    ds_read_b64_tr_b16 v[94:95], v16 offset:3840
    v_mfma_f32_16x16x32_bf16 v[152:155], v[20:23], v[64:67], v[152:155]
    ds_read_b64_tr_b16 v[52:53], v16 offset:6272
    v_mfma_f32_16x16x32_bf16 v[152:155], v[32:35], v[68:71], v[152:155]
    ds_read_b64_tr_b16 v[54:55], v16 offset:7040
    v_mfma_f32_16x16x32_bf16 v[156:159], v[20:23], v[72:75], v[156:159]
    ds_read_b64_tr_b16 v[24:25], v16 offset:9344
    v_mfma_f32_16x16x32_bf16 v[156:159], v[32:35], v[84:87], v[156:159]
    ds_read_b64_tr_b16 v[26:27], v16 offset:10112
    v_mfma_f32_16x16x32_bf16 v[96:99], v[36:39], v[80:83], v[96:99]
    ds_read_b64_tr_b16 v[56:57], v16 offset:32
    s_waitcnt lgkmcnt(7)
    v_mfma_f32_16x16x32_bf16 v[96:99], v[40:43], v[88:91], v[96:99]
    ds_read_b64_tr_b16 v[58:59], v16 offset:800
    v_mfma_f32_16x16x32_bf16 v[100:103], v[36:39], v[28:31], v[100:103]
    ds_read_b64_tr_b16 v[20:21], v16 offset:3104
    v_mfma_f32_16x16x32_bf16 v[100:103], v[40:43], v[60:63], v[100:103]
    ds_read_b64_tr_b16 v[22:23], v16 offset:3872
    v_mfma_f32_16x16x32_bf16 v[104:107], v[36:39], v[64:67], v[104:107]
    ds_read_b64_tr_b16 v[32:33], v16 offset:6304
    v_mfma_f32_16x16x32_bf16 v[104:107], v[40:43], v[68:71], v[104:107]
    ds_read_b64_tr_b16 v[34:35], v16 offset:7072
    v_mfma_f32_16x16x32_bf16 v[108:111], v[36:39], v[72:75], v[108:111]
    v_mfma_f32_16x16x32_bf16 v[108:111], v[40:43], v[84:87], v[108:111]
    ds_read_b64_tr_b16 v[36:37], v16 offset:9376
    v_mfma_f32_16x16x32_bf16 v[112:115], v[44:47], v[80:83], v[112:115]
    ds_read_b64_tr_b16 v[38:39], v16 offset:10144
    v_mfma_f32_16x16x32_bf16 v[112:115], v[48:51], v[88:91], v[112:115]
    ds_read_b64_tr_b16 v[40:41], v16 offset:64
    v_mfma_f32_16x16x32_bf16 v[116:119], v[44:47], v[28:31], v[116:119]
    ds_read_b64_tr_b16 v[42:43], v16 offset:832
    v_mfma_f32_16x16x32_bf16 v[116:119], v[48:51], v[60:63], v[116:119]
    v_mfma_f32_16x16x32_bf16 v[120:123], v[44:47], v[64:67], v[120:123]
    v_mfma_f32_16x16x32_bf16 v[120:123], v[48:51], v[68:71], v[120:123]
    v_mfma_f32_16x16x32_bf16 v[124:127], v[44:47], v[72:75], v[124:127]
    v_mfma_f32_16x16x32_bf16 v[124:127], v[48:51], v[84:87], v[124:127]
    ds_read_b64_tr_b16 v[44:45], v16 offset:3136
    v_mfma_f32_16x16x32_bf16 v[160:163], v[76:79], v[80:83], v[160:163]
    ds_read_b64_tr_b16 v[46:47], v16 offset:3904
    s_waitcnt lgkmcnt(3)
    v_mfma_f32_16x16x32_bf16 v[160:163], v[92:95], v[88:91], v[160:163]
    ds_read_b64_tr_b16 v[48:49], v16 offset:6336
    v_mfma_f32_16x16x32_bf16 v[164:167], v[76:79], v[28:31], v[164:167]
    ds_read_b64_tr_b16 v[50:51], v16 offset:7104
    v_mfma_f32_16x16x32_bf16 v[164:167], v[92:95], v[60:63], v[164:167]
    v_mfma_f32_16x16x32_bf16 v[168:171], v[76:79], v[64:67], v[168:171]
    v_mfma_f32_16x16x32_bf16 v[168:171], v[92:95], v[68:71], v[168:171]
    v_mfma_f32_16x16x32_bf16 v[172:175], v[76:79], v[72:75], v[172:175]
    v_mfma_f32_16x16x32_bf16 v[172:175], v[92:95], v[84:87], v[172:175]
    ds_read_b64_tr_b16 v[76:77], v16 offset:9408
    v_mfma_f32_16x16x32_bf16 v[176:179], v[52:55], v[80:83], v[176:179]
    ds_read_b64_tr_b16 v[78:79], v16 offset:10176
    v_mfma_f32_16x16x32_bf16 v[176:179], v[24:27], v[88:91], v[176:179]
    v_mfma_f32_16x16x32_bf16 v[180:183], v[52:55], v[28:31], v[180:183]
    v_mfma_f32_16x16x32_bf16 v[180:183], v[24:27], v[60:63], v[180:183]
    v_mfma_f32_16x16x32_bf16 v[184:187], v[52:55], v[64:67], v[184:187]
    v_mfma_f32_16x16x32_bf16 v[184:187], v[24:27], v[68:71], v[184:187]
    v_mfma_f32_16x16x32_bf16 v[188:191], v[52:55], v[72:75], v[188:191]
    v_mfma_f32_16x16x32_bf16 v[188:191], v[24:27], v[84:87], v[188:191]
    v_mfma_f32_16x16x32_bf16 v[192:195], v[56:59], v[80:83], v[192:195]
    v_mfma_f32_16x16x32_bf16 v[192:195], v[20:23], v[88:91], v[192:195]
    v_mfma_f32_16x16x32_bf16 v[196:199], v[56:59], v[28:31], v[196:199]
    v_mfma_f32_16x16x32_bf16 v[196:199], v[20:23], v[60:63], v[196:199]
    v_mfma_f32_16x16x32_bf16 v[200:203], v[56:59], v[64:67], v[200:203]
    v_mfma_f32_16x16x32_bf16 v[200:203], v[20:23], v[68:71], v[200:203]
    v_mfma_f32_16x16x32_bf16 v[204:207], v[56:59], v[72:75], v[204:207]
    v_mfma_f32_16x16x32_bf16 v[204:207], v[20:23], v[84:87], v[204:207]
    v_mfma_f32_16x16x32_bf16 v[208:211], v[32:35], v[80:83], v[208:211]
    v_mfma_f32_16x16x32_bf16 v[208:211], v[36:39], v[88:91], v[208:211]
    v_mfma_f32_16x16x32_bf16 v[212:215], v[32:35], v[28:31], v[212:215]
    v_mfma_f32_16x16x32_bf16 v[212:215], v[36:39], v[60:63], v[212:215]
    v_mfma_f32_16x16x32_bf16 v[216:219], v[32:35], v[64:67], v[216:219]
    v_mfma_f32_16x16x32_bf16 v[216:219], v[36:39], v[68:71], v[216:219]
    v_mfma_f32_16x16x32_bf16 v[220:223], v[32:35], v[72:75], v[220:223]
    v_mfma_f32_16x16x32_bf16 v[220:223], v[36:39], v[84:87], v[220:223]
    s_waitcnt lgkmcnt(0)
    v_mfma_f32_16x16x32_bf16 v[224:227], v[40:43], v[80:83], v[224:227]
    s_barrier
    ds_read_b64_tr_b16 v[92:93], v14 offset:24832
    v_mfma_f32_16x16x32_bf16 v[224:227], v[44:47], v[88:91], v[224:227]
    ds_read_b64_tr_b16 v[94:95], v14 offset:25088
    v_mfma_f32_16x16x32_bf16 v[228:231], v[40:43], v[28:31], v[228:231]
    ds_read_b128 v[52:55], v10 offset:32768
    v_mfma_f32_16x16x32_bf16 v[228:231], v[44:47], v[60:63], v[228:231]
    ds_read_b64_tr_b16 v[24:25], v14 offset:26880
    v_mfma_f32_16x16x32_bf16 v[232:235], v[40:43], v[64:67], v[232:235]
    ds_read_b64_tr_b16 v[26:27], v14 offset:27136
    v_mfma_f32_16x16x32_bf16 v[232:235], v[44:47], v[68:71], v[232:235]
    ds_read_b128 v[56:59], v11 offset:32768
    v_mfma_f32_16x16x32_bf16 v[236:239], v[40:43], v[72:75], v[236:239]
    ds_read_b128 v[20:23], v10 offset:34816
    v_mfma_f32_16x16x32_bf16 v[236:239], v[44:47], v[84:87], v[236:239]
    ds_read_b128 v[32:35], v11 offset:34816
    v_mfma_f32_16x16x32_bf16 v[240:243], v[48:51], v[80:83], v[240:243]
    ds_read_b128 v[36:39], v10 offset:36864
    v_mfma_f32_16x16x32_bf16 v[240:243], v[76:79], v[88:91], v[240:243]
    ds_read_b128 v[40:43], v11 offset:36864
    v_mfma_f32_16x16x32_bf16 v[244:247], v[48:51], v[28:31], v[244:247]
    ds_read_b128 v[44:47], v10 offset:38912
    v_mfma_f32_16x16x32_bf16 v[244:247], v[76:79], v[60:63], v[244:247]
    ds_read_b128 v[80:83], v11 offset:38912
    v_mfma_f32_16x16x32_bf16 v[248:251], v[48:51], v[64:67], v[248:251]
    ds_read_b64_tr_b16 v[88:89], v15 offset:24832
    v_mfma_f32_16x16x32_bf16 v[248:251], v[76:79], v[68:71], v[248:251]
    ds_read_b64_tr_b16 v[90:91], v15 offset:25088
    v_mfma_f32_16x16x32_bf16 v[252:255], v[48:51], v[72:75], v[252:255]
    ds_read_b64_tr_b16 v[28:29], v15 offset:26880
    v_mfma_f32_16x16x32_bf16 v[252:255], v[76:79], v[84:87], v[252:255]
    ds_read_b64_tr_b16 v[30:31], v15 offset:27136
    s_waitcnt lgkmcnt(7)
    v_mfma_f32_16x16x32_bf16 v[128:131], v[92:95], v[52:55], v[128:131]
    ds_read_b64_tr_b16 v[60:61], v14 offset:20736
    v_mfma_f32_16x16x32_bf16 v[128:131], v[24:27], v[56:59], v[128:131]
    ds_read_b64_tr_b16 v[62:63], v14 offset:20992
    v_mfma_f32_16x16x32_bf16 v[132:135], v[92:95], v[20:23], v[132:135]
    ds_read_b64_tr_b16 v[64:65], v14 offset:22784
    v_mfma_f32_16x16x32_bf16 v[132:135], v[24:27], v[32:35], v[132:135]
    ds_read_b64_tr_b16 v[66:67], v14 offset:23040
    v_mfma_f32_16x16x32_bf16 v[136:139], v[92:95], v[36:39], v[136:139]
    ds_read_b64_tr_b16 v[68:69], v15 offset:20736
    s_waitcnt lgkmcnt(7)
    v_mfma_f32_16x16x32_bf16 v[136:139], v[24:27], v[40:43], v[136:139]
    ds_read_b64_tr_b16 v[70:71], v15 offset:20992
    v_mfma_f32_16x16x32_bf16 v[140:143], v[92:95], v[44:47], v[140:143]
    ds_read_b64_tr_b16 v[72:73], v15 offset:22784
    v_mfma_f32_16x16x32_bf16 v[140:143], v[24:27], v[80:83], v[140:143]
    ds_read_b64_tr_b16 v[74:75], v15 offset:23040
    v_mfma_f32_16x16x32_bf16 v[144:147], v[88:91], v[52:55], v[144:147]
    ds_read_b64_tr_b16 v[48:49], v16 offset:20736
    s_waitcnt lgkmcnt(7)
    v_mfma_f32_16x16x32_bf16 v[144:147], v[28:31], v[56:59], v[144:147]
    ds_read_b64_tr_b16 v[50:51], v16 offset:21504
    v_mfma_f32_16x16x32_bf16 v[148:151], v[88:91], v[20:23], v[148:151]
    ds_read_b64_tr_b16 v[84:85], v16 offset:23808
    v_mfma_f32_16x16x32_bf16 v[148:151], v[28:31], v[32:35], v[148:151]
    ds_read_b64_tr_b16 v[86:87], v16 offset:24576
    v_mfma_f32_16x16x32_bf16 v[152:155], v[88:91], v[36:39], v[152:155]
    ds_read_b64_tr_b16 v[76:77], v16 offset:27008
    v_mfma_f32_16x16x32_bf16 v[152:155], v[28:31], v[40:43], v[152:155]
    ds_read_b64_tr_b16 v[78:79], v16 offset:27776
    v_mfma_f32_16x16x32_bf16 v[156:159], v[88:91], v[44:47], v[156:159]
    ds_read_b64_tr_b16 v[92:93], v16 offset:30080
    v_mfma_f32_16x16x32_bf16 v[156:159], v[28:31], v[80:83], v[156:159]
    ds_read_b64_tr_b16 v[94:95], v16 offset:30848
    v_mfma_f32_16x16x32_bf16 v[96:99], v[60:63], v[52:55], v[96:99]
    ds_read_b64_tr_b16 v[24:25], v16 offset:20768
    s_waitcnt lgkmcnt(7)
    v_mfma_f32_16x16x32_bf16 v[96:99], v[64:67], v[56:59], v[96:99]
    ds_read_b64_tr_b16 v[26:27], v16 offset:21536
    v_mfma_f32_16x16x32_bf16 v[100:103], v[60:63], v[20:23], v[100:103]
    ds_read_b64_tr_b16 v[88:89], v16 offset:23840
    v_mfma_f32_16x16x32_bf16 v[100:103], v[64:67], v[32:35], v[100:103]
    ds_read_b64_tr_b16 v[90:91], v16 offset:24608
    v_mfma_f32_16x16x32_bf16 v[104:107], v[60:63], v[36:39], v[104:107]
    ds_read_b64_tr_b16 v[28:29], v16 offset:27040
    v_mfma_f32_16x16x32_bf16 v[104:107], v[64:67], v[40:43], v[104:107]
    ds_read_b64_tr_b16 v[30:31], v16 offset:27808
    v_mfma_f32_16x16x32_bf16 v[108:111], v[60:63], v[44:47], v[108:111]
    v_mfma_f32_16x16x32_bf16 v[108:111], v[64:67], v[80:83], v[108:111]
    ds_read_b64_tr_b16 v[60:61], v16 offset:30112
    v_mfma_f32_16x16x32_bf16 v[112:115], v[68:71], v[52:55], v[112:115]
    ds_read_b64_tr_b16 v[62:63], v16 offset:30880
    v_mfma_f32_16x16x32_bf16 v[112:115], v[72:75], v[56:59], v[112:115]
    ds_read_b64_tr_b16 v[64:65], v16 offset:20800
    v_mfma_f32_16x16x32_bf16 v[116:119], v[68:71], v[20:23], v[116:119]
    ds_read_b64_tr_b16 v[66:67], v16 offset:21568
    v_mfma_f32_16x16x32_bf16 v[116:119], v[72:75], v[32:35], v[116:119]
    v_mfma_f32_16x16x32_bf16 v[120:123], v[68:71], v[36:39], v[120:123]
    v_mfma_f32_16x16x32_bf16 v[120:123], v[72:75], v[40:43], v[120:123]
    v_mfma_f32_16x16x32_bf16 v[124:127], v[68:71], v[44:47], v[124:127]
    v_mfma_f32_16x16x32_bf16 v[124:127], v[72:75], v[80:83], v[124:127]
    ds_read_b64_tr_b16 v[68:69], v16 offset:23872
    v_mfma_f32_16x16x32_bf16 v[160:163], v[48:51], v[52:55], v[160:163]
    ds_read_b64_tr_b16 v[70:71], v16 offset:24640
    s_waitcnt lgkmcnt(3)
    v_mfma_f32_16x16x32_bf16 v[160:163], v[84:87], v[56:59], v[160:163]
    ds_read_b64_tr_b16 v[72:73], v16 offset:27072
    v_mfma_f32_16x16x32_bf16 v[164:167], v[48:51], v[20:23], v[164:167]
    ds_read_b64_tr_b16 v[74:75], v16 offset:27840
    v_mfma_f32_16x16x32_bf16 v[164:167], v[84:87], v[32:35], v[164:167]
    v_mfma_f32_16x16x32_bf16 v[168:171], v[48:51], v[36:39], v[168:171]
    v_mfma_f32_16x16x32_bf16 v[168:171], v[84:87], v[40:43], v[168:171]
    v_mfma_f32_16x16x32_bf16 v[172:175], v[48:51], v[44:47], v[172:175]
    v_mfma_f32_16x16x32_bf16 v[172:175], v[84:87], v[80:83], v[172:175]
    ds_read_b64_tr_b16 v[48:49], v16 offset:30144
    v_mfma_f32_16x16x32_bf16 v[176:179], v[76:79], v[52:55], v[176:179]
    ds_read_b64_tr_b16 v[50:51], v16 offset:30912
    v_mfma_f32_16x16x32_bf16 v[176:179], v[92:95], v[56:59], v[176:179]
    v_mfma_f32_16x16x32_bf16 v[180:183], v[76:79], v[20:23], v[180:183]
    v_mfma_f32_16x16x32_bf16 v[180:183], v[92:95], v[32:35], v[180:183]
    v_mfma_f32_16x16x32_bf16 v[184:187], v[76:79], v[36:39], v[184:187]
    v_mfma_f32_16x16x32_bf16 v[184:187], v[92:95], v[40:43], v[184:187]
    v_mfma_f32_16x16x32_bf16 v[188:191], v[76:79], v[44:47], v[188:191]
    v_mfma_f32_16x16x32_bf16 v[188:191], v[92:95], v[80:83], v[188:191]
    v_mfma_f32_16x16x32_bf16 v[192:195], v[24:27], v[52:55], v[192:195]
    v_mfma_f32_16x16x32_bf16 v[192:195], v[88:91], v[56:59], v[192:195]
    v_mfma_f32_16x16x32_bf16 v[196:199], v[24:27], v[20:23], v[196:199]
    v_mfma_f32_16x16x32_bf16 v[196:199], v[88:91], v[32:35], v[196:199]
    v_mfma_f32_16x16x32_bf16 v[200:203], v[24:27], v[36:39], v[200:203]
    v_mfma_f32_16x16x32_bf16 v[200:203], v[88:91], v[40:43], v[200:203]
    v_mfma_f32_16x16x32_bf16 v[204:207], v[24:27], v[44:47], v[204:207]
    v_mfma_f32_16x16x32_bf16 v[204:207], v[88:91], v[80:83], v[204:207]
    v_mfma_f32_16x16x32_bf16 v[208:211], v[28:31], v[52:55], v[208:211]
    v_mfma_f32_16x16x32_bf16 v[208:211], v[60:63], v[56:59], v[208:211]
    v_mfma_f32_16x16x32_bf16 v[212:215], v[28:31], v[20:23], v[212:215]
    v_mfma_f32_16x16x32_bf16 v[212:215], v[60:63], v[32:35], v[212:215]
    v_mfma_f32_16x16x32_bf16 v[216:219], v[28:31], v[36:39], v[216:219]
    v_mfma_f32_16x16x32_bf16 v[216:219], v[60:63], v[40:43], v[216:219]
    v_mfma_f32_16x16x32_bf16 v[220:223], v[28:31], v[44:47], v[220:223]
    v_mfma_f32_16x16x32_bf16 v[220:223], v[60:63], v[80:83], v[220:223]
    s_waitcnt lgkmcnt(0)
    v_mfma_f32_16x16x32_bf16 v[224:227], v[64:67], v[52:55], v[224:227]
    s_barrier
    ds_read_b64_tr_b16 v[84:85], v14 offset:45568
    v_mfma_f32_16x16x32_bf16 v[224:227], v[68:71], v[56:59], v[224:227]
    ds_read_b64_tr_b16 v[86:87], v14 offset:45824
    v_mfma_f32_16x16x32_bf16 v[228:231], v[64:67], v[20:23], v[228:231]
    ds_read_b128 v[76:79], v12 offset:0
    v_mfma_f32_16x16x32_bf16 v[228:231], v[68:71], v[32:35], v[228:231]
    ds_read_b64_tr_b16 v[92:93], v14 offset:47616
    v_mfma_f32_16x16x32_bf16 v[232:235], v[64:67], v[36:39], v[232:235]
    ds_read_b64_tr_b16 v[94:95], v14 offset:47872
    v_mfma_f32_16x16x32_bf16 v[232:235], v[68:71], v[40:43], v[232:235]
    ds_read_b128 v[24:27], v13 offset:0
    v_mfma_f32_16x16x32_bf16 v[236:239], v[64:67], v[44:47], v[236:239]
    ds_read_b128 v[88:91], v12 offset:2048
    v_mfma_f32_16x16x32_bf16 v[236:239], v[68:71], v[80:83], v[236:239]
    ds_read_b128 v[28:31], v13 offset:2048
    v_mfma_f32_16x16x32_bf16 v[240:243], v[72:75], v[52:55], v[240:243]
    ds_read_b128 v[60:63], v12 offset:4096
    v_mfma_f32_16x16x32_bf16 v[240:243], v[48:51], v[56:59], v[240:243]
    ds_read_b128 v[64:67], v13 offset:4096
    v_mfma_f32_16x16x32_bf16 v[244:247], v[72:75], v[20:23], v[244:247]
    ds_read_b128 v[68:71], v12 offset:6144
    v_mfma_f32_16x16x32_bf16 v[244:247], v[48:51], v[32:35], v[244:247]
    ds_read_b128 v[52:55], v13 offset:6144
    v_mfma_f32_16x16x32_bf16 v[248:251], v[72:75], v[36:39], v[248:251]
    ds_read_b64_tr_b16 v[56:57], v15 offset:45568
    v_mfma_f32_16x16x32_bf16 v[248:251], v[48:51], v[40:43], v[248:251]
    ds_read_b64_tr_b16 v[58:59], v15 offset:45824
    v_mfma_f32_16x16x32_bf16 v[252:255], v[72:75], v[44:47], v[252:255]
    ds_read_b64_tr_b16 v[20:21], v15 offset:47616
    v_mfma_f32_16x16x32_bf16 v[252:255], v[48:51], v[80:83], v[252:255]
    ds_read_b64_tr_b16 v[22:23], v15 offset:47872
    s_waitcnt lgkmcnt(7)
    v_mfma_f32_16x16x32_bf16 v[128:131], v[84:87], v[76:79], v[128:131]
    ds_read_b64_tr_b16 v[32:33], v14 offset:41472
    v_mfma_f32_16x16x32_bf16 v[128:131], v[92:95], v[24:27], v[128:131]
    ds_read_b64_tr_b16 v[34:35], v14 offset:41728
    v_mfma_f32_16x16x32_bf16 v[132:135], v[84:87], v[88:91], v[132:135]
    ds_read_b64_tr_b16 v[36:37], v14 offset:43520
    v_mfma_f32_16x16x32_bf16 v[132:135], v[92:95], v[28:31], v[132:135]
    ds_read_b64_tr_b16 v[38:39], v14 offset:43776
    v_mfma_f32_16x16x32_bf16 v[136:139], v[84:87], v[60:63], v[136:139]
    ds_read_b64_tr_b16 v[40:41], v15 offset:41472
    s_waitcnt lgkmcnt(7)
    v_mfma_f32_16x16x32_bf16 v[136:139], v[92:95], v[64:67], v[136:139]
    ds_read_b64_tr_b16 v[42:43], v15 offset:41728
    v_mfma_f32_16x16x32_bf16 v[140:143], v[84:87], v[68:71], v[140:143]
    ds_read_b64_tr_b16 v[44:45], v15 offset:43520
    v_mfma_f32_16x16x32_bf16 v[140:143], v[92:95], v[52:55], v[140:143]
    ds_read_b64_tr_b16 v[46:47], v15 offset:43776
    v_mfma_f32_16x16x32_bf16 v[144:147], v[56:59], v[76:79], v[144:147]
    ds_read_b64_tr_b16 v[72:73], v16 offset:41472
    s_waitcnt lgkmcnt(7)
    v_mfma_f32_16x16x32_bf16 v[144:147], v[20:23], v[24:27], v[144:147]
    ds_read_b64_tr_b16 v[74:75], v16 offset:42240
    v_mfma_f32_16x16x32_bf16 v[148:151], v[56:59], v[88:91], v[148:151]
    ds_read_b64_tr_b16 v[80:81], v16 offset:44544
    v_mfma_f32_16x16x32_bf16 v[148:151], v[20:23], v[28:31], v[148:151]
    ds_read_b64_tr_b16 v[82:83], v16 offset:45312
    v_mfma_f32_16x16x32_bf16 v[152:155], v[56:59], v[60:63], v[152:155]
    ds_read_b64_tr_b16 v[48:49], v16 offset:47744
    v_mfma_f32_16x16x32_bf16 v[152:155], v[20:23], v[64:67], v[152:155]
    ds_read_b64_tr_b16 v[50:51], v16 offset:48512
    v_mfma_f32_16x16x32_bf16 v[156:159], v[56:59], v[68:71], v[156:159]
    ds_read_b64_tr_b16 v[84:85], v16 offset:50816
    v_mfma_f32_16x16x32_bf16 v[156:159], v[20:23], v[52:55], v[156:159]
    ds_read_b64_tr_b16 v[86:87], v16 offset:51584
    v_mfma_f32_16x16x32_bf16 v[96:99], v[32:35], v[76:79], v[96:99]
    ds_read_b64_tr_b16 v[92:93], v16 offset:41504
    s_waitcnt lgkmcnt(7)
    v_mfma_f32_16x16x32_bf16 v[96:99], v[36:39], v[24:27], v[96:99]
    ds_read_b64_tr_b16 v[94:95], v16 offset:42272
    v_mfma_f32_16x16x32_bf16 v[100:103], v[32:35], v[88:91], v[100:103]
    ds_read_b64_tr_b16 v[56:57], v16 offset:44576
    v_mfma_f32_16x16x32_bf16 v[100:103], v[36:39], v[28:31], v[100:103]
    ds_read_b64_tr_b16 v[58:59], v16 offset:45344
    v_mfma_f32_16x16x32_bf16 v[104:107], v[32:35], v[60:63], v[104:107]
    ds_read_b64_tr_b16 v[20:21], v16 offset:47776
    v_mfma_f32_16x16x32_bf16 v[104:107], v[36:39], v[64:67], v[104:107]
    ds_read_b64_tr_b16 v[22:23], v16 offset:48544
    v_mfma_f32_16x16x32_bf16 v[108:111], v[32:35], v[68:71], v[108:111]
    v_mfma_f32_16x16x32_bf16 v[108:111], v[36:39], v[52:55], v[108:111]
    ds_read_b64_tr_b16 v[32:33], v16 offset:50848
    v_mfma_f32_16x16x32_bf16 v[112:115], v[40:43], v[76:79], v[112:115]
    ds_read_b64_tr_b16 v[34:35], v16 offset:51616
    v_mfma_f32_16x16x32_bf16 v[112:115], v[44:47], v[24:27], v[112:115]
    ds_read_b64_tr_b16 v[36:37], v16 offset:41536
    v_mfma_f32_16x16x32_bf16 v[116:119], v[40:43], v[88:91], v[116:119]
    ds_read_b64_tr_b16 v[38:39], v16 offset:42304
    v_mfma_f32_16x16x32_bf16 v[116:119], v[44:47], v[28:31], v[116:119]
    v_mfma_f32_16x16x32_bf16 v[120:123], v[40:43], v[60:63], v[120:123]
    v_mfma_f32_16x16x32_bf16 v[120:123], v[44:47], v[64:67], v[120:123]
    v_mfma_f32_16x16x32_bf16 v[124:127], v[40:43], v[68:71], v[124:127]
    s_mov_b64 exec, 1
    buffer_load_dword v4, v1, s[44:47], 0 offen
    s_mov_b64 exec, -1
    s_add_u32 s72, s63, s69
    s_add_u32 s73, s64, s69
    v_mfma_f32_16x16x32_bf16 v[124:127], v[44:47], v[52:55], v[124:127]
    ds_read_b64_tr_b16 v[40:41], v16 offset:44608
    v_mfma_f32_16x16x32_bf16 v[160:163], v[72:75], v[76:79], v[160:163]
    ds_read_b64_tr_b16 v[42:43], v16 offset:45376
    s_waitcnt lgkmcnt(3)
    v_mfma_f32_16x16x32_bf16 v[160:163], v[80:83], v[24:27], v[160:163]
    ds_read_b64_tr_b16 v[44:45], v16 offset:47808
    v_mfma_f32_16x16x32_bf16 v[164:167], v[72:75], v[88:91], v[164:167]
    ds_read_b64_tr_b16 v[46:47], v16 offset:48576
    v_mfma_f32_16x16x32_bf16 v[164:167], v[80:83], v[28:31], v[164:167]
    v_mfma_f32_16x16x32_bf16 v[168:171], v[72:75], v[60:63], v[168:171]
    v_mfma_f32_16x16x32_bf16 v[168:171], v[80:83], v[64:67], v[168:171]
    v_mfma_f32_16x16x32_bf16 v[172:175], v[72:75], v[68:71], v[172:175]
    v_mfma_f32_16x16x32_bf16 v[172:175], v[80:83], v[52:55], v[172:175]
    ds_read_b64_tr_b16 v[72:73], v16 offset:50880
    v_mfma_f32_16x16x32_bf16 v[176:179], v[48:51], v[76:79], v[176:179]
    ds_read_b64_tr_b16 v[74:75], v16 offset:51648
    v_mfma_f32_16x16x32_bf16 v[176:179], v[84:87], v[24:27], v[176:179]
    v_mfma_f32_16x16x32_bf16 v[180:183], v[48:51], v[88:91], v[180:183]
    v_mfma_f32_16x16x32_bf16 v[180:183], v[84:87], v[28:31], v[180:183]
    v_mfma_f32_16x16x32_bf16 v[184:187], v[48:51], v[60:63], v[184:187]
    v_mfma_f32_16x16x32_bf16 v[184:187], v[84:87], v[64:67], v[184:187]
    v_mfma_f32_16x16x32_bf16 v[188:191], v[48:51], v[68:71], v[188:191]
    v_mfma_f32_16x16x32_bf16 v[188:191], v[84:87], v[52:55], v[188:191]
    v_mfma_f32_16x16x32_bf16 v[192:195], v[92:95], v[76:79], v[192:195]
    v_mfma_f32_16x16x32_bf16 v[192:195], v[56:59], v[24:27], v[192:195]
    v_mfma_f32_16x16x32_bf16 v[196:199], v[92:95], v[88:91], v[196:199]
    v_mfma_f32_16x16x32_bf16 v[196:199], v[56:59], v[28:31], v[196:199]
    v_mfma_f32_16x16x32_bf16 v[200:203], v[92:95], v[60:63], v[200:203]
    v_mfma_f32_16x16x32_bf16 v[200:203], v[56:59], v[64:67], v[200:203]
    v_mfma_f32_16x16x32_bf16 v[204:207], v[92:95], v[68:71], v[204:207]
    v_mfma_f32_16x16x32_bf16 v[204:207], v[56:59], v[52:55], v[204:207]
    v_mfma_f32_16x16x32_bf16 v[208:211], v[20:23], v[76:79], v[208:211]
    v_mfma_f32_16x16x32_bf16 v[208:211], v[32:35], v[24:27], v[208:211]
    v_mfma_f32_16x16x32_bf16 v[212:215], v[20:23], v[88:91], v[212:215]
    v_mfma_f32_16x16x32_bf16 v[212:215], v[32:35], v[28:31], v[212:215]
    v_mfma_f32_16x16x32_bf16 v[216:219], v[20:23], v[60:63], v[216:219]
    v_mfma_f32_16x16x32_bf16 v[216:219], v[32:35], v[64:67], v[216:219]
    v_mfma_f32_16x16x32_bf16 v[220:223], v[20:23], v[68:71], v[220:223]
    v_mfma_f32_16x16x32_bf16 v[220:223], v[32:35], v[52:55], v[220:223]
    s_waitcnt lgkmcnt(0)
    v_mfma_f32_16x16x32_bf16 v[224:227], v[36:39], v[76:79], v[224:227]
    s_barrier
    ds_read_b64_tr_b16 v[80:81], v14 offset:4096
    v_mfma_f32_16x16x32_bf16 v[224:227], v[40:43], v[24:27], v[224:227]
    ds_read_b64_tr_b16 v[82:83], v14 offset:4352
    v_mfma_f32_16x16x32_bf16 v[228:231], v[36:39], v[88:91], v[228:231]
    ds_read_b128 v[48:51], v10 offset:0
    v_mfma_f32_16x16x32_bf16 v[228:231], v[40:43], v[28:31], v[228:231]
    ds_read_b64_tr_b16 v[84:85], v14 offset:6144
    v_mfma_f32_16x16x32_bf16 v[232:235], v[36:39], v[60:63], v[232:235]
    ds_read_b64_tr_b16 v[86:87], v14 offset:6400
    v_mfma_f32_16x16x32_bf16 v[232:235], v[40:43], v[64:67], v[232:235]
    ds_read_b128 v[92:95], v11 offset:0
    v_mfma_f32_16x16x32_bf16 v[236:239], v[36:39], v[68:71], v[236:239]
    ds_read_b128 v[56:59], v10 offset:2048
    v_mfma_f32_16x16x32_bf16 v[236:239], v[40:43], v[52:55], v[236:239]
    ds_read_b128 v[20:23], v11 offset:2048
    v_mfma_f32_16x16x32_bf16 v[240:243], v[44:47], v[76:79], v[240:243]
    ds_read_b128 v[32:35], v10 offset:4096
    v_mfma_f32_16x16x32_bf16 v[240:243], v[72:75], v[24:27], v[240:243]
    ds_read_b128 v[36:39], v11 offset:4096
    v_mfma_f32_16x16x32_bf16 v[244:247], v[44:47], v[88:91], v[244:247]
    ds_read_b128 v[40:43], v10 offset:6144
    v_mfma_f32_16x16x32_bf16 v[244:247], v[72:75], v[28:31], v[244:247]
    ds_read_b128 v[76:79], v11 offset:6144
    v_mfma_f32_16x16x32_bf16 v[248:251], v[44:47], v[60:63], v[248:251]
    ds_read_b64_tr_b16 v[24:25], v15 offset:4096
    v_mfma_f32_16x16x32_bf16 v[248:251], v[72:75], v[64:67], v[248:251]
    ds_read_b64_tr_b16 v[26:27], v15 offset:4352
    v_mfma_f32_16x16x32_bf16 v[252:255], v[44:47], v[68:71], v[252:255]
    ds_read_b64_tr_b16 v[88:89], v15 offset:6144
    v_mfma_f32_16x16x32_bf16 v[252:255], v[72:75], v[52:55], v[252:255]
    ds_read_b64_tr_b16 v[90:91], v15 offset:6400
    s_waitcnt lgkmcnt(7)
    v_mfma_f32_16x16x32_bf16 v[128:131], v[80:83], v[48:51], v[128:131]
    ds_read_b64_tr_b16 v[28:29], v14 offset:0
    v_mfma_f32_16x16x32_bf16 v[128:131], v[84:87], v[92:95], v[128:131]
    ds_read_b64_tr_b16 v[30:31], v14 offset:256
    v_mfma_f32_16x16x32_bf16 v[132:135], v[80:83], v[56:59], v[132:135]
    ds_read_b64_tr_b16 v[60:61], v14 offset:2048
    v_mfma_f32_16x16x32_bf16 v[132:135], v[84:87], v[20:23], v[132:135]
    ds_read_b64_tr_b16 v[62:63], v14 offset:2304
    v_mfma_f32_16x16x32_bf16 v[136:139], v[80:83], v[32:35], v[136:139]
    ds_read_b64_tr_b16 v[64:65], v15 offset:0
    s_waitcnt lgkmcnt(7)
    v_mfma_f32_16x16x32_bf16 v[136:139], v[84:87], v[36:39], v[136:139]
    ds_read_b64_tr_b16 v[66:67], v15 offset:256
    v_mfma_f32_16x16x32_bf16 v[140:143], v[80:83], v[40:43], v[140:143]
    ds_read_b64_tr_b16 v[68:69], v15 offset:2048
    v_mfma_f32_16x16x32_bf16 v[140:143], v[84:87], v[76:79], v[140:143]
    ds_read_b64_tr_b16 v[70:71], v15 offset:2304
    v_mfma_f32_16x16x32_bf16 v[144:147], v[24:27], v[48:51], v[144:147]
    ds_read_b64_tr_b16 v[44:45], v16 offset:0
    s_waitcnt lgkmcnt(7)
    v_mfma_f32_16x16x32_bf16 v[144:147], v[88:91], v[92:95], v[144:147]
    ds_read_b64_tr_b16 v[46:47], v16 offset:768
    v_mfma_f32_16x16x32_bf16 v[148:151], v[24:27], v[56:59], v[148:151]
    ds_read_b64_tr_b16 v[52:53], v16 offset:3072
    v_mfma_f32_16x16x32_bf16 v[148:151], v[88:91], v[20:23], v[148:151]
    ds_read_b64_tr_b16 v[54:55], v16 offset:3840
    v_mfma_f32_16x16x32_bf16 v[152:155], v[24:27], v[32:35], v[152:155]
    ds_read_b64_tr_b16 v[72:73], v16 offset:6272
    v_mfma_f32_16x16x32_bf16 v[152:155], v[88:91], v[36:39], v[152:155]
    ds_read_b64_tr_b16 v[74:75], v16 offset:7040
    v_mfma_f32_16x16x32_bf16 v[156:159], v[24:27], v[40:43], v[156:159]
    ds_read_b64_tr_b16 v[80:81], v16 offset:9344
    v_mfma_f32_16x16x32_bf16 v[156:159], v[88:91], v[76:79], v[156:159]
    ds_read_b64_tr_b16 v[82:83], v16 offset:10112
    v_mfma_f32_16x16x32_bf16 v[96:99], v[28:31], v[48:51], v[96:99]
    ds_read_b64_tr_b16 v[84:85], v16 offset:32
    s_waitcnt lgkmcnt(7)
    v_mfma_f32_16x16x32_bf16 v[96:99], v[60:63], v[92:95], v[96:99]
    ds_read_b64_tr_b16 v[86:87], v16 offset:800
    v_mfma_f32_16x16x32_bf16 v[100:103], v[28:31], v[56:59], v[100:103]
    ds_read_b64_tr_b16 v[24:25], v16 offset:3104
    v_mov_b32 v2, 0x3f803f80
    v_mfma_f32_16x16x32_bf16 v[100:103], v[60:63], v[20:23], v[100:103]
    ds_read_b64_tr_b16 v[26:27], v16 offset:3872
    v_cvt_pk_bf16_f32 v128, v128, v129
    v_mfma_f32_16x16x32_bf16 v[104:107], v[28:31], v[32:35], v[104:107]
    ds_read_b64_tr_b16 v[88:89], v16 offset:6304
    v_cvt_pk_bf16_f32 v129, v130, v131
    v_mfma_f32_16x16x32_bf16 v[104:107], v[60:63], v[36:39], v[104:107]
    ds_read_b64_tr_b16 v[90:91], v16 offset:7072
    v_cvt_pk_bf16_f32 v130, v132, v133
    v_mfma_f32_16x16x32_bf16 v[108:111], v[28:31], v[40:43], v[108:111]
    v_cvt_pk_bf16_f32 v131, v134, v135
    v_mfma_f32_16x16x32_bf16 v[108:111], v[60:63], v[76:79], v[108:111]
    ds_read_b64_tr_b16 v[28:29], v16 offset:9376
    v_cvt_pk_bf16_f32 v132, v136, v137
    v_mfma_f32_16x16x32_bf16 v[112:115], v[64:67], v[48:51], v[112:115]
    ds_read_b64_tr_b16 v[30:31], v16 offset:10144
    v_cvt_pk_bf16_f32 v133, v138, v139
    v_mfma_f32_16x16x32_bf16 v[112:115], v[68:71], v[92:95], v[112:115]
    ds_read_b64_tr_b16 v[60:61], v16 offset:64
    v_cvt_pk_bf16_f32 v134, v140, v141
    v_mfma_f32_16x16x32_bf16 v[116:119], v[64:67], v[56:59], v[116:119]
    ds_read_b64_tr_b16 v[62:63], v16 offset:832
    v_cvt_pk_bf16_f32 v135, v142, v143
    v_mfma_f32_16x16x32_bf16 v[116:119], v[68:71], v[20:23], v[116:119]
    v_cvt_pk_bf16_f32 v144, v144, v145
    v_mfma_f32_16x16x32_bf16 v[120:123], v[64:67], v[32:35], v[120:123]
    v_cvt_pk_bf16_f32 v145, v146, v147
    v_mfma_f32_16x16x32_bf16 v[120:123], v[68:71], v[36:39], v[120:123]
    v_cvt_pk_bf16_f32 v146, v148, v149
    v_mfma_f32_16x16x32_bf16 v[124:127], v[64:67], v[40:43], v[124:127]
    v_cvt_pk_bf16_f32 v147, v150, v151
    v_mfma_f32_16x16x32_bf16 v[124:127], v[68:71], v[76:79], v[124:127]
    ds_read_b64_tr_b16 v[64:65], v16 offset:3136
    v_cvt_pk_bf16_f32 v148, v152, v153
    v_mfma_f32_16x16x32_bf16 v[160:163], v[44:47], v[48:51], v[160:163]
    ds_read_b64_tr_b16 v[66:67], v16 offset:3904
    v_cvt_pk_bf16_f32 v149, v154, v155
    s_waitcnt lgkmcnt(3)
    v_mfma_f32_16x16x32_bf16 v[160:163], v[52:55], v[92:95], v[160:163]
    ds_read_b64_tr_b16 v[68:69], v16 offset:6336
    v_cvt_pk_bf16_f32 v150, v156, v157
    v_mfma_f32_16x16x32_bf16 v[164:167], v[44:47], v[56:59], v[164:167]
    ds_read_b64_tr_b16 v[70:71], v16 offset:7104
    v_cvt_pk_bf16_f32 v151, v158, v159
    v_mfma_f32_16x16x32_bf16 v[164:167], v[52:55], v[20:23], v[164:167]
    v_cvt_pk_bf16_f32 v136, v96, v97
    v_mfma_f32_16x16x32_bf16 v[168:171], v[44:47], v[32:35], v[168:171]
    v_cvt_pk_bf16_f32 v137, v98, v99
    v_mfma_f32_16x16x32_bf16 v[168:171], v[52:55], v[36:39], v[168:171]
    v_cvt_pk_bf16_f32 v138, v100, v101
    v_mfma_f32_16x16x32_bf16 v[172:175], v[44:47], v[40:43], v[172:175]
    v_cvt_pk_bf16_f32 v139, v102, v103
    v_mfma_f32_16x16x32_bf16 v[172:175], v[52:55], v[76:79], v[172:175]
    ds_read_b64_tr_b16 v[44:45], v16 offset:9408
    v_cvt_pk_bf16_f32 v152, v104, v105
    v_mfma_f32_16x16x32_bf16 v[176:179], v[72:75], v[48:51], v[176:179]
    ds_read_b64_tr_b16 v[46:47], v16 offset:10176
    ds_read_b64_tr_b16 v[12:13], v6 offset:0
    ds_read_b64_tr_b16 v[14:15], v6 offset:320
    ds_read_b64_tr_b16 v[16:17], v6 offset:1280
    ds_read_b64_tr_b16 v[18:19], v6 offset:1600
    v_cvt_pk_bf16_f32 v153, v106, v107
    v_mfma_f32_16x16x32_bf16 v[176:179], v[80:83], v[92:95], v[176:179]
    v_cvt_pk_bf16_f32 v154, v108, v109
    v_mfma_f32_16x16x32_bf16 v[180:183], v[72:75], v[56:59], v[180:183]
    v_cvt_pk_bf16_f32 v155, v110, v111
    v_mfma_f32_16x16x32_bf16 v[180:183], v[80:83], v[20:23], v[180:183]
    v_cvt_pk_bf16_f32 v140, v112, v113
    v_mfma_f32_16x16x32_bf16 v[184:187], v[72:75], v[32:35], v[184:187]
    v_cvt_pk_bf16_f32 v141, v114, v115
    v_mfma_f32_16x16x32_bf16 v[184:187], v[80:83], v[36:39], v[184:187]
    v_cvt_pk_bf16_f32 v142, v116, v117
    v_mfma_f32_16x16x32_bf16 v[188:191], v[72:75], v[40:43], v[188:191]
    v_cvt_pk_bf16_f32 v143, v118, v119
    v_mfma_f32_16x16x32_bf16 v[188:191], v[80:83], v[76:79], v[188:191]
    v_cvt_pk_bf16_f32 v156, v120, v121
    v_mfma_f32_16x16x32_bf16 v[192:195], v[84:87], v[48:51], v[192:195]
    v_cvt_pk_bf16_f32 v157, v122, v123
    v_mfma_f32_16x16x32_bf16 v[192:195], v[24:27], v[92:95], v[192:195]
    v_cvt_pk_bf16_f32 v158, v124, v125
    v_mfma_f32_16x16x32_bf16 v[196:199], v[84:87], v[56:59], v[196:199]
    v_cvt_pk_bf16_f32 v159, v126, v127
    v_mfma_f32_16x16x32_bf16 v[196:199], v[24:27], v[20:23], v[196:199]
    v_permlane16_swap_b32 v136, v138
    v_mfma_f32_16x16x32_bf16 v[200:203], v[84:87], v[32:35], v[200:203]
    v_permlane16_swap_b32 v137, v139
    v_mfma_f32_16x16x32_bf16 v[200:203], v[24:27], v[36:39], v[200:203]
    v_permlane16_swap_b32 v152, v154
    v_mfma_f32_16x16x32_bf16 v[204:207], v[84:87], v[40:43], v[204:207]
    v_permlane16_swap_b32 v153, v155
    v_mfma_f32_16x16x32_bf16 v[204:207], v[24:27], v[76:79], v[204:207]
    v_permlane16_swap_b32 v140, v142
    v_mfma_f32_16x16x32_bf16 v[208:211], v[88:91], v[48:51], v[208:211]
    v_permlane16_swap_b32 v141, v143
    v_mfma_f32_16x16x32_bf16 v[208:211], v[28:31], v[92:95], v[208:211]
    v_permlane16_swap_b32 v156, v158
    v_mfma_f32_16x16x32_bf16 v[212:215], v[88:91], v[56:59], v[212:215]
    v_permlane16_swap_b32 v157, v159
    v_mfma_f32_16x16x32_bf16 v[212:215], v[28:31], v[20:23], v[212:215]
    s_waitcnt lgkmcnt(0)
    v_mfma_f32_32x32x16_bf16 v[96:111], v[12:15], v[136:139], 0
    v_mfma_f32_32x32x16_bf16 v[96:111], v[16:19], v[140:143], v[96:111]
    v_mfma_f32_32x32x16_bf16 v[112:127], v[12:15], v[152:155], 0
    v_mfma_f32_32x32x16_bf16 v[112:127], v[16:19], v[156:159], v[112:127]
    v_mfma_f32_16x16x32_bf16 v[216:219], v[88:91], v[32:35], v[216:219]
    v_cndmask_b32 v144, v144, v2, s[40:41]
    v_mfma_f32_16x16x32_bf16 v[216:219], v[28:31], v[36:39], v[216:219]
    v_cndmask_b32 v146, v146, v2, s[40:41]
    v_mfma_f32_16x16x32_bf16 v[220:223], v[88:91], v[40:43], v[220:223]
    v_cndmask_b32 v148, v148, v2, s[40:41]
    v_mfma_f32_16x16x32_bf16 v[220:223], v[28:31], v[76:79], v[220:223]
    v_cndmask_b32 v150, v150, v2, s[40:41]
    v_mfma_f32_16x16x32_bf16 v[224:227], v[60:63], v[48:51], v[224:227]
    s_nop 0
    v_max3_f32 v110, v96, v97, v98
    v_mfma_f32_16x16x32_bf16 v[224:227], v[64:67], v[92:95], v[224:227]
    v_min3_f32 v111, v96, v97, v98
    v_mfma_f32_16x16x32_bf16 v[228:231], v[60:63], v[56:59], v[228:231]
    v_max3_f32 v110, v110, v99, v100
    v_mfma_f32_16x16x32_bf16 v[228:231], v[64:67], v[20:23], v[228:231]
    v_min3_f32 v111, v111, v99, v100
    v_mfma_f32_16x16x32_bf16 v[232:235], v[60:63], v[32:35], v[232:235]
    v_max3_f32 v110, v110, v101, v102
    v_mfma_f32_16x16x32_bf16 v[232:235], v[64:67], v[36:39], v[232:235]
    v_min3_f32 v111, v111, v101, v102
    v_mfma_f32_16x16x32_bf16 v[236:239], v[60:63], v[40:43], v[236:239]
    v_max3_f32 v110, v110, v103, v104
    v_mfma_f32_16x16x32_bf16 v[236:239], v[64:67], v[76:79], v[236:239]
    v_min3_f32 v111, v111, v103, v104
    v_mfma_f32_16x16x32_bf16 v[240:243], v[68:71], v[48:51], v[240:243]
    v_max3_f32 v110, v110, v105, v106
    v_mfma_f32_16x16x32_bf16 v[240:243], v[44:47], v[92:95], v[240:243]
    v_min3_f32 v111, v111, v105, v106
    v_mfma_f32_16x16x32_bf16 v[244:247], v[68:71], v[56:59], v[244:247]
    v_max3_f32 v110, v110, v107, v108
    v_mfma_f32_16x16x32_bf16 v[244:247], v[44:47], v[20:23], v[244:247]
    v_min3_f32 v111, v111, v107, v108
    v_mfma_f32_16x16x32_bf16 v[248:251], v[68:71], v[32:35], v[248:251]
    v_max_f32 v110, v110, v109
    v_mfma_f32_16x16x32_bf16 v[248:251], v[44:47], v[36:39], v[248:251]
    v_min_f32 v111, v111, v109
    v_mfma_f32_16x16x32_bf16 v[252:255], v[68:71], v[40:43], v[252:255]
    v_mul_f32 v110, s80, v110
    v_mfma_f32_16x16x32_bf16 v[252:255], v[44:47], v[76:79], v[252:255]
    v_mul_f32 v111, s82, v111
    s_nop 1
    v_permlane32_swap_b32 v110, v111
    v_min_f32 v110, v110, v111
    v_mov_b32 v2, v110
    s_nop 1
    v_permlane32_swap_b32 v110, v2
    v_and_b32 v22, 0xffff, v7
    v_lshrrev_b32 v24, 16, v7
    v_add_u32 v23, 65536, v22
    v_add_u32 v25, 65536, v24
    v_pk_fma_f32 v[64:65], v[96:97], s[82:83], v[110:111] op_sel_hi:[1,1,0]
    v_pk_fma_f32 v[96:97], v[96:97], s[80:81], v[2:3] op_sel_hi:[1,1,0]
    v_pk_fma_f32 v[66:67], v[98:99], s[82:83], v[110:111] op_sel_hi:[1,1,0]
    v_pk_fma_f32 v[98:99], v[98:99], s[80:81], v[2:3] op_sel_hi:[1,1,0]
    v_pk_fma_f32 v[68:69], v[100:101], s[82:83], v[110:111] op_sel_hi:[1,1,0]
    v_pk_fma_f32 v[100:101], v[100:101], s[80:81], v[2:3] op_sel_hi:[1,1,0]
    v_pk_fma_f32 v[70:71], v[102:103], s[82:83], v[110:111] op_sel_hi:[1,1,0]
    v_pk_fma_f32 v[102:103], v[102:103], s[80:81], v[2:3] op_sel_hi:[1,1,0]
    v_pk_fma_f32 v[72:73], v[104:105], s[82:83], v[110:111] op_sel_hi:[1,1,0]
    v_pk_fma_f32 v[104:105], v[104:105], s[80:81], v[2:3] op_sel_hi:[1,1,0]
    v_pk_fma_f32 v[74:75], v[106:107], s[82:83], v[110:111] op_sel_hi:[1,1,0]
    v_max3_f32 v126, v112, v113, v114
    v_pk_fma_f32 v[106:107], v[106:107], s[80:81], v[2:3] op_sel_hi:[1,1,0]
    v_min3_f32 v127, v112, v113, v114
    v_pk_fma_f32 v[76:77], v[108:109], s[82:83], v[110:111] op_sel_hi:[1,1,0]
    v_max3_f32 v126, v126, v115, v116
    v_pk_fma_f32 v[108:109], v[108:109], s[80:81], v[2:3] op_sel_hi:[1,1,0]
    v_min3_f32 v127, v127, v115, v116
    v_exp_f32 v64, v64
    v_max3_f32 v126, v126, v117, v118
    v_exp_f32 v96, v96
    v_min3_f32 v127, v127, v117, v118
    v_exp_f32 v65, v65
    v_max3_f32 v126, v126, v119, v120
    v_exp_f32 v97, v97
    v_min3_f32 v127, v127, v119, v120
    v_exp_f32 v66, v66
    v_max3_f32 v126, v126, v121, v122
    v_exp_f32 v98, v98
    v_min3_f32 v127, v127, v121, v122
    v_exp_f32 v67, v67
    v_max3_f32 v126, v126, v123, v124
    v_exp_f32 v99, v99
    v_min3_f32 v127, v127, v123, v124
    v_exp_f32 v68, v68
    v_max_f32 v126, v126, v125
    v_exp_f32 v100, v100
    v_min_f32 v127, v127, v125
    v_exp_f32 v69, v69
    v_mul_f32 v126, s80, v126
    v_exp_f32 v101, v101
    v_mul_f32 v127, s82, v127
    v_exp_f32 v70, v70
    s_nop 0
    v_permlane32_swap_b32 v126, v127
    v_exp_f32 v102, v102
    v_min_f32 v126, v126, v127
    v_exp_f32 v71, v71
    v_mov_b32 v10, v126
    v_exp_f32 v103, v103
    s_nop 0
    v_permlane32_swap_b32 v126, v10
    v_exp_f32 v72, v72
    v_pk_fma_f32 v[80:81], v[112:113], s[82:83], v[126:127] op_sel_hi:[1,1,0]
    v_exp_f32 v104, v104
    v_pk_fma_f32 v[112:113], v[112:113], s[80:81], v[10:11] op_sel_hi:[1,1,0]
    v_exp_f32 v73, v73
    v_pk_fma_f32 v[82:83], v[114:115], s[82:83], v[126:127] op_sel_hi:[1,1,0]
    v_exp_f32 v105, v105
    v_pk_fma_f32 v[114:115], v[114:115], s[80:81], v[10:11] op_sel_hi:[1,1,0]
    v_exp_f32 v74, v74
    v_pk_fma_f32 v[84:85], v[116:117], s[82:83], v[126:127] op_sel_hi:[1,1,0]
    v_exp_f32 v106, v106
    v_pk_fma_f32 v[116:117], v[116:117], s[80:81], v[10:11] op_sel_hi:[1,1,0]
    v_exp_f32 v75, v75
    v_pk_fma_f32 v[86:87], v[118:119], s[82:83], v[126:127] op_sel_hi:[1,1,0]
    v_exp_f32 v107, v107
    v_pk_fma_f32 v[118:119], v[118:119], s[80:81], v[10:11] op_sel_hi:[1,1,0]
    v_exp_f32 v76, v76
    v_pk_fma_f32 v[88:89], v[120:121], s[82:83], v[126:127] op_sel_hi:[1,1,0]
    v_exp_f32 v108, v108
    v_pk_fma_f32 v[120:121], v[120:121], s[80:81], v[10:11] op_sel_hi:[1,1,0]
    v_exp_f32 v77, v77
    v_pk_fma_f32 v[90:91], v[122:123], s[82:83], v[126:127] op_sel_hi:[1,1,0]
    v_exp_f32 v109, v109
    v_pk_fma_f32 v[122:123], v[122:123], s[80:81], v[10:11] op_sel_hi:[1,1,0]
    v_pk_add_f32 v[110:111], v[64:65], v[66:67]
    v_pk_fma_f32 v[92:93], v[124:125], s[82:83], v[126:127] op_sel_hi:[1,1,0]
    v_pk_add_f32 v[2:3], v[96:97], v[98:99]
    v_pk_fma_f32 v[124:125], v[124:125], s[80:81], v[10:11] op_sel_hi:[1,1,0]
    v_pk_add_f32 v[110:111], v[110:111], v[68:69]
    v_exp_f32 v80, v80
    v_pk_add_f32 v[2:3], v[2:3], v[100:101]
    v_exp_f32 v112, v112
    v_pk_add_f32 v[110:111], v[110:111], v[70:71]
    v_exp_f32 v81, v81
    v_pk_add_f32 v[2:3], v[2:3], v[102:103]
    v_exp_f32 v113, v113
    v_pk_add_f32 v[110:111], v[110:111], v[72:73]
    v_exp_f32 v82, v82
    v_pk_add_f32 v[2:3], v[2:3], v[104:105]
    v_exp_f32 v114, v114
    v_pk_add_f32 v[110:111], v[110:111], v[74:75]
    v_exp_f32 v83, v83
    v_pk_add_f32 v[2:3], v[2:3], v[106:107]
    v_exp_f32 v115, v115
    v_pk_add_f32 v[110:111], v[110:111], v[76:77]
    v_exp_f32 v84, v84
    v_pk_add_f32 v[2:3], v[2:3], v[108:109]
    v_exp_f32 v116, v116
    v_add_f32 v110, v110, v111
    v_exp_f32 v85, v85
    v_add_f32 v111, v2, v3
    v_exp_f32 v117, v117
    s_nop 0
    v_permlane32_swap_b32 v110, v111
    v_exp_f32 v86, v86
    v_add_f32 v110, v110, v111
    v_exp_f32 v118, v118
    v_rcp_f32 v110, v110
    v_exp_f32 v87, v87
    v_mov_b32 v2, v110
    v_exp_f32 v119, v119
    s_nop 0
    v_permlane32_swap_b32 v110, v2
    v_exp_f32 v88, v88
    v_pk_mul_f32 v[64:65], v[64:65], v[110:111] op_sel_hi:[1,0]
    v_exp_f32 v120, v120
    v_pk_mul_f32 v[96:97], v[96:97], v[2:3] op_sel_hi:[1,0]
    v_exp_f32 v89, v89
    v_pk_mul_f32 v[66:67], v[66:67], v[110:111] op_sel_hi:[1,0]
    v_exp_f32 v121, v121
    v_pk_mul_f32 v[98:99], v[98:99], v[2:3] op_sel_hi:[1,0]
    v_exp_f32 v90, v90
    v_pk_mul_f32 v[68:69], v[68:69], v[110:111] op_sel_hi:[1,0]
    v_exp_f32 v122, v122
    v_pk_mul_f32 v[100:101], v[100:101], v[2:3] op_sel_hi:[1,0]
    v_exp_f32 v91, v91
    v_pk_mul_f32 v[70:71], v[70:71], v[110:111] op_sel_hi:[1,0]
    v_exp_f32 v123, v123
    v_pk_mul_f32 v[102:103], v[102:103], v[2:3] op_sel_hi:[1,0]
    v_exp_f32 v92, v92
    v_pk_mul_f32 v[72:73], v[72:73], v[110:111] op_sel_hi:[1,0]
    v_exp_f32 v124, v124
    v_pk_mul_f32 v[104:105], v[104:105], v[2:3] op_sel_hi:[1,0]
    v_exp_f32 v93, v93
    v_pk_mul_f32 v[74:75], v[74:75], v[110:111] op_sel_hi:[1,0]
    ds_write_b64 v24, v[128:129] offset:128
    v_exp_f32 v125, v125
    v_pk_mul_f32 v[106:107], v[106:107], v[2:3] op_sel_hi:[1,0]
    v_pk_add_f32 v[126:127], v[80:81], v[82:83]
    v_pk_mul_f32 v[76:77], v[76:77], v[110:111] op_sel_hi:[1,0]
    ds_write_b64 v24, v[144:145] offset:160
    v_pk_add_f32 v[10:11], v[112:113], v[114:115]
    v_pk_mul_f32 v[108:109], v[108:109], v[2:3] op_sel_hi:[1,0]
    v_pk_add_f32 v[126:127], v[126:127], v[84:85]
    v_cvt_pk_bf16_f32 v136, v64, v65
    ds_write_b64 v24, v[130:131] offset:3328
    v_pk_add_f32 v[10:11], v[10:11], v[116:117]
    v_cvt_pk_bf16_f32 v96, v96, v97
    v_pk_add_f32 v[126:127], v[126:127], v[86:87]
    v_cvt_pk_bf16_f32 v137, v66, v67
    ds_write_b64 v24, v[146:147] offset:3360
    v_pk_add_f32 v[10:11], v[10:11], v[118:119]
    v_cvt_pk_bf16_f32 v97, v98, v99
    v_pk_add_f32 v[126:127], v[126:127], v[88:89]
    v_cvt_pk_bf16_f32 v138, v68, v69
    ds_write_b64 v25, v[132:133] offset:128
    v_pk_add_f32 v[10:11], v[10:11], v[120:121]
    v_cvt_pk_bf16_f32 v98, v100, v101
    v_pk_add_f32 v[126:127], v[126:127], v[90:91]
    v_cvt_pk_bf16_f32 v139, v70, v71
    ds_write_b64 v25, v[148:149] offset:160
    v_pk_add_f32 v[10:11], v[10:11], v[122:123]
    v_cvt_pk_bf16_f32 v99, v102, v103
    v_pk_add_f32 v[126:127], v[126:127], v[92:93]
    v_cvt_pk_bf16_f32 v140, v72, v73
    ds_write_b64 v25, v[134:135] offset:3328
    v_pk_add_f32 v[10:11], v[10:11], v[124:125]
    v_cvt_pk_bf16_f32 v100, v104, v105
    v_add_f32 v126, v126, v127
    v_cvt_pk_bf16_f32 v141, v74, v75
    ds_write_b64 v25, v[150:151] offset:3360
    v_add_f32 v127, v10, v11
    v_cvt_pk_bf16_f32 v101, v106, v107
    s_nop 0
    v_permlane32_swap_b32 v126, v127
    v_cvt_pk_bf16_f32 v142, v76, v77
    v_add_f32 v126, v126, v127
    v_cvt_pk_bf16_f32 v102, v108, v109
    v_rcp_f32 v126, v126
    v_mov_b32 v143, 0
    v_mov_b32 v10, v126
    v_mov_b32 v103, 0
    s_nop 0
    v_permlane32_swap_b32 v126, v10
    v_pk_mul_f32 v[80:81], v[80:81], v[126:127] op_sel_hi:[1,0]
    ds_write_b64 v22, v[136:137] offset:0
    v_pk_mul_f32 v[112:113], v[112:113], v[10:11] op_sel_hi:[1,0]
    v_pk_mul_f32 v[82:83], v[82:83], v[126:127] op_sel_hi:[1,0]
    v_pk_mul_f32 v[114:115], v[114:115], v[10:11] op_sel_hi:[1,0]
    ds_write_b64 v22, v[96:97] offset:64
    v_pk_mul_f32 v[84:85], v[84:85], v[126:127] op_sel_hi:[1,0]
    v_pk_mul_f32 v[116:117], v[116:117], v[10:11] op_sel_hi:[1,0]
    v_pk_mul_f32 v[86:87], v[86:87], v[126:127] op_sel_hi:[1,0]
    ds_write_b64 v22, v[138:139] offset:16
    v_pk_mul_f32 v[118:119], v[118:119], v[10:11] op_sel_hi:[1,0]
    v_pk_mul_f32 v[88:89], v[88:89], v[126:127] op_sel_hi:[1,0]
    v_pk_mul_f32 v[120:121], v[120:121], v[10:11] op_sel_hi:[1,0]
    ds_write_b64 v22, v[98:99] offset:80
    v_pk_mul_f32 v[90:91], v[90:91], v[126:127] op_sel_hi:[1,0]
    v_pk_mul_f32 v[122:123], v[122:123], v[10:11] op_sel_hi:[1,0]
    v_pk_mul_f32 v[92:93], v[92:93], v[126:127] op_sel_hi:[1,0]
    ds_write_b64 v22, v[140:141] offset:32
    v_pk_mul_f32 v[124:125], v[124:125], v[10:11] op_sel_hi:[1,0]
    v_cvt_pk_bf16_f32 v152, v80, v81
    v_cvt_pk_bf16_f32 v112, v112, v113
    ds_write_b64 v22, v[100:101] offset:96
    v_cvt_pk_bf16_f32 v153, v82, v83
    v_cvt_pk_bf16_f32 v113, v114, v115
    v_cvt_pk_bf16_f32 v154, v84, v85
    ds_write_b64 v22, v[142:143] offset:48
    v_cvt_pk_bf16_f32 v114, v116, v117
    v_cvt_pk_bf16_f32 v155, v86, v87
    v_cvt_pk_bf16_f32 v115, v118, v119
    ds_write_b64 v22, v[102:103] offset:112
    v_cvt_pk_bf16_f32 v156, v88, v89
    v_cvt_pk_bf16_f32 v116, v120, v121
    v_cvt_pk_bf16_f32 v157, v90, v91
    v_cvt_pk_bf16_f32 v117, v122, v123
    v_cvt_pk_bf16_f32 v158, v92, v93
    v_cvt_pk_bf16_f32 v118, v124, v125
    v_mov_b32 v159, 0
    v_mov_b32 v119, 0
    ds_write_b64 v23, v[152:153] offset:0
    ds_write_b64 v23, v[112:113] offset:64
    ds_write_b64 v23, v[154:155] offset:16
    ds_write_b64 v23, v[114:115] offset:80
    ds_write_b64 v23, v[156:157] offset:32
    ds_write_b64 v23, v[116:117] offset:96
    ds_write_b64 v23, v[158:159] offset:48
    ds_write_b64 v23, v[118:119] offset:112
    v_mov_b32 v2, 1
    s_mov_b64 exec, 1
    ds_add_u32 v5, v2 offset:0
    s_mov_b64 exec, -1
    v_lshrrev_b32 v41, 5, v0
    v_bfe_u32 v40, v0, 2, 3
    v_lshl_add_u32 v40, v40, 1, v41
    v_and_b32 v41, 3, v0
    v_mul_u32_u24 v40, 400, v40
    v_lshl_add_u32 v48, v41, 3, v40
    v_add_u32 v49, 65536, v48
    v_lshl_add_u32 v46, s48, 5, v48
    v_add_u32 v47, 65536, v46
    s_waitcnt vmcnt(0)
    s_mov_b32 s3, 200000
    s_branch L_73
L_72:
    s_mov_b64 exec, 1
    buffer_load_dword v4, v1, s[44:47], 0 offen sc1
    s_mov_b64 exec, -1
    s_sub_u32 s3, s3, 1
    s_waitcnt vmcnt(0)
    s_cbranch_scc1 L_74
L_73:
    v_readfirstlane_b32 s0, v4
    s_nop 0
    s_cmp_eq_u32 s0, 0
    s_cbranch_scc1 L_72
L_74:
    s_not_b32 s1, s0
    s_lshl_b32 s74, s54, 5
    s_add_u32 s74, s74, s76
    s_lshl_b32 s74, s74, 11
    s_add_u32 s74, s74, 9437184
    s_and_b32 s75, s0, 0xff
    v_mov_b32 v26, 0xffffff00
    v_pk_mul_f32 v[160:161], v[160:161], s[80:81]
    v_pk_mul_f32 v[162:163], v[162:163], s[80:81]
    v_pk_mul_f32 v[164:165], v[164:165], s[80:81]
    v_pk_mul_f32 v[166:167], v[166:167], s[80:81]
    v_exp_f32 v160, v160
    v_exp_f32 v161, v161
    v_exp_f32 v162, v162
    v_exp_f32 v163, v163
    v_exp_f32 v164, v164
    v_exp_f32 v165, v165
    v_exp_f32 v166, v166
    v_exp_f32 v167, v167
    v_pk_add_f32 v[160:161], v[160:161], 1.0 op_sel_hi:[1,0]
    v_pk_add_f32 v[162:163], v[162:163], 1.0 op_sel_hi:[1,0]
    v_pk_add_f32 v[164:165], v[164:165], 1.0 op_sel_hi:[1,0]
    v_pk_add_f32 v[166:167], v[166:167], 1.0 op_sel_hi:[1,0]
    v_rcp_f32 v160, v160
    v_rcp_f32 v161, v161
    v_rcp_f32 v162, v162
    v_rcp_f32 v163, v163
    v_rcp_f32 v164, v164
    v_rcp_f32 v165, v165
    v_rcp_f32 v166, v166
    v_rcp_f32 v167, v167
    v_pk_mul_f32 v[160:161], v[160:161], v[176:177]
    v_pk_mul_f32 v[162:163], v[162:163], v[178:179]
    v_pk_mul_f32 v[164:165], v[164:165], v[180:181]
    v_pk_mul_f32 v[166:167], v[166:167], v[182:183]
    v_cvt_pk_bf16_f32 v176, v160, v161
    v_cvt_pk_bf16_f32 v178, v164, v165
    v_cvt_pk_bf16_f32 v177, v162, v163
    v_cvt_pk_bf16_f32 v179, v166, v167
    v_permlane32_swap_b32 v176, v178
    s_nop 0
    v_permlane32_swap_b32 v177, v179
    buffer_store_dwordx4 v[176:179], v1, s[28:31], s72 offen offset:0 sc1
    s_mov_b32 s3, 200000
L_75:
    ds_read_b32 v2, v5 offset:0
    s_sub_u32 s3, s3, 1
    s_waitcnt lgkmcnt(0)
    s_cbranch_scc1 L_76
    v_cmp_gt_u32 vcc, 4, v2
    s_nop 0
    s_cbranch_vccnz L_75
L_76:
    ds_read_b64_tr_b16 v[64:65], v46 offset:0
    ds_read_b64_tr_b16 v[66:67], v46 offset:200
    ds_read_b64_tr_b16 v[96:97], v48 offset:128
    ds_read_b64_tr_b16 v[98:99], v48 offset:328
    ds_read_b64_tr_b16 v[100:101], v48 offset:160
    ds_read_b64_tr_b16 v[102:103], v48 offset:360
    ds_read_b64_tr_b16 v[68:69], v47 offset:0
    ds_read_b64_tr_b16 v[70:71], v47 offset:200
    ds_read_b64_tr_b16 v[104:105], v49 offset:128
    ds_read_b64_tr_b16 v[106:107], v49 offset:328
    ds_read_b64_tr_b16 v[108:109], v49 offset:160
    ds_read_b64_tr_b16 v[110:111], v49 offset:360
    ds_read_b64_tr_b16 v[72:73], v46 offset:8192
    ds_read_b64_tr_b16 v[74:75], v46 offset:8392
    ds_read_b64_tr_b16 v[112:113], v48 offset:8320
    ds_read_b64_tr_b16 v[114:115], v48 offset:8520
    ds_read_b64_tr_b16 v[116:117], v48 offset:8352
    ds_read_b64_tr_b16 v[118:119], v48 offset:8552
    s_waitcnt lgkmcnt(12)
    v_mfma_f32_16x16x32_bf16 v[56:59], v[64:67], v[96:99], 0
    v_mfma_f32_16x16x32_bf16 v[60:63], v[64:67], v[100:103], 0
    ds_read_b64_tr_b16 v[76:77], v47 offset:8192
    ds_read_b64_tr_b16 v[78:79], v47 offset:8392
    ds_read_b64_tr_b16 v[120:121], v49 offset:8320
    ds_read_b64_tr_b16 v[122:123], v49 offset:8520
    ds_read_b64_tr_b16 v[124:125], v49 offset:8352
    ds_read_b64_tr_b16 v[126:127], v49 offset:8552
    s_waitcnt lgkmcnt(12)
    v_mfma_f32_16x16x32_bf16 v[56:59], v[68:71], v[104:107], v[56:59]
    v_mfma_f32_16x16x32_bf16 v[60:63], v[68:71], v[108:111], v[60:63]
    ds_read_b64_tr_b16 v[80:81], v46 offset:16384
    ds_read_b64_tr_b16 v[82:83], v46 offset:16584
    ds_read_b64_tr_b16 v[128:129], v48 offset:16512
    ds_read_b64_tr_b16 v[130:131], v48 offset:16712
    ds_read_b64_tr_b16 v[132:133], v48 offset:16544
    ds_read_b64_tr_b16 v[134:135], v48 offset:16744
    s_waitcnt lgkmcnt(12)
    v_mfma_f32_16x16x32_bf16 v[56:59], v[72:75], v[112:115], v[56:59]
    v_mfma_f32_16x16x32_bf16 v[60:63], v[72:75], v[116:119], v[60:63]
    ds_read_b64_tr_b16 v[84:85], v47 offset:16384
    ds_read_b64_tr_b16 v[86:87], v47 offset:16584
    ds_read_b64_tr_b16 v[136:137], v49 offset:16512
    ds_read_b64_tr_b16 v[138:139], v49 offset:16712
    ds_read_b64_tr_b16 v[140:141], v49 offset:16544
    ds_read_b64_tr_b16 v[142:143], v49 offset:16744
    s_waitcnt lgkmcnt(12)
    v_mfma_f32_16x16x32_bf16 v[56:59], v[76:79], v[120:123], v[56:59]
    v_mfma_f32_16x16x32_bf16 v[60:63], v[76:79], v[124:127], v[60:63]
    ds_read_b64_tr_b16 v[88:89], v46 offset:24576
    ds_read_b64_tr_b16 v[90:91], v46 offset:24776
    ds_read_b64_tr_b16 v[144:145], v48 offset:24704
    ds_read_b64_tr_b16 v[146:147], v48 offset:24904
    ds_read_b64_tr_b16 v[148:149], v48 offset:24736
    ds_read_b64_tr_b16 v[150:151], v48 offset:24936
    s_waitcnt lgkmcnt(12)
    v_mfma_f32_16x16x32_bf16 v[56:59], v[80:83], v[128:131], v[56:59]
    v_mfma_f32_16x16x32_bf16 v[60:63], v[80:83], v[132:135], v[60:63]
    ds_read_b64_tr_b16 v[92:93], v47 offset:24576
    ds_read_b64_tr_b16 v[94:95], v47 offset:24776
    ds_read_b64_tr_b16 v[152:153], v49 offset:24704
    ds_read_b64_tr_b16 v[154:155], v49 offset:24904
    ds_read_b64_tr_b16 v[156:157], v49 offset:24736
    ds_read_b64_tr_b16 v[158:159], v49 offset:24936
    s_waitcnt lgkmcnt(12)
    v_mfma_f32_16x16x32_bf16 v[56:59], v[84:87], v[136:139], v[56:59]
    v_mfma_f32_16x16x32_bf16 v[60:63], v[84:87], v[140:143], v[60:63]
    s_waitcnt lgkmcnt(6)
    v_mfma_f32_16x16x32_bf16 v[56:59], v[88:91], v[144:147], v[56:59]
    v_mfma_f32_16x16x32_bf16 v[60:63], v[88:91], v[148:151], v[60:63]
    s_waitcnt lgkmcnt(0)
    v_mfma_f32_16x16x32_bf16 v[56:59], v[92:95], v[152:155], v[56:59]
    v_mfma_f32_16x16x32_bf16 v[60:63], v[92:95], v[156:159], v[60:63]
    s_nop 6
    v_and_or_b32 v56, v56, v26, s75
    v_and_or_b32 v59, v59, v26, s75
    v_and_or_b32 v60, v60, v26, s75
    v_and_or_b32 v63, v63, v26, s75
    buffer_store_dwordx4 v[56:59], v1, s[28:31], s74 offen offset:0 sc1
    buffer_store_dwordx4 v[60:63], v1, s[28:31], s74 offen offset:1024 sc1
    v_mov_b32 v2, s0
    v_mov_b32 v3, s1
    s_mov_b64 exec, 2
    buffer_store_dwordx2 v[2:3], v8, s[28:31], 0 offen sc1
    s_mov_b64 exec, -1
    v_mov_b32 v2, 1
    s_mov_b64 exec, 1
    ds_add_u32 v5, v2 offset:4
    s_mov_b64 exec, -1
    v_pk_mul_f32 v[168:169], v[168:169], s[80:81]
    v_pk_mul_f32 v[170:171], v[170:171], s[80:81]
    v_pk_mul_f32 v[172:173], v[172:173], s[80:81]
    v_pk_mul_f32 v[174:175], v[174:175], s[80:81]
    v_exp_f32 v168, v168
    v_exp_f32 v169, v169
    v_exp_f32 v170, v170
    v_exp_f32 v171, v171
    v_exp_f32 v172, v172
    v_exp_f32 v173, v173
    v_exp_f32 v174, v174
    v_exp_f32 v175, v175
    v_pk_add_f32 v[168:169], v[168:169], 1.0 op_sel_hi:[1,0]
    v_pk_add_f32 v[170:171], v[170:171], 1.0 op_sel_hi:[1,0]
    v_pk_add_f32 v[172:173], v[172:173], 1.0 op_sel_hi:[1,0]
    v_pk_add_f32 v[174:175], v[174:175], 1.0 op_sel_hi:[1,0]
    v_rcp_f32 v168, v168
    v_rcp_f32 v169, v169
    v_rcp_f32 v170, v170
    v_rcp_f32 v171, v171
    v_rcp_f32 v172, v172
    v_rcp_f32 v173, v173
    v_rcp_f32 v174, v174
    v_rcp_f32 v175, v175
    v_pk_mul_f32 v[168:169], v[168:169], v[184:185]
    v_pk_mul_f32 v[170:171], v[170:171], v[186:187]
    v_pk_mul_f32 v[172:173], v[172:173], v[188:189]
    v_pk_mul_f32 v[174:175], v[174:175], v[190:191]
    v_cvt_pk_bf16_f32 v184, v168, v169
    v_cvt_pk_bf16_f32 v186, v172, v173
    v_cvt_pk_bf16_f32 v185, v170, v171
    v_cvt_pk_bf16_f32 v187, v174, v175
    v_permlane32_swap_b32 v184, v186
    s_nop 0
    v_permlane32_swap_b32 v185, v187
    buffer_store_dwordx4 v[184:187], v1, s[28:31], s73 offen offset:0 sc1
    s_add_u32 s72, s72, 4096
    s_add_u32 s73, s73, 4096
    v_pk_mul_f32 v[192:193], v[192:193], s[80:81]
    v_pk_mul_f32 v[194:195], v[194:195], s[80:81]
    v_pk_mul_f32 v[196:197], v[196:197], s[80:81]
    v_pk_mul_f32 v[198:199], v[198:199], s[80:81]
    v_exp_f32 v192, v192
    v_exp_f32 v193, v193
    v_exp_f32 v194, v194
    v_exp_f32 v195, v195
    v_exp_f32 v196, v196
    v_exp_f32 v197, v197
    v_exp_f32 v198, v198
    v_exp_f32 v199, v199
    v_pk_add_f32 v[192:193], v[192:193], 1.0 op_sel_hi:[1,0]
    v_pk_add_f32 v[194:195], v[194:195], 1.0 op_sel_hi:[1,0]
    v_pk_add_f32 v[196:197], v[196:197], 1.0 op_sel_hi:[1,0]
    v_pk_add_f32 v[198:199], v[198:199], 1.0 op_sel_hi:[1,0]
    v_rcp_f32 v192, v192
    v_rcp_f32 v193, v193
    v_rcp_f32 v194, v194
    v_rcp_f32 v195, v195
    v_rcp_f32 v196, v196
    v_rcp_f32 v197, v197
    v_rcp_f32 v198, v198
    v_rcp_f32 v199, v199
    v_pk_mul_f32 v[192:193], v[192:193], v[208:209]
    v_pk_mul_f32 v[194:195], v[194:195], v[210:211]
    v_pk_mul_f32 v[196:197], v[196:197], v[212:213]
    v_pk_mul_f32 v[198:199], v[198:199], v[214:215]
    v_cvt_pk_bf16_f32 v208, v192, v193
    v_cvt_pk_bf16_f32 v210, v196, v197
    v_cvt_pk_bf16_f32 v209, v194, v195
    v_cvt_pk_bf16_f32 v211, v198, v199
    v_permlane32_swap_b32 v208, v210
    s_nop 0
    v_permlane32_swap_b32 v209, v211
    buffer_store_dwordx4 v[208:211], v1, s[28:31], s72 offen offset:0 sc1
    v_pk_mul_f32 v[200:201], v[200:201], s[80:81]
    v_pk_mul_f32 v[202:203], v[202:203], s[80:81]
    v_pk_mul_f32 v[204:205], v[204:205], s[80:81]
    v_pk_mul_f32 v[206:207], v[206:207], s[80:81]
    v_exp_f32 v200, v200
    v_exp_f32 v201, v201
    v_exp_f32 v202, v202
    v_exp_f32 v203, v203
    v_exp_f32 v204, v204
    v_exp_f32 v205, v205
    v_exp_f32 v206, v206
    v_exp_f32 v207, v207
    v_pk_add_f32 v[200:201], v[200:201], 1.0 op_sel_hi:[1,0]
    v_pk_add_f32 v[202:203], v[202:203], 1.0 op_sel_hi:[1,0]
    v_pk_add_f32 v[204:205], v[204:205], 1.0 op_sel_hi:[1,0]
    v_pk_add_f32 v[206:207], v[206:207], 1.0 op_sel_hi:[1,0]
    v_rcp_f32 v200, v200
    v_rcp_f32 v201, v201
    v_rcp_f32 v202, v202
    v_rcp_f32 v203, v203
    v_rcp_f32 v204, v204
    v_rcp_f32 v205, v205
    v_rcp_f32 v206, v206
    v_rcp_f32 v207, v207
    v_pk_mul_f32 v[200:201], v[200:201], v[216:217]
    v_pk_mul_f32 v[202:203], v[202:203], v[218:219]
    v_pk_mul_f32 v[204:205], v[204:205], v[220:221]
    v_pk_mul_f32 v[206:207], v[206:207], v[222:223]
    v_cvt_pk_bf16_f32 v216, v200, v201
    v_cvt_pk_bf16_f32 v218, v204, v205
    v_cvt_pk_bf16_f32 v217, v202, v203
    v_cvt_pk_bf16_f32 v219, v206, v207
    v_permlane32_swap_b32 v216, v218
    s_nop 0
    v_permlane32_swap_b32 v217, v219
    buffer_store_dwordx4 v[216:219], v1, s[28:31], s73 offen offset:0 sc1
    s_add_u32 s72, s72, 4096
    s_add_u32 s73, s73, 4096
    v_pk_mul_f32 v[224:225], v[224:225], s[80:81]
    v_pk_mul_f32 v[226:227], v[226:227], s[80:81]
    v_pk_mul_f32 v[228:229], v[228:229], s[80:81]
    v_pk_mul_f32 v[230:231], v[230:231], s[80:81]
    v_exp_f32 v224, v224
    v_exp_f32 v225, v225
    v_exp_f32 v226, v226
    v_exp_f32 v227, v227
    v_exp_f32 v228, v228
    v_exp_f32 v229, v229
    v_exp_f32 v230, v230
    v_exp_f32 v231, v231
    v_pk_add_f32 v[224:225], v[224:225], 1.0 op_sel_hi:[1,0]
    v_pk_add_f32 v[226:227], v[226:227], 1.0 op_sel_hi:[1,0]
    v_pk_add_f32 v[228:229], v[228:229], 1.0 op_sel_hi:[1,0]
    v_pk_add_f32 v[230:231], v[230:231], 1.0 op_sel_hi:[1,0]
    v_rcp_f32 v224, v224
    v_rcp_f32 v225, v225
    v_rcp_f32 v226, v226
    v_rcp_f32 v227, v227
    v_rcp_f32 v228, v228
    v_rcp_f32 v229, v229
    v_rcp_f32 v230, v230
    v_rcp_f32 v231, v231
    v_pk_mul_f32 v[224:225], v[224:225], v[240:241]
    v_pk_mul_f32 v[226:227], v[226:227], v[242:243]
    v_pk_mul_f32 v[228:229], v[228:229], v[244:245]
    v_pk_mul_f32 v[230:231], v[230:231], v[246:247]
    v_cvt_pk_bf16_f32 v240, v224, v225
    v_cvt_pk_bf16_f32 v242, v228, v229
    v_cvt_pk_bf16_f32 v241, v226, v227
    v_cvt_pk_bf16_f32 v243, v230, v231
    v_permlane32_swap_b32 v240, v242
    s_nop 0
    v_permlane32_swap_b32 v241, v243
    buffer_store_dwordx4 v[240:243], v1, s[28:31], s72 offen offset:0 sc1
    v_pk_mul_f32 v[232:233], v[232:233], s[80:81]
    v_pk_mul_f32 v[234:235], v[234:235], s[80:81]
    v_pk_mul_f32 v[236:237], v[236:237], s[80:81]
    v_pk_mul_f32 v[238:239], v[238:239], s[80:81]
    v_exp_f32 v232, v232
    v_exp_f32 v233, v233
    v_exp_f32 v234, v234
    v_exp_f32 v235, v235
    v_exp_f32 v236, v236
    v_exp_f32 v237, v237
    v_exp_f32 v238, v238
    v_exp_f32 v239, v239
    v_pk_add_f32 v[232:233], v[232:233], 1.0 op_sel_hi:[1,0]
    v_pk_add_f32 v[234:235], v[234:235], 1.0 op_sel_hi:[1,0]
    v_pk_add_f32 v[236:237], v[236:237], 1.0 op_sel_hi:[1,0]
    v_pk_add_f32 v[238:239], v[238:239], 1.0 op_sel_hi:[1,0]
    v_rcp_f32 v232, v232
    v_rcp_f32 v233, v233
    v_rcp_f32 v234, v234
    v_rcp_f32 v235, v235
    v_rcp_f32 v236, v236
    v_rcp_f32 v237, v237
    v_rcp_f32 v238, v238
    v_rcp_f32 v239, v239
    v_pk_mul_f32 v[232:233], v[232:233], v[248:249]
    v_pk_mul_f32 v[234:235], v[234:235], v[250:251]
    v_pk_mul_f32 v[236:237], v[236:237], v[252:253]
    v_pk_mul_f32 v[238:239], v[238:239], v[254:255]
    v_cvt_pk_bf16_f32 v248, v232, v233
    v_cvt_pk_bf16_f32 v250, v236, v237
    v_cvt_pk_bf16_f32 v249, v234, v235
    v_cvt_pk_bf16_f32 v251, v238, v239
    v_permlane32_swap_b32 v248, v250
    s_nop 0
    v_permlane32_swap_b32 v249, v251
    buffer_store_dwordx4 v[248:251], v1, s[28:31], s73 offen offset:0 sc1
    s_waitcnt vmcnt(2)
    v_mov_b32 v2, s0
    v_mov_b32 v3, s1
    s_mov_b64 exec, 8
    buffer_store_dwordx2 v[2:3], v8, s[28:31], 0 offen sc1
    s_mov_b64 exec, -1
    s_waitcnt vmcnt(1)
    v_mov_b32 v2, s0
    v_mov_b32 v3, s1
    s_mov_b64 exec, 1
    buffer_store_dwordx2 v[2:3], v8, s[28:31], 0 offen sc1
    s_mov_b64 exec, -1
    s_cmp_eq_u32 s51, 7
    s_cbranch_scc1 L_fin
    s_and_b32 s59, s0, 0x1fff
    s_or_b32 s59, s59, 0x4000
    s_lshl_b32 s61, s59, 16
L_cfin:
    s_setprio 1
    v_bfe_u32 v2, v0, 2, 3
    v_lshrrev_b32 v3, 5, v0
    v_lshl_add_u32 v2, v3, 4, v2
    v_bfe_u32 v10, v2, 2, 1
    v_and_b32 v3, 2, v2
    v_add_lshl_u32 v3, v3, v10, 2
    v_and_or_b32 v3, v0, 3, v3
    v_lshlrev_b32 v2, 7, v2
    v_lshl_add_u32 v2, v3, 3, v2
    v_xor_b32 v3, 0, v2
    v_add_u32 v10, 32768, v3
    v_add_u32 v16, 119040, v3
    v_xor_b32 v3, 32, v2
    v_add_u32 v11, 32768, v3
    v_add_u32 v17, 119040, v3
    v_xor_b32 v3, 64, v2
    v_add_u32 v12, 32768, v3
    v_add_u32 v18, 119040, v3
    v_xor_b32 v3, 96, v2
    v_add_u32 v13, 32768, v3
    v_add_u32 v19, 119040, v3
    s_mov_b32 s3, 200000
L_77:
    ds_read_b32 v2, v5 offset:16
    s_sub_u32 s3, s3, 1
    s_waitcnt lgkmcnt(0)
    s_cbranch_scc1 L_78
    v_cmp_gt_u32 vcc, 4, v2
    s_nop 0
    s_cbranch_vccnz L_77
L_78:
    s_lshl_b32 s74, s67, 2
    s_add_u32 s74, s74, s48
    s_lshl_b32 s74, s74, 9
    s_add_u32 s74, s74, 10551296
    s_add_u32 s16, s28, s74
    s_addc_u32 s17, s29, 0
    ds_read_b64_tr_b16 v[240:241], v16 offset:0
    ds_read_b64_tr_b16 v[242:243], v16 offset:1024
    ds_read_b64_tr_b16 v[244:245], v17 offset:0
    ds_read_b64_tr_b16 v[246:247], v17 offset:1024
    ds_read_b64_tr_b16 v[248:249], v18 offset:0
    ds_read_b64_tr_b16 v[250:251], v18 offset:1024
    ds_read_b64_tr_b16 v[252:253], v19 offset:0
    ds_read_b64_tr_b16 v[254:255], v19 offset:1024
    ds_read_b64_tr_b16 v[224:225], v16 offset:20736
    ds_read_b64_tr_b16 v[226:227], v16 offset:21760
    ds_read_b64_tr_b16 v[228:229], v17 offset:20736
    ds_read_b64_tr_b16 v[230:231], v17 offset:21760
    ds_read_b64_tr_b16 v[232:233], v18 offset:20736
    ds_read_b64_tr_b16 v[234:235], v18 offset:21760
    ds_read_b64_tr_b16 v[236:237], v19 offset:20736
    ds_read_b64_tr_b16 v[238:239], v19 offset:21760
    ds_read_b64_tr_b16 v[208:209], v10 offset:0
    ds_read_b64_tr_b16 v[210:211], v10 offset:1024
    ds_read_b64_tr_b16 v[212:213], v11 offset:0
    ds_read_b64_tr_b16 v[214:215], v11 offset:1024
    ds_read_b64_tr_b16 v[216:217], v12 offset:0
    ds_read_b64_tr_b16 v[218:219], v12 offset:1024
    ds_read_b64_tr_b16 v[220:221], v13 offset:0
    ds_read_b64_tr_b16 v[222:223], v13 offset:1024
    ds_read_b64_tr_b16 v[192:193], v10 offset:4096
    ds_read_b64_tr_b16 v[194:195], v10 offset:5120
    ds_read_b64_tr_b16 v[196:197], v11 offset:4096
    ds_read_b64_tr_b16 v[198:199], v11 offset:5120
    ds_read_b64_tr_b16 v[200:201], v12 offset:4096
    ds_read_b64_tr_b16 v[202:203], v12 offset:5120
    ds_read_b64_tr_b16 v[204:205], v13 offset:4096
    ds_read_b64_tr_b16 v[206:207], v13 offset:5120
    ds_read_b64_tr_b16 v[176:177], v16 offset:4096
    ds_read_b64_tr_b16 v[178:179], v16 offset:5120
    ds_read_b64_tr_b16 v[180:181], v17 offset:4096
    ds_read_b64_tr_b16 v[182:183], v17 offset:5120
    ds_read_b64_tr_b16 v[184:185], v18 offset:4096
    ds_read_b64_tr_b16 v[186:187], v18 offset:5120
    ds_read_b64_tr_b16 v[188:189], v19 offset:4096
    ds_read_b64_tr_b16 v[190:191], v19 offset:5120
    ds_read_b64_tr_b16 v[160:161], v16 offset:24832
    ds_read_b64_tr_b16 v[162:163], v16 offset:25856
    ds_read_b64_tr_b16 v[164:165], v17 offset:24832
    ds_read_b64_tr_b16 v[166:167], v17 offset:25856
    ds_read_b64_tr_b16 v[168:169], v18 offset:24832
    ds_read_b64_tr_b16 v[170:171], v18 offset:25856
    ds_read_b64_tr_b16 v[172:173], v19 offset:24832
    ds_read_b64_tr_b16 v[174:175], v19 offset:25856
    ds_read_b64_tr_b16 v[144:145], v10 offset:8192
    ds_read_b64_tr_b16 v[146:147], v10 offset:9216
    ds_read_b64_tr_b16 v[148:149], v11 offset:8192
    ds_read_b64_tr_b16 v[150:151], v11 offset:9216
    ds_read_b64_tr_b16 v[152:153], v12 offset:8192
    ds_read_b64_tr_b16 v[154:155], v12 offset:9216
    ds_read_b64_tr_b16 v[156:157], v13 offset:8192
    ds_read_b64_tr_b16 v[158:159], v13 offset:9216
    ds_read_b64_tr_b16 v[128:129], v10 offset:12288
    ds_read_b64_tr_b16 v[130:131], v10 offset:13312
    ds_read_b64_tr_b16 v[132:133], v11 offset:12288
    ds_read_b64_tr_b16 v[134:135], v11 offset:13312
    ds_read_b64_tr_b16 v[136:137], v12 offset:12288
    ds_read_b64_tr_b16 v[138:139], v12 offset:13312
    ds_read_b64_tr_b16 v[140:141], v13 offset:12288
    ds_read_b64_tr_b16 v[142:143], v13 offset:13312
    s_load_dwordx2 s[4:5], s[16:17], 131072 glc
    s_load_dwordx2 s[6:7], s[16:17], 131200 glc
    s_load_dwordx2 s[8:9], s[16:17], 131328 glc
    s_load_dwordx2 s[10:11], s[16:17], 131456 glc
    ds_read_b64_tr_b16 v[112:113], v16 offset:8192
    ds_read_b64_tr_b16 v[114:115], v16 offset:9216
    ds_read_b64_tr_b16 v[116:117], v17 offset:8192
    ds_read_b64_tr_b16 v[118:119], v17 offset:9216
    ds_read_b64_tr_b16 v[120:121], v18 offset:8192
    ds_read_b64_tr_b16 v[122:123], v18 offset:9216
    ds_read_b64_tr_b16 v[124:125], v19 offset:8192
    ds_read_b64_tr_b16 v[126:127], v19 offset:9216
    ds_read_b64_tr_b16 v[96:97], v16 offset:28928
    ds_read_b64_tr_b16 v[98:99], v16 offset:29952
    ds_read_b64_tr_b16 v[100:101], v17 offset:28928
    ds_read_b64_tr_b16 v[102:103], v17 offset:29952
    ds_read_b64_tr_b16 v[104:105], v18 offset:28928
    ds_read_b64_tr_b16 v[106:107], v18 offset:29952
    ds_read_b64_tr_b16 v[108:109], v19 offset:28928
    ds_read_b64_tr_b16 v[110:111], v19 offset:29952
    ds_read_b64_tr_b16 v[80:81], v10 offset:16384
    ds_read_b64_tr_b16 v[82:83], v10 offset:17408
    ds_read_b64_tr_b16 v[84:85], v11 offset:16384
    ds_read_b64_tr_b16 v[86:87], v11 offset:17408
    ds_read_b64_tr_b16 v[88:89], v12 offset:16384
    ds_read_b64_tr_b16 v[90:91], v12 offset:17408
    ds_read_b64_tr_b16 v[92:93], v13 offset:16384
    ds_read_b64_tr_b16 v[94:95], v13 offset:17408
    v_and_b32 v20, 15, v0
    v_lshrrev_b32 v21, 4, v0
    v_lshlrev_b32 v22, 9, v21
    v_lshl_add_u32 v4, v20, 4, v22
    s_and_b32 s70, s48, 1
    s_lshr_b32 s71, s48, 1
    s_mul_i32 s72, s71, 147456
    s_add_u32 s77, s77, s72
    s_lshl_b32 s72, s70, 8
    s_add_u32 s77, s77, s72
    s_add_u32 s77, s77, 114688
    s_brev_b32 s39, s65
    s_lshr_b32 s39, s39, 29
    s_lshl_b32 s39, s39, 12
    s_lshl_b32 s72, s48, 12
    s_add_u32 s72, s72, 98304
    v_lshl_add_u32 v22, v20, 8, s72
    v_xor_b32 v6, v21, v20
    v_lshl_add_u32 v6, v6, 4, v22
    v_xor_b32 v7, 64, v6
    v_xor_b32 v8, 128, v6
    v_xor_b32 v9, 192, v6
    s_mov_b32 s3, 200000
    s_branch L_80
L_79:
    s_load_dwordx2 s[4:5], s[16:17], 131072 glc
    s_load_dwordx2 s[6:7], s[16:17], 131200 glc
    s_load_dwordx2 s[8:9], s[16:17], 131328 glc
    s_load_dwordx2 s[10:11], s[16:17], 131456 glc
    s_sub_u32 s3, s3, 1
    s_cbranch_scc1 L_81
L_80:
    s_waitcnt lgkmcnt(0)
    s_xor_b64 s[4:5], s[4:5], s[0:1]
    s_xor_b64 s[6:7], s[6:7], s[0:1]
    s_xor_b64 s[8:9], s[8:9], s[0:1]
    s_xor_b64 s[10:11], s[10:11], s[0:1]
    s_or_b64 s[4:5], s[4:5], s[6:7]
    s_or_b64 s[8:9], s[8:9], s[10:11]
    s_or_b64 s[4:5], s[4:5], s[8:9]
    s_cbranch_scc1 L_79
L_81:
    s_waitcnt lgkmcnt(0)
    v_mov_b32 v2, 1
    s_mov_b64 exec, 1
    ds_add_u32 v5, v2 offset:12
    s_mov_b64 exec, -1
    s_mov_b32 s3, 200000
L_82:
    ds_read_b32 v2, v5 offset:12
    s_sub_u32 s3, s3, 1
    s_waitcnt lgkmcnt(0)
    s_cbranch_scc1 L_83
    v_cmp_gt_u32 vcc, 8, v2
    s_nop 0
    s_cbranch_vccnz L_82
L_83:
    s_mov_b32 s3, 200000
L_oagain:
    s_xor_b32 s70, s39, 0
    s_add_u32 s70, s70, s77
    buffer_load_dwordx4 v[36:39], v4, s[28:31], s70 offen offset:0 sc1
    buffer_load_dwordx4 v[40:43], v4, s[28:31], s70 offen offset:2048 sc1
    s_xor_b32 s70, s39, 4096
    s_add_u32 s70, s70, s77
    buffer_load_dwordx4 v[44:47], v4, s[28:31], s70 offen offset:0 sc1
    buffer_load_dwordx4 v[48:51], v4, s[28:31], s70 offen offset:2048 sc1
    s_xor_b32 s70, s39, 8192
    s_add_u32 s70, s70, s77
    buffer_load_dwordx4 v[52:55], v4, s[28:31], s70 offen offset:0 sc1
    buffer_load_dwordx4 v[56:59], v4, s[28:31], s70 offen offset:2048 sc1
    s_xor_b32 s70, s39, 12288
    s_add_u32 s70, s70, s77
    buffer_load_dwordx4 v[60:63], v4, s[28:31], s70 offen offset:0 sc1
    buffer_load_dwordx4 v[64:67], v4, s[28:31], s70 offen offset:2048 sc1
    s_xor_b32 s70, s39, 16384
    s_add_u32 s70, s70, s77
    buffer_load_dwordx4 v[68:71], v4, s[28:31], s70 offen offset:0 sc1
    s_waitcnt vmcnt(8)
    v_xor_b32 v14, s61, v39
    v_mfma_f32_16x16x32_bf16 v[20:23], v[240:243], v[36:39], 0
    buffer_load_dwordx4 v[72:75], v4, s[28:31], s70 offen offset:2048 sc1
    v_mfma_f32_16x16x32_bf16 v[24:27], v[244:247], v[36:39], 0
    s_waitcnt vmcnt(8)
    v_bitop3_b32 v14, v14, v43, s61 bitop3:0xf6
    v_mfma_f32_16x16x32_bf16 v[28:31], v[248:251], v[36:39], 0
    v_mfma_f32_16x16x32_bf16 v[32:35], v[252:255], v[36:39], 0
    v_mfma_f32_16x16x32_bf16 v[20:23], v[224:227], v[40:43], v[20:23]
    ds_read_b64_tr_b16 v[240:241], v10 offset:20480
    ds_read_b64_tr_b16 v[242:243], v10 offset:21504
    s_xor_b32 s70, s39, 20480
    s_add_u32 s70, s70, s77
    buffer_load_dwordx4 v[76:79], v4, s[28:31], s70 offen offset:0 sc1
    v_mfma_f32_16x16x32_bf16 v[24:27], v[228:231], v[40:43], v[24:27]
    ds_read_b64_tr_b16 v[244:245], v11 offset:20480
    ds_read_b64_tr_b16 v[246:247], v11 offset:21504
    s_waitcnt vmcnt(8)
    v_bitop3_b32 v14, v14, v47, s61 bitop3:0xf6
    v_mfma_f32_16x16x32_bf16 v[28:31], v[232:235], v[40:43], v[28:31]
    ds_read_b64_tr_b16 v[248:249], v12 offset:20480
    ds_read_b64_tr_b16 v[250:251], v12 offset:21504
    v_mfma_f32_16x16x32_bf16 v[32:35], v[236:239], v[40:43], v[32:35]
    ds_read_b64_tr_b16 v[252:253], v13 offset:20480
    ds_read_b64_tr_b16 v[254:255], v13 offset:21504
    v_mfma_f32_16x16x32_bf16 v[20:23], v[208:211], v[44:47], v[20:23]
    ds_read_b64_tr_b16 v[224:225], v16 offset:12288
    ds_read_b64_tr_b16 v[226:227], v16 offset:13312
    buffer_load_dwordx4 v[36:39], v4, s[28:31], s70 offen offset:2048 sc1
    v_mfma_f32_16x16x32_bf16 v[24:27], v[212:215], v[44:47], v[24:27]
    ds_read_b64_tr_b16 v[228:229], v17 offset:12288
    ds_read_b64_tr_b16 v[230:231], v17 offset:13312
    s_waitcnt vmcnt(8)
    v_bitop3_b32 v14, v14, v51, s61 bitop3:0xf6
    v_mfma_f32_16x16x32_bf16 v[28:31], v[216:219], v[44:47], v[28:31]
    ds_read_b64_tr_b16 v[232:233], v18 offset:12288
    ds_read_b64_tr_b16 v[234:235], v18 offset:13312
    v_mfma_f32_16x16x32_bf16 v[32:35], v[220:223], v[44:47], v[32:35]
    ds_read_b64_tr_b16 v[236:237], v19 offset:12288
    ds_read_b64_tr_b16 v[238:239], v19 offset:13312
    v_mfma_f32_16x16x32_bf16 v[20:23], v[192:195], v[48:51], v[20:23]
    ds_read_b64_tr_b16 v[208:209], v16 offset:33024
    ds_read_b64_tr_b16 v[210:211], v16 offset:34048
    s_xor_b32 s70, s39, 24576
    s_add_u32 s70, s70, s77
    buffer_load_dwordx4 v[40:43], v4, s[28:31], s70 offen offset:0 sc1
    v_mfma_f32_16x16x32_bf16 v[24:27], v[196:199], v[48:51], v[24:27]
    ds_read_b64_tr_b16 v[212:213], v17 offset:33024
    ds_read_b64_tr_b16 v[214:215], v17 offset:34048
    s_waitcnt vmcnt(8)
    v_bitop3_b32 v14, v14, v55, s61 bitop3:0xf6
    v_mfma_f32_16x16x32_bf16 v[28:31], v[200:203], v[48:51], v[28:31]
    ds_read_b64_tr_b16 v[216:217], v18 offset:33024
    ds_read_b64_tr_b16 v[218:219], v18 offset:34048
    v_mfma_f32_16x16x32_bf16 v[32:35], v[204:207], v[48:51], v[32:35]
    ds_read_b64_tr_b16 v[220:221], v19 offset:33024
    ds_read_b64_tr_b16 v[222:223], v19 offset:34048
    v_mfma_f32_16x16x32_bf16 v[20:23], v[176:179], v[52:55], v[20:23]
    ds_read_b64_tr_b16 v[192:193], v10 offset:24576
    ds_read_b64_tr_b16 v[194:195], v10 offset:25600
    buffer_load_dwordx4 v[44:47], v4, s[28:31], s70 offen offset:2048 sc1
    v_mfma_f32_16x16x32_bf16 v[24:27], v[180:183], v[52:55], v[24:27]
    ds_read_b64_tr_b16 v[196:197], v11 offset:24576
    ds_read_b64_tr_b16 v[198:199], v11 offset:25600
    s_waitcnt vmcnt(8)
    v_bitop3_b32 v14, v14, v59, s61 bitop3:0xf6
    v_mfma_f32_16x16x32_bf16 v[28:31], v[184:187], v[52:55], v[28:31]
    ds_read_b64_tr_b16 v[200:201], v12 offset:24576
    ds_read_b64_tr_b16 v[202:203], v12 offset:25600
    v_mfma_f32_16x16x32_bf16 v[32:35], v[188:191], v[52:55], v[32:35]
    ds_read_b64_tr_b16 v[204:205], v13 offset:24576
    ds_read_b64_tr_b16 v[206:207], v13 offset:25600
    v_mfma_f32_16x16x32_bf16 v[20:23], v[160:163], v[56:59], v[20:23]
    ds_read_b64_tr_b16 v[176:177], v10 offset:28672
    ds_read_b64_tr_b16 v[178:179], v10 offset:29696
    s_xor_b32 s70, s39, 28672
    s_add_u32 s70, s70, s77
    buffer_load_dwordx4 v[48:51], v4, s[28:31], s70 offen offset:0 sc1
    v_mfma_f32_16x16x32_bf16 v[24:27], v[164:167], v[56:59], v[24:27]
    ds_read_b64_tr_b16 v[180:181], v11 offset:28672
    ds_read_b64_tr_b16 v[182:183], v11 offset:29696
    s_waitcnt vmcnt(8)
    v_bitop3_b32 v14, v14, v63, s61 bitop3:0xf6
    v_mfma_f32_16x16x32_bf16 v[28:31], v[168:171], v[56:59], v[28:31]
    ds_read_b64_tr_b16 v[184:185], v12 offset:28672
    ds_read_b64_tr_b16 v[186:187], v12 offset:29696
    v_mfma_f32_16x16x32_bf16 v[32:35], v[172:175], v[56:59], v[32:35]
    ds_read_b64_tr_b16 v[188:189], v13 offset:28672
    ds_read_b64_tr_b16 v[190:191], v13 offset:29696
    v_mfma_f32_16x16x32_bf16 v[20:23], v[144:147], v[60:63], v[20:23]
    buffer_load_dwordx4 v[52:55], v4, s[28:31], s70 offen offset:2048 sc1
    v_mfma_f32_16x16x32_bf16 v[24:27], v[148:151], v[60:63], v[24:27]
    s_waitcnt vmcnt(8)
    v_bitop3_b32 v14, v14, v67, s61 bitop3:0xf6
    v_mfma_f32_16x16x32_bf16 v[28:31], v[152:155], v[60:63], v[28:31]
    v_mfma_f32_16x16x32_bf16 v[32:35], v[156:159], v[60:63], v[32:35]
    v_mfma_f32_16x16x32_bf16 v[20:23], v[128:131], v[64:67], v[20:23]
    v_mfma_f32_16x16x32_bf16 v[24:27], v[132:135], v[64:67], v[24:27]
    s_waitcnt vmcnt(7)
    v_bitop3_b32 v14, v14, v71, s61 bitop3:0xf6
    v_mfma_f32_16x16x32_bf16 v[28:31], v[136:139], v[64:67], v[28:31]
    v_mfma_f32_16x16x32_bf16 v[32:35], v[140:143], v[64:67], v[32:35]
    v_mfma_f32_16x16x32_bf16 v[20:23], v[112:115], v[68:71], v[20:23]
    v_mfma_f32_16x16x32_bf16 v[24:27], v[116:119], v[68:71], v[24:27]
    s_waitcnt vmcnt(6)
    v_bitop3_b32 v14, v14, v75, s61 bitop3:0xf6
    v_mfma_f32_16x16x32_bf16 v[28:31], v[120:123], v[68:71], v[28:31]
    v_mfma_f32_16x16x32_bf16 v[32:35], v[124:127], v[68:71], v[32:35]
    v_mfma_f32_16x16x32_bf16 v[20:23], v[96:99], v[72:75], v[20:23]
    v_mfma_f32_16x16x32_bf16 v[24:27], v[100:103], v[72:75], v[24:27]
    s_waitcnt vmcnt(5)
    v_bitop3_b32 v14, v14, v79, s61 bitop3:0xf6
    v_mfma_f32_16x16x32_bf16 v[28:31], v[104:107], v[72:75], v[28:31]
    v_mfma_f32_16x16x32_bf16 v[32:35], v[108:111], v[72:75], v[32:35]
    v_mfma_f32_16x16x32_bf16 v[20:23], v[80:83], v[76:79], v[20:23]
    v_mfma_f32_16x16x32_bf16 v[24:27], v[84:87], v[76:79], v[24:27]
    s_waitcnt vmcnt(4)
    v_bitop3_b32 v14, v14, v39, s61 bitop3:0xf6
    v_mfma_f32_16x16x32_bf16 v[28:31], v[88:91], v[76:79], v[28:31]
    v_mfma_f32_16x16x32_bf16 v[32:35], v[92:95], v[76:79], v[32:35]
    s_waitcnt lgkmcnt(14)
    v_mfma_f32_16x16x32_bf16 v[20:23], v[240:243], v[36:39], v[20:23]
    v_mfma_f32_16x16x32_bf16 v[24:27], v[244:247], v[36:39], v[24:27]
    s_waitcnt vmcnt(3)
    v_bitop3_b32 v14, v14, v43, s61 bitop3:0xf6
    v_mfma_f32_16x16x32_bf16 v[28:31], v[248:251], v[36:39], v[28:31]
    v_mfma_f32_16x16x32_bf16 v[32:35], v[252:255], v[36:39], v[32:35]
    v_mfma_f32_16x16x32_bf16 v[20:23], v[224:227], v[40:43], v[20:23]
    v_mfma_f32_16x16x32_bf16 v[24:27], v[228:231], v[40:43], v[24:27]
    s_waitcnt vmcnt(2)
    v_bitop3_b32 v14, v14, v47, s61 bitop3:0xf6
    v_mfma_f32_16x16x32_bf16 v[28:31], v[232:235], v[40:43], v[28:31]
    v_mfma_f32_16x16x32_bf16 v[32:35], v[236:239], v[40:43], v[32:35]
    v_mfma_f32_16x16x32_bf16 v[20:23], v[208:211], v[44:47], v[20:23]
    v_mfma_f32_16x16x32_bf16 v[24:27], v[212:215], v[44:47], v[24:27]
    s_waitcnt vmcnt(1)
    v_bitop3_b32 v14, v14, v51, s61 bitop3:0xf6
    v_mfma_f32_16x16x32_bf16 v[28:31], v[216:219], v[44:47], v[28:31]
    v_mfma_f32_16x16x32_bf16 v[32:35], v[220:223], v[44:47], v[32:35]
    s_waitcnt lgkmcnt(8)
    v_mfma_f32_16x16x32_bf16 v[20:23], v[192:195], v[48:51], v[20:23]
    v_mfma_f32_16x16x32_bf16 v[24:27], v[196:199], v[48:51], v[24:27]
    s_waitcnt vmcnt(0)
    v_bitop3_b32 v14, v14, v55, s61 bitop3:0xf6
    v_mfma_f32_16x16x32_bf16 v[28:31], v[200:203], v[48:51], v[28:31]
    v_mfma_f32_16x16x32_bf16 v[32:35], v[204:207], v[48:51], v[32:35]
    s_waitcnt lgkmcnt(0)
    v_mfma_f32_16x16x32_bf16 v[20:23], v[176:179], v[52:55], v[20:23]
    v_cmp_lt_u32 vcc, 0xffff, v14
    v_mfma_f32_16x16x32_bf16 v[24:27], v[180:183], v[52:55], v[24:27]
    v_mfma_f32_16x16x32_bf16 v[28:31], v[184:187], v[52:55], v[28:31]
    v_mfma_f32_16x16x32_bf16 v[32:35], v[188:191], v[52:55], v[32:35]
    s_cbranch_vccnz L_oslow
L_ook:
    s_nop 2
    ds_write_b128 v6, v[20:23]
    s_nop 0
    ds_write_b128 v7, v[24:27]
    ds_write_b128 v8, v[28:31]
    ds_write_b128 v9, v[32:35]
    v_mov_b32 v2, 1
    v_lshl_add_u32 v3, s48, 2, v5
    s_mov_b64 exec, 1
    ds_add_u32 v3, v2 offset:32
    s_mov_b64 exec, -1
    s_waitcnt lgkmcnt(0)
    s_branch L_fin
L_oslow:
    s_sub_u32 s3, s3, 1
    s_cbranch_scc1 L_ook
    ds_read_b64_tr_b16 v[240:241], v16 offset:0
    ds_read_b64_tr_b16 v[242:243], v16 offset:1024
    ds_read_b64_tr_b16 v[244:245], v17 offset:0
    ds_read_b64_tr_b16 v[246:247], v17 offset:1024
    ds_read_b64_tr_b16 v[248:249], v18 offset:0
    ds_read_b64_tr_b16 v[250:251], v18 offset:1024
    ds_read_b64_tr_b16 v[252:253], v19 offset:0
    ds_read_b64_tr_b16 v[254:255], v19 offset:1024
    ds_read_b64_tr_b16 v[224:225], v16 offset:20736
    ds_read_b64_tr_b16 v[226:227], v16 offset:21760
    ds_read_b64_tr_b16 v[228:229], v17 offset:20736
    ds_read_b64_tr_b16 v[230:231], v17 offset:21760
    ds_read_b64_tr_b16 v[232:233], v18 offset:20736
    ds_read_b64_tr_b16 v[234:235], v18 offset:21760
    ds_read_b64_tr_b16 v[236:237], v19 offset:20736
    ds_read_b64_tr_b16 v[238:239], v19 offset:21760
    ds_read_b64_tr_b16 v[208:209], v10 offset:0
    ds_read_b64_tr_b16 v[210:211], v10 offset:1024
    ds_read_b64_tr_b16 v[212:213], v11 offset:0
    ds_read_b64_tr_b16 v[214:215], v11 offset:1024
    ds_read_b64_tr_b16 v[216:217], v12 offset:0
    ds_read_b64_tr_b16 v[218:219], v12 offset:1024
    ds_read_b64_tr_b16 v[220:221], v13 offset:0
    ds_read_b64_tr_b16 v[222:223], v13 offset:1024
    ds_read_b64_tr_b16 v[192:193], v10 offset:4096
    ds_read_b64_tr_b16 v[194:195], v10 offset:5120
    ds_read_b64_tr_b16 v[196:197], v11 offset:4096
    ds_read_b64_tr_b16 v[198:199], v11 offset:5120
    ds_read_b64_tr_b16 v[200:201], v12 offset:4096
    ds_read_b64_tr_b16 v[202:203], v12 offset:5120
    ds_read_b64_tr_b16 v[204:205], v13 offset:4096
    ds_read_b64_tr_b16 v[206:207], v13 offset:5120
    ds_read_b64_tr_b16 v[176:177], v16 offset:4096
    ds_read_b64_tr_b16 v[178:179], v16 offset:5120
    ds_read_b64_tr_b16 v[180:181], v17 offset:4096
    ds_read_b64_tr_b16 v[182:183], v17 offset:5120
    ds_read_b64_tr_b16 v[184:185], v18 offset:4096
    ds_read_b64_tr_b16 v[186:187], v18 offset:5120
    ds_read_b64_tr_b16 v[188:189], v19 offset:4096
    ds_read_b64_tr_b16 v[190:191], v19 offset:5120
    s_waitcnt lgkmcnt(0)
    s_branch L_oagain
L_fin:
L_end:
    s_endpgm
.section .rodata,"a"
.p2align 6
.amdhsa_kernel gated_mix__linear_kernel_hedgehog__glu_gated_glu__prompt_kernel
.amdhsa_next_free_vgpr 256
.amdhsa_next_free_sgpr 102
.amdhsa_accum_offset 256
.amdhsa_group_segment_fixed_size 0
.amdhsa_kernarg_size 96
.amdhsa_user_sgpr_count 2
.amdhsa_user_sgpr_kernarg_segment_ptr 1
.amdhsa_system_sgpr_workgroup_id_x 1
.end_amdhsa_kernel
```
